```python
import torch

def _softmax(x, axis=-1):
    return torch.softmax(x, dim=axis)
def _gelu(x):
    return torch.nn.functional.gelu(x, approximate="tanh")
def _silu(x):
    return torch.nn.functional.silu(x)
def _sigmoid(x):
    return torch.sigmoid(x)
def _layernorm(x, axis=-1, eps=1e-5):
    m = x.mean(dim=axis, keepdim=True)
    v = x.var(dim=axis, keepdim=True, unbiased=False)
    return (x - m) / torch.sqrt(v + eps)
def _scatter_add(tgt, idx, src, axis=0):
    return tgt.clone().index_add_(axis, idx, src)
def _segment_sum(src, seg, n):
    out = torch.zeros((n,) + src.shape[1:], dtype=src.dtype)
    return out.index_add_(0, seg, src)
def _pad(x, pw):
    flat = tuple(v for pair in reversed(pw) for v in pair)
    return torch.nn.functional.pad(x, flat)

kernel_name = 'sequential_preLN__ssm_conv_s4d__mixer_s_mlp__prompt'

def setup_inputs():

    _w = (lambda a: (lambda t: t.to(torch.bfloat16) if t.is_floating_point() else t)(torch.as_tensor(a)))
    def _A_setup():
        Bsz, L, D, N = 1, 2048, 640, 128
        return {
            "u": _w((lambda *s: torch.randn(*s, dtype=torch.bfloat16) * 0.05)(Bsz, L, D)),
            "log_A_real": _w((lambda *s: torch.randn(*s, dtype=torch.bfloat16) * 6.4)(D, N) * 0.5),
            "A_imag": _w((lambda *s: torch.randn(*s, dtype=torch.bfloat16) * 0.05)(D, N) * 3.14),
            "C_real": _w((lambda *s: torch.randn(*s, dtype=torch.bfloat16) * 0.05)(D, N) / N ** 0.5),
            "C_imag": _w((lambda *s: torch.randn(*s, dtype=torch.bfloat16) * 0.05)(D, N) / N ** 0.5),
            "log_dt": _w((lambda *s: torch.randn(*s, dtype=torch.bfloat16) * 0.05)(D) * 0.5 - 4.0),
            "D_skip": _w((lambda *s: torch.randn(*s, dtype=torch.bfloat16) * 0.05)(D)),
        }
    _A_in = _A_setup()

    def _B_setup():
        B, S, D, F = 1, 2048, 640, 1728
        return {
            "x":  _w((lambda *s: torch.randn(*s, dtype=torch.bfloat16) * 0.05)(B, S, D)),
            "w1": _w((lambda *s: torch.randn(*s, dtype=torch.bfloat16) * 6.4)(D, D) * (D ** -0.5)),
            "w2": _w((lambda *s: torch.randn(*s, dtype=torch.bfloat16) * 6.4)(D, D) * (D ** -0.5)),
            "w3": _w((lambda *s: torch.randn(*s, dtype=torch.bfloat16) * 6.4)(D, F) * (D ** -0.5)),
            "w4": _w((lambda *s: torch.randn(*s, dtype=torch.bfloat16) * 6.4)(F, D) * (F ** -0.5)),
        }
    _B_in = _B_setup()

    return {
        "A_u": _A_in["u"],
        "A_log_A_real": _A_in["log_A_real"],
        "A_A_imag": _A_in["A_imag"],
        "A_C_real": _A_in["C_real"],
        "A_C_imag": _A_in["C_imag"],
        "A_log_dt": _A_in["log_dt"],
        "A_D_skip": _A_in["D_skip"],
        "B_x": _B_in["x"],
        "B_w1": _B_in["w1"],
        "B_w2": _B_in["w2"],
        "B_w3": _B_in["w3"],
        "B_w4": _B_in["w4"],
    }

def reference(A_u, A_log_A_real, A_A_imag, A_C_real, A_C_imag, A_log_dt, A_D_skip, B_x, B_w1, B_w2, B_w3, B_w4):
    def _A_ref(u, log_A_real, A_imag, C_real, C_imag, log_dt, D_skip):
        L = u.shape[1]
        dt = torch.exp(log_dt)
        A = -torch.exp(log_A_real) + 1j * A_imag
        C = (C_real + 1j * C_imag) * dt[:, None]
        pos = (lambda x, dt: x.to(dt))(torch.arange(L), log_dt.dtype)
        P = torch.exp((A * dt[:, None])[:, :, None] * pos[None, None, :])
        K = 2.0 * torch.einsum("dn,dnl->dl", C, P).real
        L2 = 2 * L
        u_t = (lambda x, *d: x.permute(*d))(u, 0, 2, 1)
        Kf = (lambda x, *a, **k: torch.fft.rfft(x.float(), *a, **k))(K, L2)
        Uf = (lambda x, *a, **k: torch.fft.rfft(x.float(), *a, **k))(u_t, L2)
        y = (lambda x, *a, **k: torch.fft.irfft(x, *a, **k).to(torch.bfloat16))(Uf * Kf[None, :, :], L2)[:, :, :L]
        y = (lambda x, *d: x.permute(*d))(y, 0, 2, 1)
        return y + u * D_skip[None, None, :]

    def _B_ref(x, w1, w2, w3, w4):
        B, S, D = x.shape
        h = _gelu(_layernorm(x, axis=-1) @ w1)
        c = D // 4
        g0 = _pad(h[:, :, 0*c:1*c], ((0, 0), (1, 0), (0, 0)))[:, :S, :]
        g1 = _pad(h[:, :, 1*c:2*c], ((0, 0), (0, 1), (0, 0)))[:, 1:, :]
        g2 = _pad(h[:, :, 2*c:3*c], ((0, 0), (2, 0), (0, 0)))[:, :S, :]
        g3 = _pad(h[:, :, 3*c:   ], ((0, 0), (0, 2), (0, 0)))[:, 2:, :]
        hs = torch.concatenate([g0, g1, g2, g3], axis=-1) @ w2
        x1 = x + hs
        h2 = _gelu(_layernorm(x1, axis=-1) @ w3) @ w4
        return x1 + h2

    x = A_u
    h = x + _A_ref(_layernorm(x, axis=-1), A_log_A_real, A_A_imag, A_C_real, A_C_imag, A_log_dt, A_D_skip)
    h2 = h + _B_ref(_layernorm(h, axis=-1), B_w1, B_w2, B_w3, B_w4)
    return h2
```

```asm
; @launch kernel=f_kernel grid=(1024,1,1) block=(256,1,1) lds=39680
; @launch kernel=g_kernel grid=(256,1,1) block=(256,1,1) lds=162816
.amdgcn_target "amdgcn-amd-amdhsa--gfx950"
.text
.globl f_kernel
.p2align 8
.type f_kernel,@function
f_kernel:
    s_load_dwordx2 s[4:5], s[0:1], 112
    s_sub_u32 s3, s2, 0
    s_cmp_ge_u32 s3, 8
    s_cbranch_scc1 F_FP
    s_getpc_b64 s[62:63]
F_FQ:
    v_lshlrev_b32 v127, 6, v0
    v_min_u32 v127, g_kernel-F_FQ-4, v127
    global_load_dword v127, v127, s[62:63]
F_FP:
    s_lshr_b32 s3, s2, 7
    s_min_u32 s3, s3, 8
    s_lshl_b32 s3, s3, 2
    s_mov_b32 s6, 0x71065432
    s_mov_b32 s7, 8
    s_lshr_b64 s[6:7], s[6:7], s3
    s_and_b32 s3, s6, 15
    s_lshl_b32 s3, s3, 7
    s_and_b32 s2, s2, 127
    s_add_u32 s2, s2, s3
    s_cmp_lt_u32 s2, 256
    s_cbranch_scc1 F_LN
    s_cmp_ge_u32 s2, 896
    s_cbranch_scc1 F_AUX
    s_load_dwordx8 s[8:15], s[0:1], 8
    s_load_dwordx4 s[16:19], s[0:1], 40
    s_load_dwordx2 s[28:29], s[0:1], 104
    s_sub_u32 s3, s2, 256
    v_and_b32 v1, 63, v0
    v_lshrrev_b32 v2, 6, v0
    s_nop 0
    v_readfirstlane_b32 s20, v2
    s_lshl_b32 s21, s3, 8
    v_lshl_add_u32 v3, v1, 2, s21
    s_lshr_b32 s21, s3, 1
    s_lshl_b32 s21, s21, 2
    s_memrealtime s[60:61]
    v_or_b32 v4, s3, v0
    v_cmp_eq_u32 vcc, 0, v4
    s_waitcnt lgkmcnt(0)
    s_setprio 3
    s_cbranch_vccnz F_NW
F_NWR:
    global_load_dword v10, v3, s[8:9]
    global_load_dword v11, v3, s[10:11]
    global_load_dword v12, v3, s[12:13]
    global_load_dword v13, v3, s[14:15]
    s_load_dword s58, s[16:17], s21
    s_load_dword s59, s[18:19], s21
    s_mov_b32 s24, s4
    s_mov_b32 s25, s5
    s_mov_b32 s26, 27335680
    s_mov_b32 s27, 0x00020000
    s_movk_i32 s30, 256
    s_mov_b32 s31, 0x00020000
    s_and_b32 s22, s20, 1
    s_lshr_b32 s23, s20, 1
    s_cmp_eq_u32 s23, 0
    s_mov_b32 s36, 0xbfb8aa3b
    s_cselect_b32 s36, s36, 0xc1b8aa3b
    s_mov_b32 s37, 0x3e22f983
    s_cselect_b32 s37, s37, 0xc022f983
    s_cselect_b32 s35, 0, 11152
    s_cselect_b64 s[40:41], 0, -1
    s_lshl_b32 s38, s22, 23
    s_add_u32 s36, s36, s38
    s_add_u32 s37, s37, s38
    s_mul_i32 s38, s22, 5440
    s_add_u32 s35, s35, s38
    s_mov_b32 s42, 0x3fb8aa00
    s_mov_b32 s43, 0x36a407db
    v_and_b32 v15, 15, v1
    v_lshrrev_b32 v16, 4, v1
    s_lshl_b32 s45, 8, s20
    s_cmp_eq_u32 s20, 0
    s_cselect_b32 s45, 0, s45
    v_lshlrev_b32 v22, s20, v15
    v_add_u32 v23, s45, v22
    v_min_u32 v23, 0x80, v23
    v_lshrrev_b32 v24, 1, v23
    v_add_u32 v24, 8, v24
    v_lshrrev_b32 v25, 2, v23
    v_add_u32 v25, 16, v25
    v_lshrrev_b32 v26, 3, v23
    v_add_u32 v26, 24, v26
    v_min3_u32 v24, v24, v25, v26
    v_min_u32 v24, v24, v23
    v_mul_u32_u24 v24, 272, v24
    v_lshl_add_u32 v24, v16, 4, v24
    v_add_u32 v72, 11152, v24
    v_lshrrev_b32 v24, 1, v22
    v_add_u32 v24, 8, v24
    v_lshrrev_b32 v25, 2, v22
    v_add_u32 v25, 16, v25
    v_lshrrev_b32 v26, 3, v22
    v_add_u32 v26, 24, v26
    v_min3_u32 v24, v24, v25, v26
    v_min_u32 v24, v24, v22
    v_mul_u32_u24 v24, 272, v24
    v_lshl_add_u32 v73, v16, 4, v24
    s_add_u32 s46, s20, 1
    s_lshl_b32 s46, s46, 8
    s_cmp_eq_u32 s20, 0
    s_cselect_b32 s46, 0, s46
    v_lshlrev_b32 v74, 1, v15
    v_lshl_add_u32 v74, v16, 7, v74
    v_add_u32 v74, s46, v74
    s_add_u32 s46, s20, 1
    s_and_b32 s46, s46, 2
    s_cselect_b32 s47, 0, -1
    v_lshlrev_b32 v17, 4, v0
    v_mov_b32 v24, 0
    v_mov_b32 v25, 0
    v_mov_b32 v26, 0
    v_mov_b32 v27, 0
    v_mov_b32 v22, 11632
    v_cmp_eq_u32 vcc, 30, v0
    s_nop 1
    v_cndmask_b32 v22, v17, v22, vcc
    v_cmp_gt_u32 vcc, 31, v0
    s_nop 0
    s_and_saveexec_b64 s[52:53], vcc
    ds_write_b128 v22, v[24:27] offset:22400
    s_mov_b64 exec, -1
    s_mul_i32 s44, s3, 205
    s_lshr_b32 s44, s44, 15
    s_lshl_b32 s44, s44, 5
    s_and_b32 s54, s3, 31
    s_add_u32 s44, s44, s54
    s_lshl_b32 s44, s44, 2
    s_add_u32 s44, s44, s20
    s_lshl_b32 s44, s44, 7
    s_add_u32 s44, s44, 27201536
    s_mov_b32 s55, 0
    s_lshr_b32 s56, s3, 3
    s_mul_i32 s56, s56, 4096
    s_and_b32 s57, s3, 7
    s_mul_i32 s57, s57, 327936
    s_add_u32 s56, s56, s57
    s_lshl_b32 s54, s20, 10
    s_add_u32 s57, s56, 2752512
    s_add_u32 s57, s57, s54
    s_add_u32 s54, s54, 35584
    s_and_b32 s21, s3, 1
    s_lshl_b32 s21, s21, 4
    s_waitcnt lgkmcnt(0)
    s_lshr_b32 s58, s58, s21
    s_lshr_b32 s59, s59, s21
    s_lshl_b32 s59, s59, 16
    v_mov_b32 v5, s58
    v_mov_b32 v14, s59
    v_lshlrev_b32 v20, 16, v5
    v_mul_f32 v21, s42, v20
    v_mul_f32 v20, s43, v20
    v_exp_f32 v21, v21
    s_nop 0
    v_fma_f32 v21, v21, v20, v21
    v_cvt_pk_bf16_f32 v21, v21, v21
    v_lshlrev_b32 v5, 16, v21
    s_waitcnt vmcnt(3)
    v_lshrrev_b32 v4, 16, v10
    v_lshlrev_b32 v20, 16, v10
    v_mul_f32 v21, s42, v20
    v_mul_f32 v20, s43, v20
    v_exp_f32 v21, v21
    s_nop 0
    v_fma_f32 v21, v21, v20, v21
    v_cvt_pk_bf16_f32 v21, v21, v21
    v_lshlrev_b32 v6, 16, v21
    v_mul_f32 v6, v6, v5
    v_mul_f32 v6, s36, v6
    v_lshlrev_b32 v20, 16, v4
    v_mul_f32 v21, s42, v20
    v_mul_f32 v20, s43, v20
    v_exp_f32 v21, v21
    s_nop 0
    v_fma_f32 v21, v21, v20, v21
    v_cvt_pk_bf16_f32 v21, v21, v21
    v_lshlrev_b32 v10, 16, v21
    v_mul_f32 v10, v10, v5
    v_mul_f32 v10, s36, v10
    s_waitcnt vmcnt(2)
    v_lshlrev_b32 v7, 16, v11
    v_and_b32 v11, 0xffff0000, v11
    v_mul_f32 v7, v7, v5
    v_mul_f32 v11, v11, v5
    s_waitcnt vmcnt(1)
    v_lshlrev_b32 v8, 16, v12
    v_and_b32 v12, 0xffff0000, v12
    v_mul_f32 v8, v8, v5
    v_mul_f32 v12, v12, v5
    s_waitcnt vmcnt(0)
    v_lshlrev_b32 v9, 16, v13
    v_and_b32 v13, 0xffff0000, v13
    v_mul_f32 v9, v9, v5
    v_mul_f32 v13, v13, v5
    v_mul_f32 v7, s37, v7
    v_mul_f32 v11, s37, v11
    v_add_f32 v20, |v8|, |v9|
    v_add_f32 v21, |v12|, |v13|
    v_add_f32 v20, v20, v21
    s_nop 1
    v_add_f32 v20, v20, v20 quad_perm:[1,0,3,2] row_mask:0xf bank_mask:0xf
    s_nop 1
    v_add_f32 v20, v20, v20 quad_perm:[2,3,0,1] row_mask:0xf bank_mask:0xf
    s_nop 1
    v_add_f32 v20, v20, v20 row_half_mirror row_mask:0xf bank_mask:0xf
    s_nop 1
    v_add_f32 v20, v20, v20 row_mirror row_mask:0xf bank_mask:0xf
    s_nop 1
    v_add_f32 v20, v20, v20 row_bcast:15 row_mask:0xa bank_mask:0xf
    s_nop 1
    v_add_f32 v20, v20, v20 row_bcast:31 row_mask:0xc bank_mask:0xf
    s_nop 0
    v_readlane_b32 s48, v20, 63
    s_nop 0
    s_lshr_b32 s48, s48, 23
    s_add_u32 s48, s48, 1
    s_max_u32 s48, s48, 20
    s_min_u32 s48, s48, 254
    s_sub_u32 s49, 269, s48
    s_lshl_b32 s49, s49, 23
    s_sub_u32 s50, s48, 14
    s_lshl_b32 s50, s50, 23
    v_mul_f32 v8, s49, v8
    v_mul_f32 v9, s49, v9
    v_cndmask_b32 v8, 1.0, v8, s[40:41]
    v_cndmask_b32 v9, 0, -v9, s[40:41]
    v_mul_f32 v12, s49, v12
    v_mul_f32 v13, s49, v13
    v_cndmask_b32 v12, 1.0, v12, s[40:41]
    v_cndmask_b32 v13, 0, -v13, s[40:41]
    v_exp_f32 v20, v6
    v_fract_f32 v21, v7
    v_cos_f32 v42, v21
    v_sin_f32 v43, v21
    v_mul_f32 v42, v42, v20
    v_mul_f32 v43, v43, v20
    s_cmp_lg_u32 s22, 0
    s_cbranch_scc1 F_SB0
    v_pk_mul_f32 v[22:23], v[42:43], v[42:43] op_sel:[1,1] op_sel_hi:[0,1] neg_lo:[0,1]
    v_pk_fma_f32 v[48:49], v[42:43], v[42:43], v[22:23] op_sel:[0,0,0] op_sel_hi:[1,0,1]
    v_mov_b64 v[44:45], v[42:43]
    v_mov_b64 v[46:47], v[42:43]
    v_mov_b64 v[40:41], v[8:9]
    s_branch F_SE0
F_SB0:
    v_pk_mul_f32 v[22:23], v[42:43], v[42:43] op_sel:[1,1] op_sel_hi:[0,1] neg_lo:[0,1]
    v_pk_fma_f32 v[44:45], v[42:43], v[42:43], v[22:23] op_sel:[0,0,0] op_sel_hi:[1,0,1]
    v_pk_mul_f32 v[22:23], v[44:45], v[44:45] op_sel:[1,1] op_sel_hi:[0,1] neg_lo:[0,1]
    v_pk_fma_f32 v[46:47], v[44:45], v[44:45], v[22:23] op_sel:[0,0,0] op_sel_hi:[1,0,1]
    v_pk_mul_f32 v[22:23], v[46:47], v[8:9] op_sel:[1,1] op_sel_hi:[0,1] neg_lo:[0,1]
    v_pk_fma_f32 v[24:25], v[46:47], v[8:9], v[22:23] op_sel:[0,0,0] op_sel_hi:[1,0,1]
    v_pk_mul_f32 v[28:29], v[46:47], v[46:47] op_sel:[1,1] op_sel_hi:[0,1] neg_lo:[0,1]
    v_pk_fma_f32 v[26:27], v[46:47], v[46:47], v[28:29] op_sel:[0,0,0] op_sel_hi:[1,0,1]
    v_mov_b64 v[48:49], v[46:47]
    v_pk_mul_f32 v[22:23], v[24:25], v[26:27] op_sel:[1,1] op_sel_hi:[0,1] neg_lo:[0,1]
    v_pk_fma_f32 v[40:41], v[24:25], v[26:27], v[22:23] op_sel:[0,0,0] op_sel_hi:[1,0,1]
F_SE0:
    s_mov_b32 m0, s35
    s_cmp_lg_u32 s22, 0
    s_cbranch_scc1 F_SKIP40
    v_cvt_pk_f16_f32 v32, v40, v41
    ds_write_addtid_b32 v32 offset:0
F_SKIP40:
    v_pk_mul_f32 v[36:37], v[40:41], v[42:43] op_sel:[1,1] op_sel_hi:[0,1] neg_lo:[0,1]
    v_pk_fma_f32 v[30:31], v[40:41], v[42:43], v[36:37] op_sel:[0,0,0] op_sel_hi:[1,0,1]
    v_cvt_pk_f16_f32 v33, v30, v31
    ds_write_addtid_b32 v33 offset:272
    v_pk_mul_f32 v[36:37], v[30:31], v[42:43] op_sel:[1,1] op_sel_hi:[0,1] neg_lo:[0,1]
    v_pk_fma_f32 v[40:41], v[30:31], v[42:43], v[36:37] op_sel:[0,0,0] op_sel_hi:[1,0,1]
    v_cvt_pk_f16_f32 v34, v40, v41
    ds_write_addtid_b32 v34 offset:544
    v_pk_mul_f32 v[36:37], v[40:41], v[42:43] op_sel:[1,1] op_sel_hi:[0,1] neg_lo:[0,1]
    v_pk_fma_f32 v[30:31], v[40:41], v[42:43], v[36:37] op_sel:[0,0,0] op_sel_hi:[1,0,1]
    v_cvt_pk_f16_f32 v35, v30, v31
    ds_write_addtid_b32 v35 offset:816
    v_pk_mul_f32 v[36:37], v[30:31], v[42:43] op_sel:[1,1] op_sel_hi:[0,1] neg_lo:[0,1]
    v_pk_fma_f32 v[40:41], v[30:31], v[42:43], v[36:37] op_sel:[0,0,0] op_sel_hi:[1,0,1]
    v_cvt_pk_f16_f32 v32, v40, v41
    ds_write_addtid_b32 v32 offset:1088
    v_pk_mul_f32 v[36:37], v[40:41], v[44:45] op_sel:[1,1] op_sel_hi:[0,1] neg_lo:[0,1]
    v_pk_fma_f32 v[30:31], v[40:41], v[44:45], v[36:37] op_sel:[0,0,0] op_sel_hi:[1,0,1]
    v_cvt_pk_f16_f32 v33, v30, v31
    ds_write_addtid_b32 v33 offset:1360
    v_pk_mul_f32 v[36:37], v[30:31], v[44:45] op_sel:[1,1] op_sel_hi:[0,1] neg_lo:[0,1]
    v_pk_fma_f32 v[40:41], v[30:31], v[44:45], v[36:37] op_sel:[0,0,0] op_sel_hi:[1,0,1]
    v_cvt_pk_f16_f32 v34, v40, v41
    ds_write_addtid_b32 v34 offset:1632
    v_pk_mul_f32 v[36:37], v[40:41], v[44:45] op_sel:[1,1] op_sel_hi:[0,1] neg_lo:[0,1]
    v_pk_fma_f32 v[30:31], v[40:41], v[44:45], v[36:37] op_sel:[0,0,0] op_sel_hi:[1,0,1]
    v_cvt_pk_f16_f32 v35, v30, v31
    ds_write_addtid_b32 v35 offset:1904
    v_pk_mul_f32 v[36:37], v[30:31], v[44:45] op_sel:[1,1] op_sel_hi:[0,1] neg_lo:[0,1]
    v_pk_fma_f32 v[40:41], v[30:31], v[44:45], v[36:37] op_sel:[0,0,0] op_sel_hi:[1,0,1]
    v_cvt_pk_f16_f32 v32, v40, v41
    ds_write_addtid_b32 v32 offset:2176
    v_pk_mul_f32 v[36:37], v[40:41], v[44:45] op_sel:[1,1] op_sel_hi:[0,1] neg_lo:[0,1]
    v_pk_fma_f32 v[30:31], v[40:41], v[44:45], v[36:37] op_sel:[0,0,0] op_sel_hi:[1,0,1]
    v_cvt_pk_f16_f32 v33, v30, v31
    ds_write_addtid_b32 v33 offset:2448
    v_pk_mul_f32 v[36:37], v[30:31], v[44:45] op_sel:[1,1] op_sel_hi:[0,1] neg_lo:[0,1]
    v_pk_fma_f32 v[40:41], v[30:31], v[44:45], v[36:37] op_sel:[0,0,0] op_sel_hi:[1,0,1]
    v_cvt_pk_f16_f32 v34, v40, v41
    ds_write_addtid_b32 v34 offset:2720
    v_pk_mul_f32 v[36:37], v[40:41], v[44:45] op_sel:[1,1] op_sel_hi:[0,1] neg_lo:[0,1]
    v_pk_fma_f32 v[30:31], v[40:41], v[44:45], v[36:37] op_sel:[0,0,0] op_sel_hi:[1,0,1]
    v_cvt_pk_f16_f32 v35, v30, v31
    ds_write_addtid_b32 v35 offset:2992
    v_pk_mul_f32 v[36:37], v[30:31], v[44:45] op_sel:[1,1] op_sel_hi:[0,1] neg_lo:[0,1]
    v_pk_fma_f32 v[40:41], v[30:31], v[44:45], v[36:37] op_sel:[0,0,0] op_sel_hi:[1,0,1]
    v_cvt_pk_f16_f32 v32, v40, v41
    ds_write_addtid_b32 v32 offset:3264
    v_pk_mul_f32 v[36:37], v[40:41], v[46:47] op_sel:[1,1] op_sel_hi:[0,1] neg_lo:[0,1]
    v_pk_fma_f32 v[30:31], v[40:41], v[46:47], v[36:37] op_sel:[0,0,0] op_sel_hi:[1,0,1]
    v_cvt_pk_f16_f32 v33, v30, v31
    ds_write_addtid_b32 v33 offset:3536
    v_pk_mul_f32 v[36:37], v[30:31], v[46:47] op_sel:[1,1] op_sel_hi:[0,1] neg_lo:[0,1]
    v_pk_fma_f32 v[40:41], v[30:31], v[46:47], v[36:37] op_sel:[0,0,0] op_sel_hi:[1,0,1]
    v_cvt_pk_f16_f32 v34, v40, v41
    ds_write_addtid_b32 v34 offset:3808
    v_pk_mul_f32 v[36:37], v[40:41], v[46:47] op_sel:[1,1] op_sel_hi:[0,1] neg_lo:[0,1]
    v_pk_fma_f32 v[30:31], v[40:41], v[46:47], v[36:37] op_sel:[0,0,0] op_sel_hi:[1,0,1]
    v_cvt_pk_f16_f32 v35, v30, v31
    ds_write_addtid_b32 v35 offset:4080
    v_pk_mul_f32 v[36:37], v[30:31], v[46:47] op_sel:[1,1] op_sel_hi:[0,1] neg_lo:[0,1]
    v_pk_fma_f32 v[40:41], v[30:31], v[46:47], v[36:37] op_sel:[0,0,0] op_sel_hi:[1,0,1]
    v_cvt_pk_f16_f32 v32, v40, v41
    ds_write_addtid_b32 v32 offset:4352
    v_pk_mul_f32 v[36:37], v[40:41], v[48:49] op_sel:[1,1] op_sel_hi:[0,1] neg_lo:[0,1]
    v_pk_fma_f32 v[30:31], v[40:41], v[48:49], v[36:37] op_sel:[0,0,0] op_sel_hi:[1,0,1]
    v_cvt_pk_f16_f32 v33, v30, v31
    ds_write_addtid_b32 v33 offset:4624
    v_pk_mul_f32 v[36:37], v[30:31], v[48:49] op_sel:[1,1] op_sel_hi:[0,1] neg_lo:[0,1]
    v_pk_fma_f32 v[40:41], v[30:31], v[48:49], v[36:37] op_sel:[0,0,0] op_sel_hi:[1,0,1]
    v_cvt_pk_f16_f32 v34, v40, v41
    ds_write_addtid_b32 v34 offset:4896
    v_pk_mul_f32 v[36:37], v[40:41], v[48:49] op_sel:[1,1] op_sel_hi:[0,1] neg_lo:[0,1]
    v_pk_fma_f32 v[30:31], v[40:41], v[48:49], v[36:37] op_sel:[0,0,0] op_sel_hi:[1,0,1]
    v_cvt_pk_f16_f32 v35, v30, v31
    ds_write_addtid_b32 v35 offset:5168
    v_pk_mul_f32 v[36:37], v[30:31], v[48:49] op_sel:[1,1] op_sel_hi:[0,1] neg_lo:[0,1]
    v_pk_fma_f32 v[40:41], v[30:31], v[48:49], v[36:37] op_sel:[0,0,0] op_sel_hi:[1,0,1]
    v_cvt_pk_f16_f32 v32, v40, v41
    ds_write_addtid_b32 v32 offset:5440
    v_exp_f32 v20, v10
    v_fract_f32 v21, v11
    v_cos_f32 v52, v21
    v_sin_f32 v53, v21
    v_mul_f32 v52, v52, v20
    v_mul_f32 v53, v53, v20
    s_cmp_lg_u32 s22, 0
    s_cbranch_scc1 F_SB1
    v_pk_mul_f32 v[22:23], v[52:53], v[52:53] op_sel:[1,1] op_sel_hi:[0,1] neg_lo:[0,1]
    v_pk_fma_f32 v[58:59], v[52:53], v[52:53], v[22:23] op_sel:[0,0,0] op_sel_hi:[1,0,1]
    v_mov_b64 v[54:55], v[52:53]
    v_mov_b64 v[56:57], v[52:53]
    v_mov_b64 v[50:51], v[12:13]
    s_branch F_SE1
F_SB1:
    v_pk_mul_f32 v[22:23], v[52:53], v[52:53] op_sel:[1,1] op_sel_hi:[0,1] neg_lo:[0,1]
    v_pk_fma_f32 v[54:55], v[52:53], v[52:53], v[22:23] op_sel:[0,0,0] op_sel_hi:[1,0,1]
    v_pk_mul_f32 v[22:23], v[54:55], v[54:55] op_sel:[1,1] op_sel_hi:[0,1] neg_lo:[0,1]
    v_pk_fma_f32 v[56:57], v[54:55], v[54:55], v[22:23] op_sel:[0,0,0] op_sel_hi:[1,0,1]
    v_pk_mul_f32 v[22:23], v[56:57], v[12:13] op_sel:[1,1] op_sel_hi:[0,1] neg_lo:[0,1]
    v_pk_fma_f32 v[24:25], v[56:57], v[12:13], v[22:23] op_sel:[0,0,0] op_sel_hi:[1,0,1]
    v_pk_mul_f32 v[28:29], v[56:57], v[56:57] op_sel:[1,1] op_sel_hi:[0,1] neg_lo:[0,1]
    v_pk_fma_f32 v[26:27], v[56:57], v[56:57], v[28:29] op_sel:[0,0,0] op_sel_hi:[1,0,1]
    v_mov_b64 v[58:59], v[56:57]
    v_pk_mul_f32 v[22:23], v[24:25], v[26:27] op_sel:[1,1] op_sel_hi:[0,1] neg_lo:[0,1]
    v_pk_fma_f32 v[50:51], v[24:25], v[26:27], v[22:23] op_sel:[0,0,0] op_sel_hi:[1,0,1]
F_SE1:
    v_lshlrev_b32 v8, 4, v1
    s_waitcnt lgkmcnt(0)
    s_barrier
    s_setprio 2
    ds_read_b128 v[80:83], v72 offset:0
    ds_read_b128 v[84:87], v73 offset:0
    ds_read_b128 v[88:91], v72 offset:64
    ds_read_b128 v[92:95], v73 offset:64
    ds_read_b128 v[96:99], v72 offset:128
    ds_read_b128 v[100:103], v73 offset:128
    ds_read_b128 v[104:107], v72 offset:192
    ds_read_b128 v[108:111], v73 offset:192
    v_lshlrev_b32 v19, 3, v15
    s_waitcnt lgkmcnt(0)
    s_barrier
    s_load_dwordx2 s[60:61], s[28:29], 0
    s_mov_b32 m0, s35
    s_cmp_lg_u32 s22, 0
    s_cbranch_scc1 F_SKIP50
    v_cvt_pk_f16_f32 v32, v50, v51
    ds_write_addtid_b32 v32 offset:0
F_SKIP50:
    v_pk_mul_f32 v[36:37], v[50:51], v[52:53] op_sel:[1,1] op_sel_hi:[0,1] neg_lo:[0,1]
    v_pk_fma_f32 v[30:31], v[50:51], v[52:53], v[36:37] op_sel:[0,0,0] op_sel_hi:[1,0,1]
    v_cvt_pk_f16_f32 v33, v30, v31
    ds_write_addtid_b32 v33 offset:272
    v_pk_mul_f32 v[36:37], v[30:31], v[52:53] op_sel:[1,1] op_sel_hi:[0,1] neg_lo:[0,1]
    v_pk_fma_f32 v[50:51], v[30:31], v[52:53], v[36:37] op_sel:[0,0,0] op_sel_hi:[1,0,1]
    v_cvt_pk_f16_f32 v34, v50, v51
    ds_write_addtid_b32 v34 offset:544
    v_mfma_f32_16x16x32_f16 v[76:79], v[80:83], v[84:87], 0
    v_pk_mul_f32 v[36:37], v[50:51], v[52:53] op_sel:[1,1] op_sel_hi:[0,1] neg_lo:[0,1]
    v_pk_fma_f32 v[30:31], v[50:51], v[52:53], v[36:37] op_sel:[0,0,0] op_sel_hi:[1,0,1]
    v_cvt_pk_f16_f32 v35, v30, v31
    ds_write_addtid_b32 v35 offset:816
    v_pk_mul_f32 v[36:37], v[30:31], v[52:53] op_sel:[1,1] op_sel_hi:[0,1] neg_lo:[0,1]
    v_pk_fma_f32 v[50:51], v[30:31], v[52:53], v[36:37] op_sel:[0,0,0] op_sel_hi:[1,0,1]
    v_cvt_pk_f16_f32 v32, v50, v51
    ds_write_addtid_b32 v32 offset:1088
    v_pk_mul_f32 v[36:37], v[50:51], v[54:55] op_sel:[1,1] op_sel_hi:[0,1] neg_lo:[0,1]
    v_pk_fma_f32 v[30:31], v[50:51], v[54:55], v[36:37] op_sel:[0,0,0] op_sel_hi:[1,0,1]
    v_cvt_pk_f16_f32 v33, v30, v31
    ds_write_addtid_b32 v33 offset:1360
    v_mfma_f32_16x16x32_f16 v[76:79], v[88:91], v[92:95], v[76:79]
    v_pk_mul_f32 v[36:37], v[30:31], v[54:55] op_sel:[1,1] op_sel_hi:[0,1] neg_lo:[0,1]
    v_pk_fma_f32 v[50:51], v[30:31], v[54:55], v[36:37] op_sel:[0,0,0] op_sel_hi:[1,0,1]
    v_cvt_pk_f16_f32 v34, v50, v51
    ds_write_addtid_b32 v34 offset:1632
    v_pk_mul_f32 v[36:37], v[50:51], v[54:55] op_sel:[1,1] op_sel_hi:[0,1] neg_lo:[0,1]
    v_pk_fma_f32 v[30:31], v[50:51], v[54:55], v[36:37] op_sel:[0,0,0] op_sel_hi:[1,0,1]
    v_cvt_pk_f16_f32 v35, v30, v31
    ds_write_addtid_b32 v35 offset:1904
    v_pk_mul_f32 v[36:37], v[30:31], v[54:55] op_sel:[1,1] op_sel_hi:[0,1] neg_lo:[0,1]
    v_pk_fma_f32 v[50:51], v[30:31], v[54:55], v[36:37] op_sel:[0,0,0] op_sel_hi:[1,0,1]
    v_cvt_pk_f16_f32 v32, v50, v51
    ds_write_addtid_b32 v32 offset:2176
    v_mfma_f32_16x16x32_f16 v[76:79], v[96:99], v[100:103], v[76:79]
    v_pk_mul_f32 v[36:37], v[50:51], v[54:55] op_sel:[1,1] op_sel_hi:[0,1] neg_lo:[0,1]
    v_pk_fma_f32 v[30:31], v[50:51], v[54:55], v[36:37] op_sel:[0,0,0] op_sel_hi:[1,0,1]
    v_cvt_pk_f16_f32 v33, v30, v31
    ds_write_addtid_b32 v33 offset:2448
    v_pk_mul_f32 v[36:37], v[30:31], v[54:55] op_sel:[1,1] op_sel_hi:[0,1] neg_lo:[0,1]
    v_pk_fma_f32 v[50:51], v[30:31], v[54:55], v[36:37] op_sel:[0,0,0] op_sel_hi:[1,0,1]
    v_cvt_pk_f16_f32 v34, v50, v51
    ds_write_addtid_b32 v34 offset:2720
    v_pk_mul_f32 v[36:37], v[50:51], v[54:55] op_sel:[1,1] op_sel_hi:[0,1] neg_lo:[0,1]
    v_pk_fma_f32 v[30:31], v[50:51], v[54:55], v[36:37] op_sel:[0,0,0] op_sel_hi:[1,0,1]
    v_cvt_pk_f16_f32 v35, v30, v31
    ds_write_addtid_b32 v35 offset:2992
    v_mfma_f32_16x16x32_f16 v[76:79], v[104:107], v[108:111], v[76:79]
    v_pk_mul_f32 v[36:37], v[30:31], v[54:55] op_sel:[1,1] op_sel_hi:[0,1] neg_lo:[0,1]
    v_pk_fma_f32 v[50:51], v[30:31], v[54:55], v[36:37] op_sel:[0,0,0] op_sel_hi:[1,0,1]
    v_cvt_pk_f16_f32 v32, v50, v51
    ds_write_addtid_b32 v32 offset:3264
    v_pk_mul_f32 v[36:37], v[50:51], v[56:57] op_sel:[1,1] op_sel_hi:[0,1] neg_lo:[0,1]
    v_pk_fma_f32 v[30:31], v[50:51], v[56:57], v[36:37] op_sel:[0,0,0] op_sel_hi:[1,0,1]
    v_cvt_pk_f16_f32 v33, v30, v31
    ds_write_addtid_b32 v33 offset:3536
    v_pk_mul_f32 v[36:37], v[30:31], v[56:57] op_sel:[1,1] op_sel_hi:[0,1] neg_lo:[0,1]
    v_pk_fma_f32 v[50:51], v[30:31], v[56:57], v[36:37] op_sel:[0,0,0] op_sel_hi:[1,0,1]
    v_cvt_pk_f16_f32 v34, v50, v51
    ds_write_addtid_b32 v34 offset:3808
    v_pk_mul_f32 v[36:37], v[50:51], v[56:57] op_sel:[1,1] op_sel_hi:[0,1] neg_lo:[0,1]
    v_pk_fma_f32 v[30:31], v[50:51], v[56:57], v[36:37] op_sel:[0,0,0] op_sel_hi:[1,0,1]
    v_cvt_pk_f16_f32 v35, v30, v31
    ds_write_addtid_b32 v35 offset:4080
    v_pk_mul_f32 v[36:37], v[30:31], v[56:57] op_sel:[1,1] op_sel_hi:[0,1] neg_lo:[0,1]
    v_pk_fma_f32 v[50:51], v[30:31], v[56:57], v[36:37] op_sel:[0,0,0] op_sel_hi:[1,0,1]
    v_cvt_pk_f16_f32 v32, v50, v51
    ds_write_addtid_b32 v32 offset:4352
    v_pk_mul_f32 v[36:37], v[50:51], v[58:59] op_sel:[1,1] op_sel_hi:[0,1] neg_lo:[0,1]
    v_pk_fma_f32 v[30:31], v[50:51], v[58:59], v[36:37] op_sel:[0,0,0] op_sel_hi:[1,0,1]
    v_cvt_pk_f16_f32 v33, v30, v31
    ds_write_addtid_b32 v33 offset:4624
    v_pk_mul_f32 v[36:37], v[30:31], v[58:59] op_sel:[1,1] op_sel_hi:[0,1] neg_lo:[0,1]
    v_pk_fma_f32 v[50:51], v[30:31], v[58:59], v[36:37] op_sel:[0,0,0] op_sel_hi:[1,0,1]
    v_cvt_pk_f16_f32 v34, v50, v51
    ds_write_addtid_b32 v34 offset:4896
    v_pk_mul_f32 v[36:37], v[50:51], v[58:59] op_sel:[1,1] op_sel_hi:[0,1] neg_lo:[0,1]
    v_pk_fma_f32 v[30:31], v[50:51], v[58:59], v[36:37] op_sel:[0,0,0] op_sel_hi:[1,0,1]
    v_cvt_pk_f16_f32 v35, v30, v31
    ds_write_addtid_b32 v35 offset:5168
    v_pk_mul_f32 v[36:37], v[30:31], v[58:59] op_sel:[1,1] op_sel_hi:[0,1] neg_lo:[0,1]
    v_pk_fma_f32 v[50:51], v[30:31], v[58:59], v[36:37] op_sel:[0,0,0] op_sel_hi:[1,0,1]
    v_cvt_pk_f16_f32 v32, v50, v51
    ds_write_addtid_b32 v32 offset:5440
    s_waitcnt lgkmcnt(0)
    s_barrier
    s_setprio 1
    s_cmp_lg_u32 s60, 0
    s_cbranch_scc1 F_NC_OK
    s_load_dwordx2 s[60:61], s[28:29], 128
    s_mov_b32 s62, 0x20000
    s_waitcnt lgkmcnt(0)
F_NC:
    s_cmp_lg_u32 s60, 0
    s_cbranch_scc1 F_NC_OK
    v_mov_b32 v2, 0
    buffer_load_dwordx2 v[2:3], v2, s[28:31], 0 offen sc1
    s_waitcnt vmcnt(0)
    v_readfirstlane_b32 s60, v2
    v_readfirstlane_b32 s61, v3
    s_sub_u32 s62, s62, 1
    s_cbranch_scc0 F_NC
F_NC_OK:
    ds_read_b128 v[80:83], v72 offset:0
    ds_read_b128 v[84:87], v73 offset:0
    ds_read_b128 v[88:91], v72 offset:64
    ds_read_b128 v[92:95], v73 offset:64
    ds_read_b128 v[96:99], v72 offset:128
    ds_read_b128 v[100:103], v73 offset:128
    ds_read_b128 v[104:107], v72 offset:192
    ds_read_b128 v[108:111], v73 offset:192
    v_and_b32 v18, 3, v1
    s_mov_b32 s64, 0x85ebca6b
    s_mov_b32 s65, 0xc2b2ae35
    v_mul_u32_u24 v6, 0x9e3779, v18
    v_add_u32 v6, s60, v6
    v_lshrrev_b32 v7, 16, v6
    v_xor_b32 v6, v6, v7
    v_mul_lo_u32 v6, v6, s64
    v_lshrrev_b32 v7, 13, v6
    v_xor_b32 v6, v6, v7
    v_mul_lo_u32 v6, v6, s65
    v_lshrrev_b32 v7, 16, v6
    v_xor_b32 v6, v6, v7
    v_lshrrev_b32 v7, 3, v6
    v_and_b32 v7, 458759, v7
    v_lshrrev_b32 v12, 6, v6
    v_and_b32 v12, 458759, v12
    v_lshrrev_b32 v13, 9, v6
    v_and_b32 v13, 458759, v13
    v_and_b32 v6, 458759, v6
    v_lshlrev_b32 v20, 3, v0
    v_sub_u32 v20, 2047, v20
    v_cvt_f32_u32 v22, v20
    v_add_f32 v23, -1.0, v22
    s_cmp_eq_u32 s20, 3
    s_cbranch_scc1 F_GA3
    v_cvt_pk_bf16_f32 v24, v22, v23
    v_pk_add_f32 v[22:23], v[22:23], -2.0 op_sel_hi:[1,0]
    v_lshlrev_b32_sdwa v40, 1, v24 dst_sel:DWORD dst_unused:UNUSED_PAD src0_sel:DWORD src1_sel:WORD_0
    v_lshlrev_b32_sdwa v41, 1, v24 dst_sel:DWORD dst_unused:UNUSED_PAD src0_sel:DWORD src1_sel:WORD_1
    v_cvt_pk_bf16_f32 v24, v22, v23
    v_pk_add_f32 v[22:23], v[22:23], -2.0 op_sel_hi:[1,0]
    v_lshlrev_b32_sdwa v42, 1, v24 dst_sel:DWORD dst_unused:UNUSED_PAD src0_sel:DWORD src1_sel:WORD_0
    v_lshlrev_b32_sdwa v43, 1, v24 dst_sel:DWORD dst_unused:UNUSED_PAD src0_sel:DWORD src1_sel:WORD_1
    v_cvt_pk_bf16_f32 v24, v22, v23
    v_pk_add_f32 v[22:23], v[22:23], -2.0 op_sel_hi:[1,0]
    v_lshlrev_b32_sdwa v44, 1, v24 dst_sel:DWORD dst_unused:UNUSED_PAD src0_sel:DWORD src1_sel:WORD_0
    v_lshlrev_b32_sdwa v45, 1, v24 dst_sel:DWORD dst_unused:UNUSED_PAD src0_sel:DWORD src1_sel:WORD_1
    v_cvt_pk_bf16_f32 v24, v22, v23
    v_pk_add_f32 v[22:23], v[22:23], -2.0 op_sel_hi:[1,0]
    v_lshlrev_b32_sdwa v46, 1, v24 dst_sel:DWORD dst_unused:UNUSED_PAD src0_sel:DWORD src1_sel:WORD_0
    v_lshlrev_b32_sdwa v47, 1, v24 dst_sel:DWORD dst_unused:UNUSED_PAD src0_sel:DWORD src1_sel:WORD_1
    v_cvt_pk_bf16_f32 v24, v22, v23
    v_pk_add_f32 v[22:23], v[22:23], -2.0 op_sel_hi:[1,0]
    v_lshlrev_b32_sdwa v48, 1, v24 dst_sel:DWORD dst_unused:UNUSED_PAD src0_sel:DWORD src1_sel:WORD_0
    v_lshlrev_b32_sdwa v49, 1, v24 dst_sel:DWORD dst_unused:UNUSED_PAD src0_sel:DWORD src1_sel:WORD_1
    v_cvt_pk_bf16_f32 v24, v22, v23
    v_lshlrev_b32_sdwa v50, 1, v24 dst_sel:DWORD dst_unused:UNUSED_PAD src0_sel:DWORD src1_sel:WORD_0
    s_branch F_GAE
F_GA3:
    v_mul_u32_u24 v21, 0x10001, v20
    v_add_u32 v21, 1115636352, v21
    s_mov_b32 s58, 0x43004300
    s_mov_b32 s59, 0xfffefffe
    v_cvt_pk_bf16_f32 v24, v22, v23
    v_pk_min_i16 v25, v21, s58
    v_pk_max_i16 v24, v24, v25
    v_pk_add_u16 v21, v21, s59
    v_pk_add_f32 v[22:23], v[22:23], -2.0 op_sel_hi:[1,0]
    v_lshlrev_b32_sdwa v40, 1, v24 dst_sel:DWORD dst_unused:UNUSED_PAD src0_sel:DWORD src1_sel:WORD_0
    v_lshlrev_b32_sdwa v41, 1, v24 dst_sel:DWORD dst_unused:UNUSED_PAD src0_sel:DWORD src1_sel:WORD_1
    v_cvt_pk_bf16_f32 v24, v22, v23
    v_pk_min_i16 v25, v21, s58
    v_pk_max_i16 v24, v24, v25
    v_pk_add_u16 v21, v21, s59
    v_pk_add_f32 v[22:23], v[22:23], -2.0 op_sel_hi:[1,0]
    v_lshlrev_b32_sdwa v42, 1, v24 dst_sel:DWORD dst_unused:UNUSED_PAD src0_sel:DWORD src1_sel:WORD_0
    v_lshlrev_b32_sdwa v43, 1, v24 dst_sel:DWORD dst_unused:UNUSED_PAD src0_sel:DWORD src1_sel:WORD_1
    v_cvt_pk_bf16_f32 v24, v22, v23
    v_pk_min_i16 v25, v21, s58
    v_pk_max_i16 v24, v24, v25
    v_pk_add_u16 v21, v21, s59
    v_pk_add_f32 v[22:23], v[22:23], -2.0 op_sel_hi:[1,0]
    v_lshlrev_b32_sdwa v44, 1, v24 dst_sel:DWORD dst_unused:UNUSED_PAD src0_sel:DWORD src1_sel:WORD_0
    v_lshlrev_b32_sdwa v45, 1, v24 dst_sel:DWORD dst_unused:UNUSED_PAD src0_sel:DWORD src1_sel:WORD_1
    v_cvt_pk_bf16_f32 v24, v22, v23
    v_pk_min_i16 v25, v21, s58
    v_pk_max_i16 v24, v24, v25
    v_pk_add_u16 v21, v21, s59
    v_pk_add_f32 v[22:23], v[22:23], -2.0 op_sel_hi:[1,0]
    v_lshlrev_b32_sdwa v46, 1, v24 dst_sel:DWORD dst_unused:UNUSED_PAD src0_sel:DWORD src1_sel:WORD_0
    v_lshlrev_b32_sdwa v47, 1, v24 dst_sel:DWORD dst_unused:UNUSED_PAD src0_sel:DWORD src1_sel:WORD_1
    v_cvt_pk_bf16_f32 v24, v22, v23
    v_pk_min_i16 v25, v21, s58
    v_pk_max_i16 v24, v24, v25
    v_pk_add_u16 v21, v21, s59
    v_pk_add_f32 v[22:23], v[22:23], -2.0 op_sel_hi:[1,0]
    v_lshlrev_b32_sdwa v48, 1, v24 dst_sel:DWORD dst_unused:UNUSED_PAD src0_sel:DWORD src1_sel:WORD_0
    v_lshlrev_b32_sdwa v49, 1, v24 dst_sel:DWORD dst_unused:UNUSED_PAD src0_sel:DWORD src1_sel:WORD_1
    v_cvt_pk_bf16_f32 v24, v22, v23
    v_pk_min_i16 v25, v21, s58
    v_pk_max_i16 v24, v24, v25
    v_lshlrev_b32_sdwa v50, 1, v24 dst_sel:DWORD dst_unused:UNUSED_PAD src0_sel:DWORD src1_sel:WORD_0
F_GAE:
    s_waitcnt lgkmcnt(6)
    v_mfma_f32_16x16x32_f16 v[76:79], v[80:83], v[84:87], v[76:79]
    s_waitcnt lgkmcnt(4)
    v_mfma_f32_16x16x32_f16 v[76:79], v[88:91], v[92:95], v[76:79]
    s_waitcnt lgkmcnt(2)
    v_mfma_f32_16x16x32_f16 v[76:79], v[96:99], v[100:103], v[76:79]
    s_waitcnt lgkmcnt(0)
    v_mfma_f32_16x16x32_f16 v[76:79], v[104:107], v[108:111], v[76:79]
    v_sub_u32 v20, 15, v15
    v_and_b32 v21, 3, v20
    v_mul_u32_u24 v10, 4160, v21
    v_lshrrev_b32 v20, 2, v20
    v_lshl_add_u32 v10, v20, 3, v10
    v_lshl_add_u32 v10, v16, 4, v10
    s_lshl_b32 s21, s20, 7
    s_sub_u32 s21, 384, s21
    v_add_u32 v10, s21, v10
    v_lshlrev_b32 v11, 5, v15
    v_lshl_add_u32 v9, v16, 3, v11
    v_lshl_add_u32 v11, v16, 4, v11
    v_add_u32 v11, s21, v11
    s_lshl_b32 s21, s20, 10
    v_add_u32 v9, s21, v9
    s_mov_b32 exec_hi, s47
    v_cvt_f16_f32 v20, v76
    ds_write_b16 v74, v20 offset:34048
    v_cvt_f16_f32 v21, v77
    ds_write_b16 v74, v21 offset:34080
    v_cvt_f16_f32 v22, v78
    ds_write_b16 v74, v22 offset:34112
    v_cvt_f16_f32 v23, v79
    ds_write_b16 v74, v23 offset:34144
    s_mov_b32 exec_hi, -1
    v_lshrrev_b32 v20, 1, v0
    v_mul_u32_u24 v20, 4128, v20
    v_add_u32 v20, v20, v17
    v_mov_b32 v24, 0
    v_mov_b32 v25, 0
    v_mov_b32 v26, 0
    v_mov_b32 v27, 0
    v_cmp_gt_u32 vcc, 8, v0
    s_waitcnt lgkmcnt(0)
    s_barrier
    s_and_saveexec_b64 s[52:53], vcc
    ds_write_b128 v20, v[24:27] offset:4096
    s_mov_b64 exec, -1
    ds_read_u16 v52, v40
    ds_read_u16 v53, v41
    ds_read_u16 v54, v42
    ds_read_u16 v55, v43
    ds_read_u16 v56, v44
    ds_read_u16 v57, v45
    ds_read_u16 v58, v46
    ds_read_u16 v59, v47
    ds_read_u16 v60, v48
    ds_read_u16 v61, v49
    ds_read_u16 v62, v50
    s_waitcnt lgkmcnt(3)
    v_lshl_or_b32 v64, v53, 16, v52
    v_lshl_or_b32 v65, v55, 16, v54
    v_lshl_or_b32 v66, v57, 16, v56
    v_lshl_or_b32 v67, v59, 16, v58
    ds_write_b128 v17, v[64:67] offset:0
    s_waitcnt lgkmcnt(3)
    v_lshl_or_b32 v68, v54, 16, v53
    v_lshl_or_b32 v69, v56, 16, v55
    v_lshl_or_b32 v70, v58, 16, v57
    v_lshl_or_b32 v71, v60, 16, v59
    ds_write_b128 v17, v[68:71] offset:4160
    s_waitcnt lgkmcnt(3)
    v_lshl_or_b32 v72, v55, 16, v54
    v_lshl_or_b32 v73, v57, 16, v56
    v_lshl_or_b32 v74, v59, 16, v58
    v_lshl_or_b32 v75, v61, 16, v60
    ds_write_b128 v17, v[72:75] offset:8320
    s_waitcnt lgkmcnt(3)
    v_lshl_or_b32 v76, v56, 16, v55
    v_lshl_or_b32 v77, v58, 16, v57
    v_lshl_or_b32 v78, v60, 16, v59
    v_lshl_or_b32 v79, v62, 16, v61
    ds_write_b128 v17, v[76:79] offset:12480
    s_waitcnt lgkmcnt(0)
    s_barrier
    ds_read_b64 v[64:65], v10 offset:3648
    ds_read_b64 v[66:67], v10 offset:3656
    ds_read_b64 v[96:97], v10 offset:3584
    ds_read_b64 v[98:99], v10 offset:3592
    ds_read_b64 v[68:69], v10 offset:3136
    ds_read_b64 v[70:71], v10 offset:3144
    ds_read_b64 v[100:101], v10 offset:3072
    ds_read_b64 v[102:103], v10 offset:3080
    ds_read_b64 v[72:73], v10 offset:2624
    ds_read_b64 v[74:75], v10 offset:2632
    ds_read_b64 v[104:105], v10 offset:2560
    ds_read_b64 v[106:107], v10 offset:2568
    ds_read_b64 v[76:77], v10 offset:2112
    ds_read_b64 v[78:79], v10 offset:2120
    ds_read_b64 v[108:109], v10 offset:2048
    ds_read_b64 v[110:111], v10 offset:2056
    buffer_load_dwordx4 v[2:5], v17, s[24:27], s56 offen sc1
    ds_read_b64 v[80:81], v10 offset:1600
    ds_read_b64 v[82:83], v10 offset:1608
    ds_read_b64 v[112:113], v10 offset:1536
    ds_read_b64 v[114:115], v10 offset:1544
    ds_read_b64 v[84:85], v10 offset:1088
    ds_read_b64 v[86:87], v10 offset:1096
    ds_read_b64 v[116:117], v10 offset:1024
    ds_read_b64 v[118:119], v10 offset:1032
    ds_read_b64 v[88:89], v10 offset:576
    ds_read_b64 v[90:91], v10 offset:584
    ds_read_b64 v[120:121], v10 offset:512
    ds_read_b64 v[122:123], v10 offset:520
    ds_read_b64 v[92:93], v10 offset:64
    ds_read_b64 v[94:95], v10 offset:72
    ds_read_b64 v[124:125], v10 offset:0
    ds_read_b64 v[126:127], v10 offset:8
    s_mov_b32 s49, 0x20000
F_PL:
    s_cmp_lt_u32 s55, 1
    s_cbranch_scc1 F_PP9
F_PL_D:
    s_setprio 0
    s_barrier
    ds_read_b128 v[16:19], v11 offset:22464
    ds_read_b128 v[20:23], v11 offset:25984
    ds_read_b128 v[24:27], v11 offset:22976
    ds_read_b128 v[28:31], v11 offset:25472
    s_waitcnt lgkmcnt(3)
    v_mfma_f32_16x16x32_f16 v[60:63], v[92:95], v[16:19], 0
    v_mfma_f32_16x16x32_f16 v[56:59], v[88:91], v[16:19], 0
    v_mfma_f32_16x16x32_f16 v[52:55], v[84:87], v[16:19], 0
    v_mfma_f32_16x16x32_f16 v[48:51], v[80:83], v[16:19], 0
    v_mfma_f32_16x16x32_f16 v[44:47], v[76:79], v[16:19], 0
    v_mfma_f32_16x16x32_f16 v[40:43], v[72:75], v[16:19], 0
    v_mfma_f32_16x16x32_f16 v[36:39], v[68:71], v[16:19], 0
    v_mfma_f32_16x16x32_f16 v[32:35], v[64:67], v[16:19], 0
    ds_read_b128 v[16:19], v11 offset:23488
    s_cmp_ge_u32 s55, 2
    s_cbranch_scc1 F_PR10
    s_getreg_b32 s63, hwreg(HW_REG_IB_STS, 0, 4)
    s_cmp_eq_u32 s63, 0
    s_cbranch_scc1 F_PP10
F_PR10:
    s_waitcnt lgkmcnt(3)
    v_mfma_f32_16x16x32_f16 v[60:63], v[96:99], v[20:23], v[60:63]
    ds_read_b128 v[20:23], v11 offset:24960
    s_waitcnt lgkmcnt(3)
    v_mfma_f32_16x16x32_f16 v[60:63], v[88:91], v[24:27], v[60:63]
    v_mfma_f32_16x16x32_f16 v[56:59], v[84:87], v[24:27], v[56:59]
    v_mfma_f32_16x16x32_f16 v[52:55], v[80:83], v[24:27], v[52:55]
    v_mfma_f32_16x16x32_f16 v[48:51], v[76:79], v[24:27], v[48:51]
    v_mfma_f32_16x16x32_f16 v[44:47], v[72:75], v[24:27], v[44:47]
    v_mfma_f32_16x16x32_f16 v[40:43], v[68:71], v[24:27], v[40:43]
    v_mfma_f32_16x16x32_f16 v[36:39], v[64:67], v[24:27], v[36:39]
    ds_read_b128 v[24:27], v11 offset:24000
    s_waitcnt lgkmcnt(3)
    v_mfma_f32_16x16x32_f16 v[60:63], v[100:103], v[28:31], v[60:63]
    v_mfma_f32_16x16x32_f16 v[56:59], v[96:99], v[28:31], v[56:59]
    ds_read_b128 v[28:31], v11 offset:24448
    s_cmp_ge_u32 s55, 2
    s_cbranch_scc1 F_PR11
    s_getreg_b32 s63, hwreg(HW_REG_IB_STS, 0, 4)
    s_cmp_eq_u32 s63, 0
    s_cbranch_scc1 F_PP11
F_PR11:
    s_waitcnt lgkmcnt(3)
    v_mfma_f32_16x16x32_f16 v[60:63], v[84:87], v[16:19], v[60:63]
    v_mfma_f32_16x16x32_f16 v[56:59], v[80:83], v[16:19], v[56:59]
    v_mfma_f32_16x16x32_f16 v[52:55], v[76:79], v[16:19], v[52:55]
    v_mfma_f32_16x16x32_f16 v[48:51], v[72:75], v[16:19], v[48:51]
    v_mfma_f32_16x16x32_f16 v[44:47], v[68:71], v[16:19], v[44:47]
    v_mfma_f32_16x16x32_f16 v[40:43], v[64:67], v[16:19], v[40:43]
    ds_read_b128 v[16:19], v11 offset:24512
    s_waitcnt lgkmcnt(3)
    v_mfma_f32_16x16x32_f16 v[60:63], v[104:107], v[20:23], v[60:63]
    v_mfma_f32_16x16x32_f16 v[56:59], v[100:103], v[20:23], v[56:59]
    v_mfma_f32_16x16x32_f16 v[52:55], v[96:99], v[20:23], v[52:55]
    ds_read_b128 v[20:23], v11 offset:23936
    s_waitcnt lgkmcnt(3)
    v_mfma_f32_16x16x32_f16 v[60:63], v[80:83], v[24:27], v[60:63]
    v_mfma_f32_16x16x32_f16 v[56:59], v[76:79], v[24:27], v[56:59]
    v_mfma_f32_16x16x32_f16 v[52:55], v[72:75], v[24:27], v[52:55]
    v_mfma_f32_16x16x32_f16 v[48:51], v[68:71], v[24:27], v[48:51]
    v_mfma_f32_16x16x32_f16 v[44:47], v[64:67], v[24:27], v[44:47]
    ds_read_b128 v[24:27], v11 offset:25024
    s_cmp_ge_u32 s55, 2
    s_cbranch_scc1 F_PR12
    s_getreg_b32 s63, hwreg(HW_REG_IB_STS, 0, 4)
    s_cmp_eq_u32 s63, 0
    s_cbranch_scc1 F_PP12
F_PR12:
    s_waitcnt lgkmcnt(3)
    v_mfma_f32_16x16x32_f16 v[60:63], v[108:111], v[28:31], v[60:63]
    v_mfma_f32_16x16x32_f16 v[56:59], v[104:107], v[28:31], v[56:59]
    v_mfma_f32_16x16x32_f16 v[52:55], v[100:103], v[28:31], v[52:55]
    v_mfma_f32_16x16x32_f16 v[48:51], v[96:99], v[28:31], v[48:51]
    ds_read_b128 v[28:31], v11 offset:23424
    s_waitcnt lgkmcnt(3)
    v_mfma_f32_16x16x32_f16 v[60:63], v[76:79], v[16:19], v[60:63]
    v_mfma_f32_16x16x32_f16 v[56:59], v[72:75], v[16:19], v[56:59]
    v_mfma_f32_16x16x32_f16 v[52:55], v[68:71], v[16:19], v[52:55]
    v_mfma_f32_16x16x32_f16 v[48:51], v[64:67], v[16:19], v[48:51]
    ds_read_b128 v[16:19], v11 offset:25536
    s_waitcnt lgkmcnt(3)
    v_mfma_f32_16x16x32_f16 v[60:63], v[112:115], v[20:23], v[60:63]
    v_mfma_f32_16x16x32_f16 v[56:59], v[108:111], v[20:23], v[56:59]
    v_mfma_f32_16x16x32_f16 v[52:55], v[104:107], v[20:23], v[52:55]
    v_mfma_f32_16x16x32_f16 v[48:51], v[100:103], v[20:23], v[48:51]
    v_mfma_f32_16x16x32_f16 v[44:47], v[96:99], v[20:23], v[44:47]
    ds_read_b128 v[20:23], v11 offset:22912
    s_cmp_ge_u32 s55, 2
    s_cbranch_scc1 F_PR13
    s_getreg_b32 s63, hwreg(HW_REG_IB_STS, 0, 4)
    s_cmp_eq_u32 s63, 0
    s_cbranch_scc1 F_PP13
F_PR13:
    s_waitcnt lgkmcnt(3)
    v_mfma_f32_16x16x32_f16 v[60:63], v[72:75], v[24:27], v[60:63]
    v_mfma_f32_16x16x32_f16 v[56:59], v[68:71], v[24:27], v[56:59]
    v_mfma_f32_16x16x32_f16 v[52:55], v[64:67], v[24:27], v[52:55]
    ds_read_b128 v[24:27], v11 offset:26048
    s_waitcnt lgkmcnt(3)
    v_mfma_f32_16x16x32_f16 v[60:63], v[116:119], v[28:31], v[60:63]
    v_mfma_f32_16x16x32_f16 v[56:59], v[112:115], v[28:31], v[56:59]
    v_mfma_f32_16x16x32_f16 v[52:55], v[108:111], v[28:31], v[52:55]
    v_mfma_f32_16x16x32_f16 v[48:51], v[104:107], v[28:31], v[48:51]
    v_mfma_f32_16x16x32_f16 v[44:47], v[100:103], v[28:31], v[44:47]
    v_mfma_f32_16x16x32_f16 v[40:43], v[96:99], v[28:31], v[40:43]
    ds_read_b128 v[28:31], v11 offset:22400
    s_waitcnt lgkmcnt(3)
    v_mfma_f32_16x16x32_f16 v[60:63], v[68:71], v[16:19], v[60:63]
    v_mfma_f32_16x16x32_f16 v[56:59], v[64:67], v[16:19], v[56:59]
    s_cmp_ge_u32 s55, 2
    s_cbranch_scc1 F_PR14
    s_getreg_b32 s63, hwreg(HW_REG_IB_STS, 0, 4)
    s_cmp_eq_u32 s63, 0
    s_cbranch_scc1 F_PP14
F_PR14:
    s_waitcnt lgkmcnt(2)
    v_mfma_f32_16x16x32_f16 v[60:63], v[120:123], v[20:23], v[60:63]
    v_mfma_f32_16x16x32_f16 v[56:59], v[116:119], v[20:23], v[56:59]
    v_mfma_f32_16x16x32_f16 v[52:55], v[112:115], v[20:23], v[52:55]
    v_mfma_f32_16x16x32_f16 v[48:51], v[108:111], v[20:23], v[48:51]
    v_mfma_f32_16x16x32_f16 v[44:47], v[104:107], v[20:23], v[44:47]
    v_mfma_f32_16x16x32_f16 v[40:43], v[100:103], v[20:23], v[40:43]
    v_mfma_f32_16x16x32_f16 v[36:39], v[96:99], v[20:23], v[36:39]
    s_waitcnt lgkmcnt(1)
    v_mfma_f32_16x16x32_f16 v[60:63], v[64:67], v[24:27], v[60:63]
    s_waitcnt lgkmcnt(0)
    v_mfma_f32_16x16x32_f16 v[60:63], v[124:127], v[28:31], v[60:63]
    v_mfma_f32_16x16x32_f16 v[56:59], v[120:123], v[28:31], v[56:59]
    v_mfma_f32_16x16x32_f16 v[52:55], v[116:119], v[28:31], v[52:55]
    v_mfma_f32_16x16x32_f16 v[48:51], v[112:115], v[28:31], v[48:51]
    v_mfma_f32_16x16x32_f16 v[44:47], v[108:111], v[28:31], v[44:47]
    v_mfma_f32_16x16x32_f16 v[40:43], v[104:107], v[28:31], v[40:43]
    v_mfma_f32_16x16x32_f16 v[36:39], v[100:103], v[28:31], v[36:39]
    v_mfma_f32_16x16x32_f16 v[32:35], v[96:99], v[28:31], v[32:35]
    s_cmp_ge_u32 s55, 2
    s_cbranch_scc1 F_PR15
    s_getreg_b32 s63, hwreg(HW_REG_IB_STS, 0, 4)
    s_cmp_eq_u32 s63, 0
    s_cbranch_scc1 F_PP15
F_PR15:
    ds_read_b64 v[88:89], v9 offset:22880
    ds_read_b64 v[90:91], v9 offset:23392
    s_lshl_b32 s21, s20, 10
    v_lshl_add_u32 v12, v1, 4, s21
    s_mov_b32 s49, 0x20000
F_PM:
    s_cmp_lt_u32 s55, 2
    s_cbranch_scc1 F_PP16
F_PM_D:
    s_waitcnt lgkmcnt(0)
    s_barrier
    s_cmp_eq_u32 s20, 0
    s_cbranch_scc1 F_SK0
    ds_write_b128 v12, v[32:35] offset:0
F_SK0:
    s_cmp_eq_u32 s20, 0
    s_cbranch_scc1 F_SK1
    ds_write_b128 v12, v[36:39] offset:4096
F_SK1:
    s_cmp_eq_u32 s20, 1
    s_cbranch_scc1 F_SK2
    ds_write_b128 v12, v[40:43] offset:8192
F_SK2:
    s_cmp_eq_u32 s20, 1
    s_cbranch_scc1 F_SK3
    ds_write_b128 v12, v[44:47] offset:12288
F_SK3:
    s_cmp_eq_u32 s20, 2
    s_cbranch_scc1 F_SK4
    ds_write_b128 v12, v[48:51] offset:16384
F_SK4:
    s_cmp_eq_u32 s20, 2
    s_cbranch_scc1 F_SK5
    ds_write_b128 v12, v[52:55] offset:20480
F_SK5:
    s_cmp_eq_u32 s20, 3
    s_cbranch_scc1 F_SK6
    ds_write_b128 v12, v[56:59] offset:24576
F_SK6:
    s_cmp_eq_u32 s20, 3
    s_cbranch_scc1 F_SK7
    ds_write_b128 v12, v[60:63] offset:28672
F_SK7:
    s_cmp_lg_u32 s20, 0
    s_cbranch_scc1 F_MV0
    v_mov_b64 v[64:65], v[32:33]
    v_mov_b64 v[66:67], v[34:35]
    v_mov_b64 v[68:69], v[36:37]
    v_mov_b64 v[70:71], v[38:39]
F_MV0:
    s_cmp_lg_u32 s20, 1
    s_cbranch_scc1 F_MV1
    v_mov_b64 v[64:65], v[40:41]
    v_mov_b64 v[66:67], v[42:43]
    v_mov_b64 v[68:69], v[44:45]
    v_mov_b64 v[70:71], v[46:47]
F_MV1:
    s_cmp_lg_u32 s20, 2
    s_cbranch_scc1 F_MV2
    v_mov_b64 v[64:65], v[48:49]
    v_mov_b64 v[66:67], v[50:51]
    v_mov_b64 v[68:69], v[52:53]
    v_mov_b64 v[70:71], v[54:55]
F_MV2:
    s_cmp_lg_u32 s20, 3
    s_cbranch_scc1 F_MV3
    v_mov_b64 v[64:65], v[56:57]
    v_mov_b64 v[66:67], v[58:59]
    v_mov_b64 v[68:69], v[60:61]
    v_mov_b64 v[70:71], v[62:63]
F_MV3:
    s_lshl_b32 s21, s20, 13
    v_lshl_add_u32 v13, v1, 4, s21
    s_add_u32 s21, s20, 1
    s_and_b32 s21, s21, 3
    s_lshl_b32 s21, s21, 10
    v_add_u32 v17, s21, v13
    s_add_u32 s21, s20, 2
    s_and_b32 s21, s21, 3
    s_lshl_b32 s21, s21, 10
    v_add_u32 v18, s21, v13
    s_add_u32 s21, s20, 3
    s_and_b32 s21, s21, 3
    s_lshl_b32 s21, s21, 10
    v_add_u32 v19, s21, v13
    v_cvt_f32_f16 v100, v88
    v_cvt_f32_f16_sdwa v101, v88 dst_sel:DWORD dst_unused:UNUSED_PAD src0_sel:WORD_1
    v_cvt_f32_f16 v102, v89
    v_cvt_f32_f16_sdwa v103, v89 dst_sel:DWORD dst_unused:UNUSED_PAD src0_sel:WORD_1
    v_cvt_f32_f16 v104, v90
    v_cvt_f32_f16_sdwa v105, v90 dst_sel:DWORD dst_unused:UNUSED_PAD src0_sel:WORD_1
    v_cvt_f32_f16 v106, v91
    v_cvt_f32_f16_sdwa v107, v91 dst_sel:DWORD dst_unused:UNUSED_PAD src0_sel:WORD_1
    v_mul_f32 v100, v100, v14
    v_mul_f32 v101, v101, v14
    v_mul_f32 v102, v102, v14
    v_mul_f32 v103, v103, v14
    v_mul_f32 v104, v104, v14
    v_mul_f32 v105, v105, v14
    v_mul_f32 v106, v106, v14
    v_mul_f32 v107, v107, v14
    v_cvt_pk_bf16_f32 v116, v100, v101
    v_cvt_pk_bf16_f32 v117, v102, v103
    v_cvt_pk_bf16_f32 v118, v104, v105
    v_cvt_pk_bf16_f32 v119, v106, v107
    v_lshlrev_b32 v100, 16, v116
    v_and_b32 v101, 0xffff0000, v116
    v_lshlrev_b32 v102, 16, v117
    v_and_b32 v103, 0xffff0000, v117
    v_lshlrev_b32 v104, 16, v118
    v_and_b32 v105, 0xffff0000, v118
    v_lshlrev_b32 v106, 16, v119
    v_and_b32 v107, 0xffff0000, v119
    s_waitcnt vmcnt(0) lgkmcnt(0)
    s_barrier
    ds_read_b64 v[92:93], v9 offset:35584
    ds_read_b64 v[94:95], v9 offset:36096
    ds_read_b128 v[32:35], v17 offset:0
    ds_read_b128 v[36:39], v17 offset:4096
    ds_read_b128 v[40:43], v18 offset:0
    ds_read_b128 v[44:47], v18 offset:4096
    ds_read_b128 v[48:51], v19 offset:0
    ds_read_b128 v[52:55], v19 offset:4096
    s_waitcnt lgkmcnt(6)
    v_lshlrev_b32 v108, 16, v92
    v_and_b32 v109, 0xffff0000, v92
    v_lshlrev_b32 v110, 16, v93
    v_and_b32 v111, 0xffff0000, v93
    v_lshlrev_b32 v112, 16, v94
    v_and_b32 v113, 0xffff0000, v94
    v_lshlrev_b32 v114, 16, v95
    v_and_b32 v115, 0xffff0000, v95
    s_mul_i32 s32, s3, 4224
    s_add_u32 s32, s32, 18354176
    s_waitcnt lgkmcnt(0)
    v_add_f32 v64, v64, v32
    v_add_f32 v40, v40, v48
    v_add_f32 v65, v65, v33
    v_add_f32 v41, v41, v49
    v_add_f32 v66, v66, v34
    v_add_f32 v42, v42, v50
    v_add_f32 v67, v67, v35
    v_add_f32 v43, v43, v51
    v_add_f32 v68, v68, v36
    v_add_f32 v44, v44, v52
    v_add_f32 v69, v69, v37
    v_add_f32 v45, v45, v53
    v_add_f32 v70, v70, v38
    v_add_f32 v46, v46, v54
    v_add_f32 v71, v71, v39
    v_add_f32 v47, v47, v55
    v_add_f32 v64, v64, v40
    v_add_f32 v65, v65, v41
    v_add_f32 v66, v66, v42
    v_add_f32 v67, v67, v43
    v_add_f32 v68, v68, v44
    v_add_f32 v69, v69, v45
    v_add_f32 v70, v70, v46
    v_add_f32 v71, v71, v47
    v_mul_f32 v64, s50, v64
    v_mul_f32 v65, s50, v65
    v_mul_f32 v66, s50, v66
    v_mul_f32 v67, s50, v67
    v_mul_f32 v68, s50, v68
    v_mul_f32 v69, s50, v69
    v_mul_f32 v70, s50, v70
    v_mul_f32 v71, s50, v71
    v_cvt_pk_bf16_f32 v116, v64, v65
    v_cvt_pk_bf16_f32 v117, v66, v67
    v_cvt_pk_bf16_f32 v118, v68, v69
    v_cvt_pk_bf16_f32 v119, v70, v71
    v_lshlrev_b32 v64, 16, v116
    v_and_b32 v65, 0xffff0000, v116
    v_lshlrev_b32 v66, 16, v117
    v_and_b32 v67, 0xffff0000, v117
    v_lshlrev_b32 v68, 16, v118
    v_and_b32 v69, 0xffff0000, v118
    v_lshlrev_b32 v70, 16, v119
    v_and_b32 v71, 0xffff0000, v119
    v_add_f32 v64, v64, v100
    v_add_f32 v65, v65, v101
    v_add_f32 v66, v66, v102
    v_add_f32 v67, v67, v103
    v_add_f32 v68, v68, v104
    v_add_f32 v69, v69, v105
    v_add_f32 v70, v70, v106
    v_add_f32 v71, v71, v107
    v_cvt_pk_bf16_f32 v116, v64, v65
    v_cvt_pk_bf16_f32 v117, v66, v67
    v_cvt_pk_bf16_f32 v118, v68, v69
    v_cvt_pk_bf16_f32 v119, v70, v71
    v_lshlrev_b32 v64, 16, v116
    v_and_b32 v65, 0xffff0000, v116
    v_lshlrev_b32 v66, 16, v117
    v_and_b32 v67, 0xffff0000, v117
    v_lshlrev_b32 v68, 16, v118
    v_and_b32 v69, 0xffff0000, v118
    v_lshlrev_b32 v70, 16, v119
    v_and_b32 v71, 0xffff0000, v119
    v_add_f32 v64, v64, v108
    v_add_f32 v65, v65, v109
    v_add_f32 v66, v66, v110
    v_add_f32 v67, v67, v111
    v_add_f32 v68, v68, v112
    v_add_f32 v69, v69, v113
    v_add_f32 v70, v70, v114
    v_add_f32 v71, v71, v115
    v_cvt_pk_bf16_f32 v116, v64, v65
    v_cvt_pk_bf16_f32 v117, v66, v67
    v_cvt_pk_bf16_f32 v118, v68, v69
    v_cvt_pk_bf16_f32 v119, v70, v71
    buffer_store_dwordx2 v[116:117], v9, s[24:27], s32 offen
    buffer_store_dwordx2 v[118:119], v9, s[24:27], s32 offen offset:512
    v_cmp_lt_u32 vcc, 47, v1
    v_mov_b32 v24, 5120
    s_nop 0
    v_cndmask_b32 v24, 32, v24, vcc
    v_lshrrev_b32 v25, 2, v15
    s_movk_i32 s33, 5120
    v_mad_u32_u24 v24, v25, s33, v24
    v_cndmask_b32 v25, v116, v117, vcc
    v_cndmask_b32 v26, v118, v119, vcc
    s_lshr_b32 s33, s3, 3
    s_lshl_b32 s33, s33, 6
    s_and_b32 s34, s3, 7
    s_lshl_b32 s34, s34, 1
    s_add_u32 s33, s33, s34
    s_mul_i32 s34, s20, 40960
    s_add_u32 s33, s33, s34
    s_add_u32 s33, s33, 18182144
    s_add_u32 s34, s33, 20480
    s_mov_b32 exec_lo, 0x1111
    s_mov_b32 exec_hi, 0x88880000
    buffer_store_short v25, v24, s[24:27], s33 offen
    buffer_store_short_d16_hi v25, v24, s[24:27], s33 offen offset:16
    buffer_store_short v26, v24, s[24:27], s34 offen
    buffer_store_short_d16_hi v26, v24, s[24:27], s34 offen offset:16
    s_mov_b64 exec, -1
    s_endpgm
F_PP9:
    s_sub_u32 s49, s49, 1
    s_cbranch_scc1 F_PL_D
    s_waitcnt vmcnt(0)
    s_cmp_eq_u32 s55, 1
    s_cbranch_scc1 F_PX9
    v_xor_b32 v2, v2, v6
    v_xor_b32 v3, v3, v7
    v_xor_b32 v4, v4, v12
    v_xor_b32 v5, v5, v13
    v_or3_b32 v18, v2, v3, v4
    v_or_b32 v18, v18, v5
    v_and_b32 v18, 458759, v18
    v_cmp_ne_u32 s[64:65], 0, v18
    s_nop 0
    s_cmp_lg_u64 s[64:65], 0
    s_cbranch_scc0 F_PW9
    buffer_load_dwordx4 v[2:5], v17, s[24:27], s56 offen sc1
    s_branch F_PL
F_PW9:
    ds_write_b128 v17, v[2:5] offset:22880
    v_mov_b32 v6, v19
    s_mov_b32 s55, 1
    s_waitcnt lgkmcnt(0)
    s_branch F_PI9
F_PX9:
    v_cmp_ne_u64 s[64:65], s[60:61], v[2:3]
    s_nop 0
    s_cmp_lg_u64 s[64:65], 0
    s_cbranch_scc1 F_PI9
    s_mov_b32 m0, s54
    s_nop 0
    buffer_load_dwordx4 v8, s[24:27], s57 offen sc1 lds
    s_mov_b32 s55, 2
    s_branch F_PL
F_PI9:
    buffer_load_dwordx2 v[2:3], v6, s[24:27], s44 offen sc1
    s_branch F_PL
F_PP10:
    s_waitcnt vmcnt(0)
    v_cmp_ne_u64 s[64:65], s[60:61], v[2:3]
    s_nop 0
    s_cmp_lg_u64 s[64:65], 0
    s_cbranch_scc1 F_PI10
    s_mov_b32 m0, s54
    s_nop 0
    buffer_load_dwordx4 v8, s[24:27], s57 offen sc1 lds
    s_mov_b32 s55, 2
    s_branch F_PR10
F_PI10:
    buffer_load_dwordx2 v[2:3], v6, s[24:27], s44 offen sc1
    s_branch F_PR10
F_PP11:
    s_waitcnt vmcnt(0)
    v_cmp_ne_u64 s[64:65], s[60:61], v[2:3]
    s_nop 0
    s_cmp_lg_u64 s[64:65], 0
    s_cbranch_scc1 F_PI11
    s_mov_b32 m0, s54
    s_nop 0
    buffer_load_dwordx4 v8, s[24:27], s57 offen sc1 lds
    s_mov_b32 s55, 2
    s_branch F_PR11
F_PI11:
    buffer_load_dwordx2 v[2:3], v6, s[24:27], s44 offen sc1
    s_branch F_PR11
F_PP12:
    s_waitcnt vmcnt(0)
    v_cmp_ne_u64 s[64:65], s[60:61], v[2:3]
    s_nop 0
    s_cmp_lg_u64 s[64:65], 0
    s_cbranch_scc1 F_PI12
    s_mov_b32 m0, s54
    s_nop 0
    buffer_load_dwordx4 v8, s[24:27], s57 offen sc1 lds
    s_mov_b32 s55, 2
    s_branch F_PR12
F_PI12:
    buffer_load_dwordx2 v[2:3], v6, s[24:27], s44 offen sc1
    s_branch F_PR12
F_PP13:
    s_waitcnt vmcnt(0)
    v_cmp_ne_u64 s[64:65], s[60:61], v[2:3]
    s_nop 0
    s_cmp_lg_u64 s[64:65], 0
    s_cbranch_scc1 F_PI13
    s_mov_b32 m0, s54
    s_nop 0
    buffer_load_dwordx4 v8, s[24:27], s57 offen sc1 lds
    s_mov_b32 s55, 2
    s_branch F_PR13
F_PI13:
    buffer_load_dwordx2 v[2:3], v6, s[24:27], s44 offen sc1
    s_branch F_PR13
F_PP14:
    s_waitcnt vmcnt(0)
    v_cmp_ne_u64 s[64:65], s[60:61], v[2:3]
    s_nop 0
    s_cmp_lg_u64 s[64:65], 0
    s_cbranch_scc1 F_PI14
    s_mov_b32 m0, s54
    s_nop 0
    buffer_load_dwordx4 v8, s[24:27], s57 offen sc1 lds
    s_mov_b32 s55, 2
    s_branch F_PR14
F_PI14:
    buffer_load_dwordx2 v[2:3], v6, s[24:27], s44 offen sc1
    s_branch F_PR14
F_PP15:
    s_waitcnt vmcnt(0)
    v_cmp_ne_u64 s[64:65], s[60:61], v[2:3]
    s_nop 0
    s_cmp_lg_u64 s[64:65], 0
    s_cbranch_scc1 F_PI15
    s_mov_b32 m0, s54
    s_nop 0
    buffer_load_dwordx4 v8, s[24:27], s57 offen sc1 lds
    s_mov_b32 s55, 2
    s_branch F_PR15
F_PI15:
    buffer_load_dwordx2 v[2:3], v6, s[24:27], s44 offen sc1
    s_branch F_PR15
F_PP16:
    s_sub_u32 s49, s49, 1
    s_cbranch_scc1 F_PM_D
    s_waitcnt vmcnt(0)
    v_cmp_ne_u64 s[64:65], s[60:61], v[2:3]
    s_nop 0
    s_cmp_lg_u64 s[64:65], 0
    s_cbranch_scc1 F_PI16
    s_mov_b32 m0, s54
    s_nop 0
    buffer_load_dwordx4 v8, s[24:27], s57 offen sc1 lds
    s_mov_b32 s55, 2
    s_branch F_PM
F_PI16:
    buffer_load_dwordx2 v[2:3], v6, s[24:27], s44 offen sc1
    s_branch F_PM
F_NW:
    s_or_b32 s60, s60, 1
    v_mov_b32 v6, s60
    v_mov_b32 v7, s61
    s_mov_b64 exec, 1
    global_store_dwordx2 v4, v[6:7], s[28:29] sc1
    global_store_dwordx2 v4, v[6:7], s[28:29] offset:128 sc1
    s_mov_b64 exec, -1
    s_branch F_NWR
F_LN:
    s_load_dwordx2 s[8:9], s[0:1], 0
    s_load_dwordx2 s[28:29], s[0:1], 104
    s_setprio 3
    s_and_b32 s20, s2, 63
    s_lshr_b32 s21, s2, 6
    v_lshrrev_b32 v1, 3, v0
    v_and_b32 v2, 7, v0
    s_lshl_b32 s22, s20, 5
    v_add_u32 v3, s22, v1
    v_mul_u32_u24 v3, 1280, v3
    v_lshl_add_u32 v3, v2, 4, v3
    s_mul_i32 s23, s21, 5
    s_lshr_b32 s23, s23, 1
    s_lshl_b32 s23, s23, 7
    s_cmp_gt_u32 s21, 0
    s_cselect_b32 s34, 0, 0x180
    s_cmp_gt_u32 s21, 1
    s_cselect_b32 s35, 0, 0x180
    s_cmp_gt_u32 s21, 2
    s_cselect_b32 s36, 0, 0x180
    s_mov_b32 s10, 2621440
    s_mov_b32 s11, 0x00020000
    s_movk_i32 s30, 256
    s_mov_b32 s31, 0x00020000
    s_waitcnt lgkmcnt(0)
    buffer_load_dwordx4 v[8:11], v3, s[8:11], s23 offen offset:0
    buffer_load_dwordx4 v[12:15], v3, s[8:11], s23 offen offset:128
    buffer_load_dwordx4 v[16:19], v3, s[8:11], s23 offen offset:256
    buffer_load_dwordx4 v[20:23], v3, s[8:11], s34 offen offset:0
    buffer_load_dwordx4 v[24:27], v3, s[8:11], s34 offen offset:128
    buffer_load_dwordx4 v[28:31], v3, s[8:11], s35 offen offset:256
    buffer_load_dwordx4 v[32:35], v3, s[8:11], s35 offen offset:384
    buffer_load_dwordx4 v[36:39], v3, s[8:11], s35 offen offset:512
    buffer_load_dwordx4 v[40:43], v3, s[8:11], s36 offen offset:640
    buffer_load_dwordx4 v[44:47], v3, s[8:11], s36 offen offset:768
    s_mov_b32 s24, s4
    s_mov_b32 s25, s5
    s_mov_b32 s26, 27335680
    s_mov_b32 s27, 0x00020000
    v_and_b32 v4, 0x13, v1
    v_bfe_u32 v5, v1, 2, 1
    v_lshl_or_b32 v4, v5, 3, v4
    v_bfe_u32 v5, v1, 3, 1
    v_lshl_or_b32 v4, v5, 2, v4
    v_mul_u32_u24 v4, 416, v4
    v_lshl_add_u32 v4, v2, 4, v4
    v_and_b32 v5, 63, v0
    v_lshrrev_b32 v6, 4, v5
    v_bfe_u32 v7, v5, 2, 2
    v_and_b32 v60, 1, v6
    v_lshl_add_u32 v7, v60, 2, v7
    v_lshrrev_b32 v60, 1, v6
    v_lshl_add_u32 v7, v60, 4, v7
    v_mul_u32_u24 v7, 416, v7
    v_and_b32 v60, 3, v5
    v_lshl_add_u32 v7, v60, 3, v7
    v_lshrrev_b32 v61, 6, v0
    v_lshl_add_u32 v7, v61, 5, v7
    s_and_b32 s22, s21, 1
    s_lshl_b32 s22, s22, 6
    v_add_u32 v7, s22, v7
    v_readfirstlane_b32 s33, v61
    v_and_b32 v60, 15, v5
    v_lshl_add_u32 v60, v61, 4, v60
    s_mul_i32 s22, s21, 160
    v_add_u32 v60, s22, v60
    v_and_b32 v61, 7, v60
    v_mul_u32_u24 v61, 327936, v61
    v_lshrrev_b32 v60, 3, v60
    v_lshl_add_u32 v6, v6, 4, v61
    v_mul_u32_u24 v60, 4096, v60
    v_add_u32 v6, v6, v60
    s_lshl_b32 s22, s20, 6
    s_add_u32 s34, s22, 0
    s_add_u32 s35, s22, 32768
    s_add_u32 s36, s22, 65536
    s_cmp_lt_u32 s33, 2
    s_cselect_b32 s36, s36, 1073741824
    s_add_u32 s37, s34, 2752512
    s_add_u32 s38, s35, 2752512
    s_add_u32 s39, s36, 2752512
    v_mov_b32 v60, 0
    v_mov_b32 v61, 0
    v_mov_b32 v62, 0
    v_mov_b32 v63, 0
    v_mov_b32 v64, 0
    v_mov_b32 v65, 0
    v_mov_b32 v66, 0
    v_mov_b32 v67, 0
    s_mov_b32 s40, 0x3f803f80
    s_mov_b32 s41, 0x00040004
    s_waitcnt vmcnt(9)
    ds_write_b128 v4, v[8:11] offset:13312
    s_waitcnt vmcnt(8)
    ds_write_b128 v4, v[12:15] offset:13440
    s_waitcnt vmcnt(7)
    ds_write_b128 v4, v[16:19] offset:13568
    v_dot2c_f32_bf16 v60, s40, v8
    v_dot2c_f32_bf16 v64, v8, v8
    v_dot2c_f32_bf16 v61, s40, v9
    v_dot2c_f32_bf16 v65, v9, v9
    v_dot2c_f32_bf16 v62, s40, v10
    v_dot2c_f32_bf16 v66, v10, v10
    v_dot2c_f32_bf16 v63, s40, v11
    v_dot2c_f32_bf16 v67, v11, v11
    v_dot2c_f32_bf16 v60, s40, v12
    v_dot2c_f32_bf16 v64, v12, v12
    v_dot2c_f32_bf16 v61, s40, v13
    v_dot2c_f32_bf16 v65, v13, v13
    v_dot2c_f32_bf16 v62, s40, v14
    v_dot2c_f32_bf16 v66, v14, v14
    v_dot2c_f32_bf16 v63, s40, v15
    v_dot2c_f32_bf16 v67, v15, v15
    v_dot2c_f32_bf16 v60, s40, v16
    v_dot2c_f32_bf16 v64, v16, v16
    v_dot2c_f32_bf16 v61, s40, v17
    v_dot2c_f32_bf16 v65, v17, v17
    v_dot2c_f32_bf16 v62, s40, v18
    v_dot2c_f32_bf16 v66, v18, v18
    v_dot2c_f32_bf16 v63, s40, v19
    v_dot2c_f32_bf16 v67, v19, v19
    s_waitcnt lgkmcnt(0)
    s_barrier
    ds_read_b64_tr_b16 v[84:85], v7 offset:13312
    ds_read_b64_tr_b16 v[86:87], v7 offset:16640
    ds_read_b64_tr_b16 v[88:89], v7 offset:13440
    ds_read_b64_tr_b16 v[90:91], v7 offset:16768
    ds_read_b64_tr_b16 v[92:93], v7 offset:13568
    ds_read_b64_tr_b16 v[94:95], v7 offset:16896
    s_waitcnt lgkmcnt(4)
    buffer_store_dwordx4 v[84:87], v6, s[24:27], s37 offen sc1
    s_waitcnt lgkmcnt(2)
    buffer_store_dwordx4 v[88:91], v6, s[24:27], s38 offen sc1
    s_waitcnt lgkmcnt(0)
    buffer_store_dwordx4 v[92:95], v6, s[24:27], s39 offen sc1
    s_waitcnt vmcnt(9)
    v_dot2c_f32_bf16 v60, s40, v20
    v_dot2c_f32_bf16 v64, v20, v20
    v_dot2c_f32_bf16 v61, s40, v21
    v_dot2c_f32_bf16 v65, v21, v21
    v_dot2c_f32_bf16 v62, s40, v22
    v_dot2c_f32_bf16 v66, v22, v22
    v_dot2c_f32_bf16 v63, s40, v23
    v_dot2c_f32_bf16 v67, v23, v23
    s_waitcnt vmcnt(8)
    v_dot2c_f32_bf16 v60, s40, v24
    v_dot2c_f32_bf16 v64, v24, v24
    v_dot2c_f32_bf16 v61, s40, v25
    v_dot2c_f32_bf16 v65, v25, v25
    v_dot2c_f32_bf16 v62, s40, v26
    v_dot2c_f32_bf16 v66, v26, v26
    v_dot2c_f32_bf16 v63, s40, v27
    v_dot2c_f32_bf16 v67, v27, v27
    s_waitcnt vmcnt(7)
    v_dot2c_f32_bf16 v60, s40, v28
    v_dot2c_f32_bf16 v64, v28, v28
    v_dot2c_f32_bf16 v61, s40, v29
    v_dot2c_f32_bf16 v65, v29, v29
    v_dot2c_f32_bf16 v62, s40, v30
    v_dot2c_f32_bf16 v66, v30, v30
    v_dot2c_f32_bf16 v63, s40, v31
    v_dot2c_f32_bf16 v67, v31, v31
    s_waitcnt vmcnt(6)
    v_dot2c_f32_bf16 v60, s40, v32
    v_dot2c_f32_bf16 v64, v32, v32
    v_dot2c_f32_bf16 v61, s40, v33
    v_dot2c_f32_bf16 v65, v33, v33
    v_dot2c_f32_bf16 v62, s40, v34
    v_dot2c_f32_bf16 v66, v34, v34
    v_dot2c_f32_bf16 v63, s40, v35
    v_dot2c_f32_bf16 v67, v35, v35
    s_waitcnt vmcnt(5)
    v_dot2c_f32_bf16 v60, s40, v36
    v_dot2c_f32_bf16 v64, v36, v36
    v_dot2c_f32_bf16 v61, s40, v37
    v_dot2c_f32_bf16 v65, v37, v37
    v_dot2c_f32_bf16 v62, s40, v38
    v_dot2c_f32_bf16 v66, v38, v38
    v_dot2c_f32_bf16 v63, s40, v39
    v_dot2c_f32_bf16 v67, v39, v39
    s_waitcnt vmcnt(4)
    v_dot2c_f32_bf16 v60, s40, v40
    v_dot2c_f32_bf16 v64, v40, v40
    v_dot2c_f32_bf16 v61, s40, v41
    v_dot2c_f32_bf16 v65, v41, v41
    v_dot2c_f32_bf16 v62, s40, v42
    v_dot2c_f32_bf16 v66, v42, v42
    v_dot2c_f32_bf16 v63, s40, v43
    v_dot2c_f32_bf16 v67, v43, v43
    s_waitcnt vmcnt(3)
    v_dot2c_f32_bf16 v60, s40, v44
    v_dot2c_f32_bf16 v64, v44, v44
    v_dot2c_f32_bf16 v61, s40, v45
    v_dot2c_f32_bf16 v65, v45, v45
    v_dot2c_f32_bf16 v62, s40, v46
    v_dot2c_f32_bf16 v66, v46, v46
    v_dot2c_f32_bf16 v63, s40, v47
    v_dot2c_f32_bf16 v67, v47, v47
    s_load_dwordx2 s[60:61], s[28:29], 0
    v_add_f32 v60, v60, v61
    v_add_f32 v62, v62, v63
    v_add_f32 v64, v64, v65
    v_add_f32 v66, v66, v67
    v_add_f32 v60, v60, v62
    v_add_f32 v64, v64, v66
    s_nop 0
    v_add_f32 v60, v60, v60 quad_perm:[1,0,3,2] row_mask:0xf bank_mask:0xf
    v_add_f32 v64, v64, v64 quad_perm:[1,0,3,2] row_mask:0xf bank_mask:0xf
    s_nop 0
    v_add_f32 v60, v60, v60 quad_perm:[2,3,0,1] row_mask:0xf bank_mask:0xf
    v_add_f32 v64, v64, v64 quad_perm:[2,3,0,1] row_mask:0xf bank_mask:0xf
    s_nop 0
    v_add_f32 v60, v60, v60 row_half_mirror row_mask:0xf bank_mask:0xf
    v_add_f32 v64, v64, v64 row_half_mirror row_mask:0xf bank_mask:0xf
    v_mul_f32 v60, 0x3acccccd, v60
    v_mul_f32 v64, 0x3acccccd, v64
    v_fma_f32 v64, -v60, v60, v64
    v_max_f32 v64, 0, v64
    v_cvt_pk_bf16_f32 v64, 0, v64
    v_add_f32 v64, 0x3727c5ac, v64
    v_cvt_pk_bf16_f32 v64, 0, v64
    v_sqrt_f32 v64, v64
    v_cvt_pk_bf16_f32 v60, 0, v60
    v_cvt_pk_bf16_f32 v64, 0, v64
    v_rcp_f32 v62, v64
    v_lshlrev_b32 v20, 16, v8
    v_and_b32 v21, 0xffff0000, v8
    v_lshlrev_b32 v22, 16, v9
    v_and_b32 v23, 0xffff0000, v9
    v_lshlrev_b32 v24, 16, v10
    v_and_b32 v25, 0xffff0000, v10
    v_lshlrev_b32 v26, 16, v11
    v_and_b32 v27, 0xffff0000, v11
    v_pk_add_f32 v[20:21], v[20:21], v[60:61] op_sel_hi:[1,0] neg_lo:[0,1] neg_hi:[0,1]
    v_pk_add_f32 v[22:23], v[22:23], v[60:61] op_sel_hi:[1,0] neg_lo:[0,1] neg_hi:[0,1]
    v_pk_add_f32 v[24:25], v[24:25], v[60:61] op_sel_hi:[1,0] neg_lo:[0,1] neg_hi:[0,1]
    v_pk_add_f32 v[26:27], v[26:27], v[60:61] op_sel_hi:[1,0] neg_lo:[0,1] neg_hi:[0,1]
    v_cvt_pk_bf16_f32 v20, 0, v20
    v_cvt_pk_bf16_f32 v21, 0, v21
    v_cvt_pk_bf16_f32 v22, 0, v22
    v_cvt_pk_bf16_f32 v23, 0, v23
    v_cvt_pk_bf16_f32 v24, 0, v24
    v_cvt_pk_bf16_f32 v25, 0, v25
    v_cvt_pk_bf16_f32 v26, 0, v26
    v_cvt_pk_bf16_f32 v27, 0, v27
    v_pk_mul_f32 v[20:21], v[20:21], v[62:63] op_sel_hi:[1,0]
    v_pk_mul_f32 v[22:23], v[22:23], v[62:63] op_sel_hi:[1,0]
    v_pk_mul_f32 v[24:25], v[24:25], v[62:63] op_sel_hi:[1,0]
    v_pk_mul_f32 v[26:27], v[26:27], v[62:63] op_sel_hi:[1,0]
    v_cvt_pkrtz_f16_f32 v8, v20, v21
    v_cvt_pkrtz_f16_f32 v9, v22, v23
    v_cvt_pkrtz_f16_f32 v10, v24, v25
    v_cvt_pkrtz_f16_f32 v11, v26, v27
    v_add_u32 v8, s41, v8
    v_add_u32 v9, s41, v9
    v_add_u32 v10, s41, v10
    v_add_u32 v11, s41, v11
    ds_write_b128 v4, v[8:11] offset:0
    v_lshlrev_b32 v28, 16, v12
    v_and_b32 v29, 0xffff0000, v12
    v_lshlrev_b32 v30, 16, v13
    v_and_b32 v31, 0xffff0000, v13
    v_lshlrev_b32 v32, 16, v14
    v_and_b32 v33, 0xffff0000, v14
    v_lshlrev_b32 v34, 16, v15
    v_and_b32 v35, 0xffff0000, v15
    v_pk_add_f32 v[28:29], v[28:29], v[60:61] op_sel_hi:[1,0] neg_lo:[0,1] neg_hi:[0,1]
    v_pk_add_f32 v[30:31], v[30:31], v[60:61] op_sel_hi:[1,0] neg_lo:[0,1] neg_hi:[0,1]
    v_pk_add_f32 v[32:33], v[32:33], v[60:61] op_sel_hi:[1,0] neg_lo:[0,1] neg_hi:[0,1]
    v_pk_add_f32 v[34:35], v[34:35], v[60:61] op_sel_hi:[1,0] neg_lo:[0,1] neg_hi:[0,1]
    v_cvt_pk_bf16_f32 v28, 0, v28
    v_cvt_pk_bf16_f32 v29, 0, v29
    v_cvt_pk_bf16_f32 v30, 0, v30
    v_cvt_pk_bf16_f32 v31, 0, v31
    v_cvt_pk_bf16_f32 v32, 0, v32
    v_cvt_pk_bf16_f32 v33, 0, v33
    v_cvt_pk_bf16_f32 v34, 0, v34
    v_cvt_pk_bf16_f32 v35, 0, v35
    v_pk_mul_f32 v[28:29], v[28:29], v[62:63] op_sel_hi:[1,0]
    v_pk_mul_f32 v[30:31], v[30:31], v[62:63] op_sel_hi:[1,0]
    v_pk_mul_f32 v[32:33], v[32:33], v[62:63] op_sel_hi:[1,0]
    v_pk_mul_f32 v[34:35], v[34:35], v[62:63] op_sel_hi:[1,0]
    v_cvt_pkrtz_f16_f32 v12, v28, v29
    v_cvt_pkrtz_f16_f32 v13, v30, v31
    v_cvt_pkrtz_f16_f32 v14, v32, v33
    v_cvt_pkrtz_f16_f32 v15, v34, v35
    v_add_u32 v12, s41, v12
    v_add_u32 v13, s41, v13
    v_add_u32 v14, s41, v14
    v_add_u32 v15, s41, v15
    ds_write_b128 v4, v[12:15] offset:128
    v_lshlrev_b32 v36, 16, v16
    v_and_b32 v37, 0xffff0000, v16
    v_lshlrev_b32 v38, 16, v17
    v_and_b32 v39, 0xffff0000, v17
    v_lshlrev_b32 v40, 16, v18
    v_and_b32 v41, 0xffff0000, v18
    v_lshlrev_b32 v42, 16, v19
    v_and_b32 v43, 0xffff0000, v19
    v_pk_add_f32 v[36:37], v[36:37], v[60:61] op_sel_hi:[1,0] neg_lo:[0,1] neg_hi:[0,1]
    v_pk_add_f32 v[38:39], v[38:39], v[60:61] op_sel_hi:[1,0] neg_lo:[0,1] neg_hi:[0,1]
    v_pk_add_f32 v[40:41], v[40:41], v[60:61] op_sel_hi:[1,0] neg_lo:[0,1] neg_hi:[0,1]
    v_pk_add_f32 v[42:43], v[42:43], v[60:61] op_sel_hi:[1,0] neg_lo:[0,1] neg_hi:[0,1]
    v_cvt_pk_bf16_f32 v36, 0, v36
    v_cvt_pk_bf16_f32 v37, 0, v37
    v_cvt_pk_bf16_f32 v38, 0, v38
    v_cvt_pk_bf16_f32 v39, 0, v39
    v_cvt_pk_bf16_f32 v40, 0, v40
    v_cvt_pk_bf16_f32 v41, 0, v41
    v_cvt_pk_bf16_f32 v42, 0, v42
    v_cvt_pk_bf16_f32 v43, 0, v43
    v_pk_mul_f32 v[36:37], v[36:37], v[62:63] op_sel_hi:[1,0]
    v_pk_mul_f32 v[38:39], v[38:39], v[62:63] op_sel_hi:[1,0]
    v_pk_mul_f32 v[40:41], v[40:41], v[62:63] op_sel_hi:[1,0]
    v_pk_mul_f32 v[42:43], v[42:43], v[62:63] op_sel_hi:[1,0]
    v_cvt_pkrtz_f16_f32 v16, v36, v37
    v_cvt_pkrtz_f16_f32 v17, v38, v39
    v_cvt_pkrtz_f16_f32 v18, v40, v41
    v_cvt_pkrtz_f16_f32 v19, v42, v43
    v_add_u32 v16, s41, v16
    v_add_u32 v17, s41, v17
    v_add_u32 v18, s41, v18
    v_add_u32 v19, s41, v19
    ds_write_b128 v4, v[16:19] offset:256
    s_waitcnt lgkmcnt(0)
    s_cmp_lg_u32 s60, 0
    s_cbranch_scc1 F_NL_OK
    s_load_dwordx2 s[60:61], s[28:29], 128
    s_mov_b32 s62, 0x20000
    s_waitcnt lgkmcnt(0)
F_NL:
    s_cmp_lg_u32 s60, 0
    s_cbranch_scc1 F_NL_OK
    v_mov_b32 v60, 0
    buffer_load_dwordx2 v[60:61], v60, s[28:31], 0 offen sc1
    s_waitcnt vmcnt(0)
    v_readfirstlane_b32 s60, v60
    v_readfirstlane_b32 s61, v61
    s_sub_u32 s62, s62, 1
    s_cbranch_scc0 F_NL
F_NL_OK:
    v_bfe_u32 v60, v0, 4, 2
    s_mov_b32 s22, 0x85ebca6b
    s_mov_b32 s23, 0xc2b2ae35
    v_mul_u32_u24 v64, 0x9e3779, v60
    v_add_u32 v64, s60, v64
    v_lshrrev_b32 v65, 16, v64
    v_xor_b32 v64, v64, v65
    v_mul_lo_u32 v64, v64, s22
    v_lshrrev_b32 v65, 13, v64
    v_xor_b32 v64, v64, v65
    v_mul_lo_u32 v64, v64, s23
    v_lshrrev_b32 v65, 16, v64
    v_xor_b32 v64, v64, v65
    v_lshrrev_b32 v65, 3, v64
    v_and_b32 v65, 458759, v65
    v_lshrrev_b32 v66, 6, v64
    v_and_b32 v66, 458759, v66
    v_lshrrev_b32 v67, 9, v64
    v_and_b32 v67, 458759, v67
    v_and_b32 v64, 458759, v64
    s_barrier
    ds_read_b64_tr_b16 v[72:73], v7 offset:0
    ds_read_b64_tr_b16 v[74:75], v7 offset:3328
    ds_read_b64_tr_b16 v[76:77], v7 offset:128
    ds_read_b64_tr_b16 v[78:79], v7 offset:3456
    ds_read_b64_tr_b16 v[80:81], v7 offset:256
    ds_read_b64_tr_b16 v[82:83], v7 offset:3584
    s_mov_b32 s23, 0xfff8fff8
    s_waitcnt lgkmcnt(4)
    v_and_or_b32 v72, v72, s23, v64
    v_and_or_b32 v73, v73, s23, v65
    v_and_or_b32 v74, v74, s23, v66
    v_and_or_b32 v75, v75, s23, v67
    buffer_store_dwordx4 v[72:75], v6, s[24:27], s34 offen sc1
    s_waitcnt lgkmcnt(2)
    v_and_or_b32 v76, v76, s23, v64
    v_and_or_b32 v77, v77, s23, v65
    v_and_or_b32 v78, v78, s23, v66
    v_and_or_b32 v79, v79, s23, v67
    buffer_store_dwordx4 v[76:79], v6, s[24:27], s35 offen sc1
    s_waitcnt lgkmcnt(0)
    v_and_or_b32 v80, v80, s23, v64
    v_and_or_b32 v81, v81, s23, v65
    v_and_or_b32 v82, v82, s23, v66
    v_and_or_b32 v83, v83, s23, v67
    buffer_store_dwordx4 v[80:83], v6, s[24:27], s36 offen sc1
    v_lshlrev_b32 v62, 9, v0
    s_lshl_b32 s22, s21, 14
    s_lshl_b32 s23, s20, 3
    s_add_u32 s22, s22, s23
    s_add_u32 s22, s22, 27201536
    s_cmp_lg_u32 s33, 0
    s_cselect_b32 s22, 1073741824, s22
    v_mov_b32 v60, s60
    v_mov_b32 v61, s61
    s_waitcnt vmcnt(3)
    s_barrier
    s_lshl_b32 s23, s2, 7
    s_add_u32 s23, s23, 27267072
    s_cmp_lg_u32 s33, 0
    s_cselect_b32 s23, 1073741824, s23
    s_mov_b64 exec, 1
    buffer_store_dwordx2 v[60:61], v62, s[24:27], s23 offen
    s_mov_b64 exec, -1
    s_mov_b32 exec_hi, 0
    buffer_store_dwordx2 v[60:61], v62, s[24:27], s22 offen sc1
    s_mov_b64 exec, -1
    s_setprio 0
    s_sub_u32 s3, s2, 128
    s_cmp_ge_u32 s3, 128
    s_cbranch_scc1 F_END
    s_mul_i32 s48, s3, 3
    s_add_u32 s48, s48, 384
    s_cmp_ge_u32 s48, 696
    s_cbranch_scc1 F_END
    s_add_u32 s3, s3, 128
    s_mov_b32 s21, 3
    s_branch F_AX1
F_AUX:
    s_cmp_ge_u32 s2, 1024
    s_cbranch_scc1 F_END
    s_sub_u32 s3, s2, 896
    s_mul_i32 s48, s3, 3
    s_mov_b32 s21, 3
F_AX1:
    s_load_dwordx8 s[12:19], s[0:1], 64
    s_load_dwordx2 s[28:29], s[0:1], 104
    v_lshrrev_b32 v1, 6, v0
    s_nop 0
    v_readfirstlane_b32 s33, v1
    s_mov_b32 s26, 27335680
    s_mov_b32 s27, 0x00020000
    s_movk_i32 s30, 256
    s_mov_b32 s31, 0x00020000
    v_mov_b32 v8, 0
    v_mov_b32 v9, 0
    v_mov_b32 v10, 0
    v_mov_b32 v11, 0
    s_lshl_b32 s20, s3, 12
    s_add_u32 s20, s20, 27332608
    v_lshlrev_b32 v3, 4, v0
    s_add_u32 s48, s48, s33
    s_waitcnt lgkmcnt(0)
    s_mov_b32 s24, s4
    s_mov_b32 s25, s5
    buffer_store_dwordx4 v[8:11], v3, s[24:27], s20 offen
    s_cmp_ge_u32 s33, s21
    s_cselect_b32 s48, 696, s48
    s_cmp_ge_u32 s48, 696
    s_cbranch_scc1 F_TC
    v_and_b32 v124, 63, v0
    s_mov_b32 s62, 0
    s_mov_b32 s63, 0
    s_mov_b32 s59, 4
    s_mov_b32 s47, 0x00020000
    s_cmp_ge_u32 s48, 80
    s_cbranch_scc1 F_PK_N0
    s_and_b32 s49, s48, 3
    s_lshl_b32 s49, s49, 1
    s_lshr_b32 s52, s48, 2
    s_mul_i32 s48, s49, 20
    s_add_u32 s48, s48, s52
    s_mul_i32 s65, s48, 320
    s_add_u32 s65, s65, 17960960
    s_mul_i32 s64, s49, 160
    s_mul_i32 s50, s48, 5120
    s_add_u32 s50, s50, 21057536
    s_mov_b32 s43, 102400
    s_lshl_b32 s57, s52, 5
    s_mov_b32 s58, 8
    s_mov_b32 s44, s12
    s_mov_b32 s45, s13
    s_mov_b32 s46, 819200
    s_mov_b32 s51, 5
    s_branch F_PK_B5
F_PK_N0:
    s_cmp_ge_u32 s48, 160
    s_cbranch_scc1 F_PK_N1
    s_sub_u32 s48, s48, 80
    s_and_b32 s49, s48, 3
    s_lshl_b32 s49, s49, 1
    s_lshr_b32 s52, s48, 2
    s_mul_i32 s48, s49, 20
    s_add_u32 s48, s48, s52
    s_mov_b32 s65, 1073741824
    s_mul_i32 s64, s49, 160
    s_mul_i32 s50, s48, 5120
    s_add_u32 s50, s50, 21876736
    s_mov_b32 s43, 102400
    s_mul_i32 s53, s52, 205
    s_lshr_b32 s53, s53, 10
    s_mul_i32 s54, s53, 5
    s_sub_u32 s54, s52, s54
    s_mul_i32 s57, s53, 160
    s_lshr_b32 s55, s54, 1
    s_mul_i32 s55, s55, 80
    s_and_b32 s56, s54, 1
    s_lshl_b32 s56, s56, 3
    s_add_u32 s55, s55, s56
    s_cmp_eq_u32 s54, 4
    s_cselect_b32 s55, 16, s55
    s_cselect_b32 s59, 80, 4
    s_add_u32 s57, s57, s55
    s_mov_b32 s58, 20
    s_mov_b32 s44, s14
    s_mov_b32 s45, s15
    s_mov_b32 s46, 819200
    s_mov_b32 s51, 5
    s_branch F_PK_B5
F_PK_N1:
    s_cmp_ge_u32 s48, 376
    s_cbranch_scc1 F_PK_N2
    s_sub_u32 s48, s48, 160
    s_and_b32 s49, s48, 3
    s_lshl_b32 s49, s49, 1
    s_lshr_b32 s52, s48, 2
    s_mul_i32 s48, s49, 54
    s_add_u32 s48, s48, s52
    s_mov_b32 s65, 1073741824
    s_mul_i32 s64, s49, 160
    s_mul_i32 s50, s48, 5120
    s_add_u32 s50, s50, 24989696
    s_mov_b32 s43, 276480
    s_mul_i32 s53, s52, 43
    s_lshr_b32 s53, s53, 7
    s_mul_i32 s54, s53, 3
    s_sub_u32 s54, s52, s54
    s_mul_i32 s57, s53, 108
    s_lshl_b32 s54, s54, 3
    s_add_u32 s57, s57, s54
    s_sub_u32 s55, s52, 48
    s_lshl_b32 s55, s55, 3
    s_mul_i32 s56, s55, 28
    s_add_u32 s56, s56, 24
    s_cmp_ge_u32 s52, 48
    s_cselect_b32 s57, s56, s57
    s_cselect_b32 s58, 56, 28
    s_cselect_b32 s59, 28, 4
    s_cselect_b32 s62, s55, 0
    s_cselect_b32 s63, 24, 0
    s_mov_b32 s44, s18
    s_mov_b32 s45, s19
    s_mov_b32 s46, 2211840
    s_mov_b32 s51, 5
    s_branch F_PK_B5
F_PK_N2:
    s_sub_u32 s48, s48, 376
    s_and_b32 s49, s48, 15
    s_lshr_b32 s52, s48, 4
    s_mul_i32 s48, s49, 20
    s_add_u32 s48, s48, s52
    s_mul_i32 s65, s48, 512
    s_add_u32 s65, s65, 18014208
    s_mul_i32 s64, s49, 216
    s_mul_i32 s50, s48, 7168
    s_add_u32 s50, s50, 22695936
    s_mov_b32 s43, 143360
    s_mul_i32 s53, s52, 205
    s_lshr_b32 s53, s53, 10
    s_mul_i32 s54, s53, 5
    s_sub_u32 s54, s52, s54
    s_mul_i32 s57, s53, 160
    s_lshr_b32 s55, s54, 1
    s_mul_i32 s55, s55, 80
    s_and_b32 s56, s54, 1
    s_lshl_b32 s56, s56, 3
    s_add_u32 s55, s55, s56
    s_cmp_eq_u32 s54, 4
    s_cselect_b32 s55, 16, s55
    s_cselect_b32 s59, 80, 4
    s_add_u32 s57, s57, s55
    s_mov_b32 s58, 20
    s_mov_b32 s44, s16
    s_mov_b32 s45, s17
    s_mov_b32 s46, 2211840
    s_mov_b32 s51, 7
    s_branch F_PK_B7
F_PK_B5:
    v_add_u32 v96, 0, v124
    v_mul_u32_u24 v97, 6554, v96
    v_lshrrev_b32 v97, 16, v97
    v_mad_i32_i24 v96, v97, -10, v96
    v_lshrrev_b32 v98, 4, v97
    v_bfe_u32 v99, v97, 2, 1
    v_lshl_or_b32 v98, v98, 1, v99
    v_bfe_u32 v99, v97, 3, 1
    v_and_b32 v97, 3, v97
    v_add_u32 v97, s57, v97
    v_mad_u32_u24 v97, v98, s58, v97
    v_mad_u32_u24 v97, v99, s59, v97
    v_lshl_add_u32 v98, v98, 1, v99
    v_add_u32 v98, s62, v98
    v_mul_u32_u24 v98, 43, v98
    v_lshrrev_b32 v98, 7, v98
    v_mad_u32_u24 v97, v98, s63, v97
    v_mul_u32_u24 v97, 1280, v97
    v_lshl_add_u32 v96, v96, 4, v97
    v_add_u32 v100, 64, v124
    v_mul_u32_u24 v101, 6554, v100
    v_lshrrev_b32 v101, 16, v101
    v_mad_i32_i24 v100, v101, -10, v100
    v_lshrrev_b32 v102, 4, v101
    v_bfe_u32 v103, v101, 2, 1
    v_lshl_or_b32 v102, v102, 1, v103
    v_bfe_u32 v103, v101, 3, 1
    v_and_b32 v101, 3, v101
    v_add_u32 v101, s57, v101
    v_mad_u32_u24 v101, v102, s58, v101
    v_mad_u32_u24 v101, v103, s59, v101
    v_lshl_add_u32 v102, v102, 1, v103
    v_add_u32 v102, s62, v102
    v_mul_u32_u24 v102, 43, v102
    v_lshrrev_b32 v102, 7, v102
    v_mad_u32_u24 v101, v102, s63, v101
    v_mul_u32_u24 v101, 1280, v101
    v_lshl_add_u32 v100, v100, 4, v101
    v_add_u32 v104, 128, v124
    v_mul_u32_u24 v105, 6554, v104
    v_lshrrev_b32 v105, 16, v105
    v_mad_i32_i24 v104, v105, -10, v104
    v_lshrrev_b32 v106, 4, v105
    v_bfe_u32 v107, v105, 2, 1
    v_lshl_or_b32 v106, v106, 1, v107
    v_bfe_u32 v107, v105, 3, 1
    v_and_b32 v105, 3, v105
    v_add_u32 v105, s57, v105
    v_mad_u32_u24 v105, v106, s58, v105
    v_mad_u32_u24 v105, v107, s59, v105
    v_lshl_add_u32 v106, v106, 1, v107
    v_add_u32 v106, s62, v106
    v_mul_u32_u24 v106, 43, v106
    v_lshrrev_b32 v106, 7, v106
    v_mad_u32_u24 v105, v106, s63, v105
    v_mul_u32_u24 v105, 1280, v105
    v_lshl_add_u32 v104, v104, 4, v105
    v_add_u32 v108, 192, v124
    v_mul_u32_u24 v109, 6554, v108
    v_lshrrev_b32 v109, 16, v109
    v_mad_i32_i24 v108, v109, -10, v108
    v_lshrrev_b32 v110, 4, v109
    v_bfe_u32 v111, v109, 2, 1
    v_lshl_or_b32 v110, v110, 1, v111
    v_bfe_u32 v111, v109, 3, 1
    v_and_b32 v109, 3, v109
    v_add_u32 v109, s57, v109
    v_mad_u32_u24 v109, v110, s58, v109
    v_mad_u32_u24 v109, v111, s59, v109
    v_lshl_add_u32 v110, v110, 1, v111
    v_add_u32 v110, s62, v110
    v_mul_u32_u24 v110, 43, v110
    v_lshrrev_b32 v110, 7, v110
    v_mad_u32_u24 v109, v110, s63, v109
    v_mul_u32_u24 v109, 1280, v109
    v_lshl_add_u32 v108, v108, 4, v109
    v_add_u32 v112, 256, v124
    v_mul_u32_u24 v113, 6554, v112
    v_lshrrev_b32 v113, 16, v113
    v_mad_i32_i24 v112, v113, -10, v112
    v_lshrrev_b32 v114, 4, v113
    v_bfe_u32 v115, v113, 2, 1
    v_lshl_or_b32 v114, v114, 1, v115
    v_bfe_u32 v115, v113, 3, 1
    v_and_b32 v113, 3, v113
    v_add_u32 v113, s57, v113
    v_mad_u32_u24 v113, v114, s58, v113
    v_mad_u32_u24 v113, v115, s59, v113
    v_lshl_add_u32 v114, v114, 1, v115
    v_add_u32 v114, s62, v114
    v_mul_u32_u24 v114, 43, v114
    v_lshrrev_b32 v114, 7, v114
    v_mad_u32_u24 v113, v114, s63, v113
    v_mul_u32_u24 v113, 1280, v113
    v_lshl_add_u32 v112, v112, 4, v113
    s_branch F_PK_E
F_PK_B7:
    v_add_u32 v96, 0, v124
    v_mul_u32_u24 v97, 4682, v96
    v_lshrrev_b32 v97, 16, v97
    v_mad_i32_i24 v96, v97, -14, v96
    v_lshrrev_b32 v98, 4, v97
    v_bfe_u32 v99, v97, 2, 1
    v_lshl_or_b32 v98, v98, 1, v99
    v_bfe_u32 v99, v97, 3, 1
    v_and_b32 v97, 3, v97
    v_add_u32 v97, s57, v97
    v_mad_u32_u24 v97, v98, s58, v97
    v_mad_u32_u24 v97, v99, s59, v97
    v_mul_u32_u24 v97, 3456, v97
    v_lshl_add_u32 v96, v96, 4, v97
    v_add_u32 v100, 64, v124
    v_mul_u32_u24 v101, 4682, v100
    v_lshrrev_b32 v101, 16, v101
    v_mad_i32_i24 v100, v101, -14, v100
    v_lshrrev_b32 v102, 4, v101
    v_bfe_u32 v103, v101, 2, 1
    v_lshl_or_b32 v102, v102, 1, v103
    v_bfe_u32 v103, v101, 3, 1
    v_and_b32 v101, 3, v101
    v_add_u32 v101, s57, v101
    v_mad_u32_u24 v101, v102, s58, v101
    v_mad_u32_u24 v101, v103, s59, v101
    v_mul_u32_u24 v101, 3456, v101
    v_lshl_add_u32 v100, v100, 4, v101
    v_add_u32 v104, 128, v124
    v_mul_u32_u24 v105, 4682, v104
    v_lshrrev_b32 v105, 16, v105
    v_mad_i32_i24 v104, v105, -14, v104
    v_lshrrev_b32 v106, 4, v105
    v_bfe_u32 v107, v105, 2, 1
    v_lshl_or_b32 v106, v106, 1, v107
    v_bfe_u32 v107, v105, 3, 1
    v_and_b32 v105, 3, v105
    v_add_u32 v105, s57, v105
    v_mad_u32_u24 v105, v106, s58, v105
    v_mad_u32_u24 v105, v107, s59, v105
    v_mul_u32_u24 v105, 3456, v105
    v_lshl_add_u32 v104, v104, 4, v105
    v_add_u32 v108, 192, v124
    v_mul_u32_u24 v109, 4682, v108
    v_lshrrev_b32 v109, 16, v109
    v_mad_i32_i24 v108, v109, -14, v108
    v_lshrrev_b32 v110, 4, v109
    v_bfe_u32 v111, v109, 2, 1
    v_lshl_or_b32 v110, v110, 1, v111
    v_bfe_u32 v111, v109, 3, 1
    v_and_b32 v109, 3, v109
    v_add_u32 v109, s57, v109
    v_mad_u32_u24 v109, v110, s58, v109
    v_mad_u32_u24 v109, v111, s59, v109
    v_mul_u32_u24 v109, 3456, v109
    v_lshl_add_u32 v108, v108, 4, v109
    v_add_u32 v112, 256, v124
    v_mul_u32_u24 v113, 4682, v112
    v_lshrrev_b32 v113, 16, v113
    v_mad_i32_i24 v112, v113, -14, v112
    v_lshrrev_b32 v114, 4, v113
    v_bfe_u32 v115, v113, 2, 1
    v_lshl_or_b32 v114, v114, 1, v115
    v_bfe_u32 v115, v113, 3, 1
    v_and_b32 v113, 3, v113
    v_add_u32 v113, s57, v113
    v_mad_u32_u24 v113, v114, s58, v113
    v_mad_u32_u24 v113, v115, s59, v113
    v_mul_u32_u24 v113, 3456, v113
    v_lshl_add_u32 v112, v112, 4, v113
    v_add_u32 v116, 320, v124
    v_mul_u32_u24 v117, 4682, v116
    v_lshrrev_b32 v117, 16, v117
    v_mad_i32_i24 v116, v117, -14, v116
    v_lshrrev_b32 v118, 4, v117
    v_bfe_u32 v119, v117, 2, 1
    v_lshl_or_b32 v118, v118, 1, v119
    v_bfe_u32 v119, v117, 3, 1
    v_and_b32 v117, 3, v117
    v_add_u32 v117, s57, v117
    v_mad_u32_u24 v117, v118, s58, v117
    v_mad_u32_u24 v117, v119, s59, v117
    v_mul_u32_u24 v117, 3456, v117
    v_lshl_add_u32 v116, v116, 4, v117
    v_add_u32 v120, 384, v124
    v_mul_u32_u24 v121, 4682, v120
    v_lshrrev_b32 v121, 16, v121
    v_mad_i32_i24 v120, v121, -14, v120
    v_lshrrev_b32 v122, 4, v121
    v_bfe_u32 v123, v121, 2, 1
    v_lshl_or_b32 v122, v122, 1, v123
    v_bfe_u32 v123, v121, 3, 1
    v_and_b32 v121, 3, v121
    v_add_u32 v121, s57, v121
    v_mad_u32_u24 v121, v122, s58, v121
    v_mad_u32_u24 v121, v123, s59, v121
    v_mul_u32_u24 v121, 3456, v121
    v_lshl_add_u32 v120, v120, 4, v121
F_PK_E:
    s_mul_i32 s52, s33, 7168
    v_lshlrev_b32 v16, 4, v124
    v_add_u32 v17, s52, v16
    v_lshrrev_b32 v2, 4, v124
    v_bfe_u32 v20, v124, 2, 2
    v_and_b32 v21, 1, v2
    v_lshl_add_u32 v21, v21, 2, v20
    v_lshrrev_b32 v22, 1, v2
    v_lshl_add_u32 v21, v22, 4, v21
    v_lshlrev_b32 v21, 2, v21
    v_and_b32 v22, 3, v124
    v_add_u32 v21, v21, v22
    s_lshl_b32 s53, s51, 3
    v_mul_u32_u24 v21, s53, v21
    v_add_u32 v15, s52, v21
    v_mov_b32 v12, 0x3f803f80
    s_cmp_lg_u32 s33, 0
    s_cbranch_scc1 F_GA_D
    s_and_b32 s22, s2, 127
    s_lshl_b32 s22, s22, 9
    s_add_u32 s22, s22, 27201536
    v_lshlrev_b32 v6, 3, v0
    v_mov_b32 v7, 0
    s_cmp_ge_u32 s3, 128
    s_cbranch_scc1 F_GA_G
    s_lshl_b32 s22, s3, 7
    s_add_u32 s22, s22, 27267072
    v_mov_b32 v6, 0
F_GA_G:
    s_movk_i32 s34, 0x80
F_GA:
    buffer_load_dwordx2 v[60:61], v7, s[28:31], 0 offen sc1
    buffer_load_dwordx2 v[4:5], v6, s[24:27], s22 offen sc1
    s_sub_u32 s34, s34, 1
    s_cbranch_scc1 F_GA_D
    s_waitcnt vmcnt(0)
    v_cmp_ne_u64 vcc, v[60:61], v[4:5]
    v_cmp_eq_u32 s[36:37], 0, v60
    s_nop 0
    s_or_b64 vcc, vcc, s[36:37]
    s_cbranch_vccnz F_GA
F_GA_D:
    s_waitcnt vmcnt(0)
    s_barrier
F_GA_E:
    s_cmp_eq_u32 s51, 7
    s_cbranch_scc1 F_PK_S7
    buffer_load_dwordx4 v[60:63], v96, s[44:47], s64 offen offset:160
    buffer_load_dwordx4 v[64:67], v100, s[44:47], s64 offen offset:160
    buffer_load_dwordx4 v[68:71], v104, s[44:47], s64 offen offset:160
    buffer_load_dwordx4 v[72:75], v108, s[44:47], s64 offen offset:160
    buffer_load_dwordx4 v[76:79], v112, s[44:47], s64 offen offset:160
    buffer_load_dwordx4 v[96:99], v96, s[44:47], s64 offen
    buffer_load_dwordx4 v[100:103], v100, s[44:47], s64 offen
    buffer_load_dwordx4 v[104:107], v104, s[44:47], s64 offen
    buffer_load_dwordx4 v[108:111], v108, s[44:47], s64 offen
    buffer_load_dwordx4 v[112:115], v112, s[44:47], s64 offen
    s_add_u32 s54, s50, s43
    v_and_b32 v13, 7, v124
    v_bfe_u32 v14, v124, 3, 1
    v_mul_u32_u24 v14, 6400, v14
    v_mul_u32_u24 v18, 80, v2
    v_lshl_add_u32 v14, v13, 4, v14
    v_add_u32 v14, v14, v18
    v_cmp_gt_u32 vcc, 5, v13
    s_add_u32 s55, s54, 4096
    s_mov_b32 s52, 0x1000100
    s_mov_b32 s53, s52
    s_waitcnt vmcnt(9)
    ds_write_b128 v17, v[60:63] offset:0
    s_waitcnt vmcnt(8)
    ds_write_b128 v17, v[64:67] offset:1024
    s_waitcnt vmcnt(7)
    ds_write_b128 v17, v[68:71] offset:2048
    s_waitcnt vmcnt(6)
    ds_write_b128 v17, v[72:75] offset:3072
    s_waitcnt vmcnt(5)
    ds_write_b128 v17, v[76:79] offset:4096
    s_waitcnt lgkmcnt(0)
    ds_read_b64_tr_b16 v[28:29], v15 offset:0
    ds_read_b64_tr_b16 v[30:31], v15 offset:1280
    ds_read_b64_tr_b16 v[32:33], v15 offset:8
    ds_read_b64_tr_b16 v[34:35], v15 offset:1288
    ds_read_b64_tr_b16 v[36:37], v15 offset:16
    ds_read_b64_tr_b16 v[38:39], v15 offset:1296
    ds_read_b64_tr_b16 v[40:41], v15 offset:24
    ds_read_b64_tr_b16 v[42:43], v15 offset:1304
    ds_read_b64_tr_b16 v[44:45], v15 offset:32
    ds_read_b64_tr_b16 v[46:47], v15 offset:1312
    v_cndmask_b32 v88, 0, v12, s[52:53]
    v_cndmask_b32 v89, 0, v12, s[52:53]
    v_cndmask_b32 v90, 0, v12, s[52:53]
    v_cndmask_b32 v91, 0, v12, s[52:53]
    s_waitcnt lgkmcnt(8)
    buffer_store_dwordx4 v[28:31], v16, s[24:27], s54 offen offset:0 sc1
    v_mfma_f32_16x16x32_bf16 v[8:11], v[28:31], v[88:91], 0
    s_lshl_b64 s[52:53], s[52:53], 1
    v_cndmask_b32 v92, 0, v12, s[52:53]
    v_cndmask_b32 v93, 0, v12, s[52:53]
    v_cndmask_b32 v94, 0, v12, s[52:53]
    v_cndmask_b32 v95, 0, v12, s[52:53]
    s_waitcnt lgkmcnt(6)
    buffer_store_dwordx4 v[32:35], v16, s[24:27], s54 offen offset:1024 sc1
    v_mfma_f32_16x16x32_bf16 v[8:11], v[32:35], v[92:95], v[8:11]
    s_lshl_b64 s[52:53], s[52:53], 1
    v_cndmask_b32 v88, 0, v12, s[52:53]
    v_cndmask_b32 v89, 0, v12, s[52:53]
    v_cndmask_b32 v90, 0, v12, s[52:53]
    v_cndmask_b32 v91, 0, v12, s[52:53]
    s_waitcnt lgkmcnt(4)
    buffer_store_dwordx4 v[36:39], v16, s[24:27], s54 offen offset:2048 sc1
    v_mfma_f32_16x16x32_bf16 v[8:11], v[36:39], v[88:91], v[8:11]
    s_lshl_b64 s[52:53], s[52:53], 1
    v_cndmask_b32 v92, 0, v12, s[52:53]
    v_cndmask_b32 v93, 0, v12, s[52:53]
    v_cndmask_b32 v94, 0, v12, s[52:53]
    v_cndmask_b32 v95, 0, v12, s[52:53]
    s_waitcnt lgkmcnt(2)
    buffer_store_dwordx4 v[40:43], v16, s[24:27], s54 offen offset:3072 sc1
    v_mfma_f32_16x16x32_bf16 v[8:11], v[40:43], v[92:95], v[8:11]
    s_lshl_b64 s[52:53], s[52:53], 1
    v_cndmask_b32 v88, 0, v12, s[52:53]
    v_cndmask_b32 v89, 0, v12, s[52:53]
    v_cndmask_b32 v90, 0, v12, s[52:53]
    v_cndmask_b32 v91, 0, v12, s[52:53]
    s_waitcnt lgkmcnt(0)
    buffer_store_dwordx4 v[44:47], v16, s[24:27], s55 offen offset:0 sc1
    v_mfma_f32_16x16x32_bf16 v[8:11], v[44:47], v[88:91], v[8:11]
    s_add_u32 s55, s50, 4096
    s_mov_b32 s52, 0x10001
    s_mov_b32 s53, s52
    s_waitcnt vmcnt(9)
    ds_write_b128 v17, v[96:99] offset:0
    s_waitcnt vmcnt(8)
    ds_write_b128 v17, v[100:103] offset:1024
    s_waitcnt vmcnt(7)
    ds_write_b128 v17, v[104:107] offset:2048
    s_waitcnt vmcnt(6)
    ds_write_b128 v17, v[108:111] offset:3072
    s_waitcnt vmcnt(5)
    ds_write_b128 v17, v[112:115] offset:4096
    s_waitcnt lgkmcnt(0)
    ds_read_b64_tr_b16 v[28:29], v15 offset:0
    ds_read_b64_tr_b16 v[30:31], v15 offset:1280
    ds_read_b64_tr_b16 v[32:33], v15 offset:8
    ds_read_b64_tr_b16 v[34:35], v15 offset:1288
    ds_read_b64_tr_b16 v[36:37], v15 offset:16
    ds_read_b64_tr_b16 v[38:39], v15 offset:1296
    ds_read_b64_tr_b16 v[40:41], v15 offset:24
    ds_read_b64_tr_b16 v[42:43], v15 offset:1304
    ds_read_b64_tr_b16 v[44:45], v15 offset:32
    ds_read_b64_tr_b16 v[46:47], v15 offset:1312
    v_cndmask_b32 v88, 0, v12, s[52:53]
    v_cndmask_b32 v89, 0, v12, s[52:53]
    v_cndmask_b32 v90, 0, v12, s[52:53]
    v_cndmask_b32 v91, 0, v12, s[52:53]
    s_waitcnt lgkmcnt(8)
    buffer_store_dwordx4 v[28:31], v16, s[24:27], s50 offen offset:0 sc1
    v_mfma_f32_16x16x32_bf16 v[8:11], v[28:31], v[88:91], v[8:11]
    s_lshl_b64 s[52:53], s[52:53], 1
    v_cndmask_b32 v92, 0, v12, s[52:53]
    v_cndmask_b32 v93, 0, v12, s[52:53]
    v_cndmask_b32 v94, 0, v12, s[52:53]
    v_cndmask_b32 v95, 0, v12, s[52:53]
    s_waitcnt lgkmcnt(6)
    buffer_store_dwordx4 v[32:35], v16, s[24:27], s50 offen offset:1024 sc1
    v_mfma_f32_16x16x32_bf16 v[8:11], v[32:35], v[92:95], v[8:11]
    s_lshl_b64 s[52:53], s[52:53], 1
    v_cndmask_b32 v88, 0, v12, s[52:53]
    v_cndmask_b32 v89, 0, v12, s[52:53]
    v_cndmask_b32 v90, 0, v12, s[52:53]
    v_cndmask_b32 v91, 0, v12, s[52:53]
    s_waitcnt lgkmcnt(4)
    buffer_store_dwordx4 v[36:39], v16, s[24:27], s50 offen offset:2048 sc1
    v_mfma_f32_16x16x32_bf16 v[8:11], v[36:39], v[88:91], v[8:11]
    s_lshl_b64 s[52:53], s[52:53], 1
    v_cndmask_b32 v92, 0, v12, s[52:53]
    v_cndmask_b32 v93, 0, v12, s[52:53]
    v_cndmask_b32 v94, 0, v12, s[52:53]
    v_cndmask_b32 v95, 0, v12, s[52:53]
    s_waitcnt lgkmcnt(2)
    buffer_store_dwordx4 v[40:43], v16, s[24:27], s50 offen offset:3072 sc1
    v_mfma_f32_16x16x32_bf16 v[8:11], v[40:43], v[92:95], v[8:11]
    s_lshl_b64 s[52:53], s[52:53], 1
    v_cndmask_b32 v88, 0, v12, s[52:53]
    v_cndmask_b32 v89, 0, v12, s[52:53]
    v_cndmask_b32 v90, 0, v12, s[52:53]
    v_cndmask_b32 v91, 0, v12, s[52:53]
    s_waitcnt lgkmcnt(0)
    buffer_store_dwordx4 v[44:47], v16, s[24:27], s55 offen offset:0 sc1
    v_mfma_f32_16x16x32_bf16 v[8:11], v[44:47], v[88:91], v[8:11]
    s_mov_b64 exec, vcc
    s_nop 6
    buffer_store_dwordx4 v[8:11], v14, s[24:27], s65 offen sc1
    s_branch F_PK_X
F_PK_S7:
    buffer_load_dwordx4 v[96:99], v96, s[44:47], s64 offen
    buffer_load_dwordx4 v[100:103], v100, s[44:47], s64 offen
    buffer_load_dwordx4 v[104:107], v104, s[44:47], s64 offen
    buffer_load_dwordx4 v[108:111], v108, s[44:47], s64 offen
    buffer_load_dwordx4 v[112:115], v112, s[44:47], s64 offen
    buffer_load_dwordx4 v[116:119], v116, s[44:47], s64 offen
    buffer_load_dwordx4 v[120:123], v120, s[44:47], s64 offen
    s_add_u32 s54, s50, s43
    v_and_b32 v13, 15, v124
    v_bfe_u32 v14, v124, 3, 1
    v_mul_u32_u24 v14, 6400, v14
    v_mul_u32_u24 v18, 112, v2
    v_lshl_add_u32 v14, v13, 4, v14
    v_add_u32 v14, v14, v18
    v_cmp_gt_u32 vcc, 7, v13
    s_add_u32 s55, s50, 4096
    s_mov_b32 s52, 0x10001
    s_mov_b32 s53, s52
    s_waitcnt vmcnt(6)
    ds_write_b128 v17, v[96:99] offset:0
    s_waitcnt vmcnt(5)
    ds_write_b128 v17, v[100:103] offset:1024
    s_waitcnt vmcnt(4)
    ds_write_b128 v17, v[104:107] offset:2048
    s_waitcnt vmcnt(3)
    ds_write_b128 v17, v[108:111] offset:3072
    s_waitcnt vmcnt(2)
    ds_write_b128 v17, v[112:115] offset:4096
    s_waitcnt vmcnt(1)
    ds_write_b128 v17, v[116:119] offset:5120
    s_waitcnt vmcnt(0)
    ds_write_b128 v17, v[120:123] offset:6144
    s_waitcnt lgkmcnt(0)
    ds_read_b64_tr_b16 v[28:29], v15 offset:0
    ds_read_b64_tr_b16 v[30:31], v15 offset:1792
    ds_read_b64_tr_b16 v[32:33], v15 offset:8
    ds_read_b64_tr_b16 v[34:35], v15 offset:1800
    ds_read_b64_tr_b16 v[36:37], v15 offset:16
    ds_read_b64_tr_b16 v[38:39], v15 offset:1808
    ds_read_b64_tr_b16 v[40:41], v15 offset:24
    ds_read_b64_tr_b16 v[42:43], v15 offset:1816
    ds_read_b64_tr_b16 v[44:45], v15 offset:32
    ds_read_b64_tr_b16 v[46:47], v15 offset:1824
    ds_read_b64_tr_b16 v[48:49], v15 offset:40
    ds_read_b64_tr_b16 v[50:51], v15 offset:1832
    ds_read_b64_tr_b16 v[52:53], v15 offset:48
    ds_read_b64_tr_b16 v[54:55], v15 offset:1840
    v_cndmask_b32 v88, 0, v12, s[52:53]
    v_cndmask_b32 v89, 0, v12, s[52:53]
    v_cndmask_b32 v90, 0, v12, s[52:53]
    v_cndmask_b32 v91, 0, v12, s[52:53]
    s_waitcnt lgkmcnt(12)
    buffer_store_dwordx4 v[28:31], v16, s[24:27], s50 offen offset:0 sc1
    v_mfma_f32_16x16x32_bf16 v[8:11], v[28:31], v[88:91], 0
    s_lshl_b64 s[52:53], s[52:53], 1
    v_cndmask_b32 v92, 0, v12, s[52:53]
    v_cndmask_b32 v93, 0, v12, s[52:53]
    v_cndmask_b32 v94, 0, v12, s[52:53]
    v_cndmask_b32 v95, 0, v12, s[52:53]
    s_waitcnt lgkmcnt(10)
    buffer_store_dwordx4 v[32:35], v16, s[24:27], s50 offen offset:1024 sc1
    v_mfma_f32_16x16x32_bf16 v[8:11], v[32:35], v[92:95], v[8:11]
    s_lshl_b64 s[52:53], s[52:53], 1
    v_cndmask_b32 v88, 0, v12, s[52:53]
    v_cndmask_b32 v89, 0, v12, s[52:53]
    v_cndmask_b32 v90, 0, v12, s[52:53]
    v_cndmask_b32 v91, 0, v12, s[52:53]
    s_waitcnt lgkmcnt(8)
    buffer_store_dwordx4 v[36:39], v16, s[24:27], s50 offen offset:2048 sc1
    v_mfma_f32_16x16x32_bf16 v[8:11], v[36:39], v[88:91], v[8:11]
    s_lshl_b64 s[52:53], s[52:53], 1
    v_cndmask_b32 v92, 0, v12, s[52:53]
    v_cndmask_b32 v93, 0, v12, s[52:53]
    v_cndmask_b32 v94, 0, v12, s[52:53]
    v_cndmask_b32 v95, 0, v12, s[52:53]
    s_waitcnt lgkmcnt(6)
    buffer_store_dwordx4 v[40:43], v16, s[24:27], s50 offen offset:3072 sc1
    v_mfma_f32_16x16x32_bf16 v[8:11], v[40:43], v[92:95], v[8:11]
    s_lshl_b64 s[52:53], s[52:53], 1
    v_cndmask_b32 v88, 0, v12, s[52:53]
    v_cndmask_b32 v89, 0, v12, s[52:53]
    v_cndmask_b32 v90, 0, v12, s[52:53]
    v_cndmask_b32 v91, 0, v12, s[52:53]
    s_waitcnt lgkmcnt(4)
    buffer_store_dwordx4 v[44:47], v16, s[24:27], s55 offen offset:0 sc1
    v_mfma_f32_16x16x32_bf16 v[8:11], v[44:47], v[88:91], v[8:11]
    s_lshl_b64 s[52:53], s[52:53], 1
    v_cndmask_b32 v92, 0, v12, s[52:53]
    v_cndmask_b32 v93, 0, v12, s[52:53]
    v_cndmask_b32 v94, 0, v12, s[52:53]
    v_cndmask_b32 v95, 0, v12, s[52:53]
    s_waitcnt lgkmcnt(2)
    buffer_store_dwordx4 v[48:51], v16, s[24:27], s55 offen offset:1024 sc1
    v_mfma_f32_16x16x32_bf16 v[8:11], v[48:51], v[92:95], v[8:11]
    s_lshl_b64 s[52:53], s[52:53], 1
    v_cndmask_b32 v88, 0, v12, s[52:53]
    v_cndmask_b32 v89, 0, v12, s[52:53]
    v_cndmask_b32 v90, 0, v12, s[52:53]
    v_cndmask_b32 v91, 0, v12, s[52:53]
    s_waitcnt lgkmcnt(0)
    buffer_store_dwordx4 v[52:55], v16, s[24:27], s55 offen offset:2048 sc1
    v_mfma_f32_16x16x32_bf16 v[8:11], v[52:55], v[88:91], v[8:11]
    s_mov_b64 exec, vcc
    s_nop 6
    buffer_store_dwordx4 v[8:11], v14, s[24:27], s65 offen sc1
F_PK_X:
    s_endpgm
F_TC:
    s_cmp_ge_u32 s3, 128
    s_cbranch_scc1 F_END
    s_getpc_b64 s[6:7]
F_GT:
    s_add_u32 s6, s6, g_kernel-F_GT
    s_addc_u32 s7, s7, 0
    s_lshr_b32 s53, s3, 3
    s_lshl_b32 s53, s53, 12
    v_and_b32 v3, 63, v0
    v_lshl_add_u32 v3, v3, 6, s53
    v_min_u32 v3, CODE_END-g_kernel-4, v3
    global_load_dword v3, v3, s[6:7]
    s_and_b32 s52, s3, 7
    s_lshl_b32 s52, s52, 4
    s_lshr_b32 s53, s3, 3
    s_add_u32 s52, s52, s53
    v_and_b32 v4, 63, v0
    v_lshlrev_b32 v4, 7, v4
    s_mul_i32 s53, s52, 1024
    s_add_u32 s53, s53, 17825792
    s_mov_b64 exec, 0xff
    buffer_load_dword v8, v4, s[24:27], s53 offen
    s_mov_b64 exec, -1
    s_waitcnt vmcnt(0)
F_END:
    s_endpgm
.globl g_kernel
.p2align 8
.type g_kernel,@function
g_kernel:
    s_cmp_ge_u32 s2, 256
    s_cbranch_scc1 G_END
    s_load_dwordx2 s[4:5], s[0:1], 112
    s_load_dwordx2 s[16:17], s[0:1], 96
    v_and_b32 v1, 63, v0
    v_lshrrev_b32 v2, 6, v0
    s_nop 0
    v_readfirstlane_b32 s20, v2
    v_lshrrev_b32 v2, 4, v1
    v_and_b32 v3, 15, v1
    v_lshlrev_b32 v4, 4, v1
    v_add_u32 v5, 0x1000, v4
    s_and_b32 s7, s2, 7
    s_lshr_b32 s8, s2, 3
    s_and_b32 s28, s8, 3
    s_lshl_b32 s21, s7, 2
    s_add_u32 s21, s21, s28
    s_lshr_b32 s22, s8, 2
    s_lshr_b32 s50, s8, 3
    v_bfe_u32 v6, v1, 1, 2
    v_bfe_u32 v7, v1, 4, 1
    v_xor_b32 v6, v6, v7
    v_lshlrev_b32 v6, 5, v6
    v_and_b32 v7, 1, v1
    v_lshl_or_b32 v6, v7, 4, v6
    v_lshrrev_b32 v7, 3, v1
    v_mul_u32_u24 v7, 4224, v7
    v_or_b32 v6, v7, v6
    v_xor_b32 v7, 64, v6
    s_mul_i32 s30, s20, 675840
    s_lshl_b32 s28, s21, 7
    s_add_u32 s30, s30, s28
    s_mul_i32 s31, s20, 36864
    s_add_u32 s31, s31, 15360
    s_mov_b32 s26, 27335680
    s_mov_b32 s27, 0x00020000
    s_getreg_b32 s6, hwreg(HW_REG_XCC_ID, 0, 4)
    s_add_u32 s6, s6, 1
    s_lshl_b32 s9, s7, 7
    s_add_u32 s9, s9, 27332608
    s_add_u32 s64, s9, s8
    v_mov_b32 v17, s6
    v_mov_b32 v18, 1073741824
    v_cmp_eq_u32 vcc, 0, v0
    s_nop 1
    v_cndmask_b32 v19, v18, v0, vcc
    s_mul_i32 s6, s6, 0x01010101
    s_mov_b32 s7, s6
    v_and_b32 v12, 3, v3
    v_lshlrev_b32 v12, 4, v12
    v_lshl_add_u32 v12, v2, 6, v12
    s_and_b32 s29, s50, 1
    s_add_u32 s28, s21, s29
    s_mul_i32 s32, s28, 5120
    s_mul_i32 s28, s20, 1280
    s_add_u32 s32, s32, s28
    s_mul_i32 s33, s22, 102400
    s_mul_i32 s28, s20, 25600
    s_add_u32 s33, s33, s28
    s_lshl_b32 s34, s22, 2
    s_add_u32 s34, s34, s20
    s_mul_i32 s34, s34, 1600
    s_sub_u32 s28, s32, s34
    s_add_u32 s28, s28, 18183168
    v_mov_b32 v16, 17960704
    v_mov_b32 v13, s28
    v_cmp_gt_u32 vcc, 16, v1
    s_nop 1
    v_cndmask_b32 v16, v16, v13, vcc
    v_add_u32 v16, v16, v4
    v_bfe_u32 v24, v1, 2, 2
    v_and_b32 v25, 3, v1
    v_lshrrev_b32 v8, 1, v24
    v_and_b32 v9, 1, v2
    v_lshl_or_b32 v8, v9, 1, v8
    v_xor_b32 v8, s20, v8
    v_lshlrev_b32 v8, 5, v8
    v_lshl_or_b32 v8, v25, 3, v8
    v_lshl_add_u32 v9, v2, 3, v24
    v_lshl_or_b32 v8, v9, 7, v8
    v_add_u32 v8, s31, v8
    v_xor_b32 v9, 32, v8
    v_xor_b32 v10, 64, v8
    v_xor_b32 v11, 96, v8
    v_mov_b32 v26, 0x3f803f80
    v_accvgpr_write_b32 a0, v26
    v_accvgpr_write_b32 a4, -1
    v_accvgpr_write_b32 a1, v26
    v_accvgpr_write_b32 a5, -1
    v_accvgpr_write_b32 a2, v26
    v_accvgpr_write_b32 a6, -1
    v_accvgpr_write_b32 a3, v26
    v_accvgpr_write_b32 a7, -1
    v_mul_u32_u24 v13, 80, v2
    v_add_u32 v13, s31, v13
    v_lshrrev_b32 v15, 1, v3
    v_min_u32 v15, 4, v15
    v_lshl_add_u32 v14, v15, 4, v13
    s_mov_b32 s18, 2621440
    s_mov_b32 s19, 0x00020000
    s_mov_b32 s49, 0x4000
    s_and_b32 s23, s8, 1
    s_lshl_b32 s51, s22, 1
    s_add_u32 s51, s51, s23
    s_mul_i32 s35, s51, 143360
    s_mul_i32 s28, s20, 35840
    s_add_u32 s35, s35, s28
    s_lshl_b32 s43, s51, 2
    s_add_u32 s43, s43, s20
    s_mul_i32 s43, s43, 2560
    s_lshl_b32 s53, s20, 10
    s_mul_i32 s28, s22, 276480
    s_mul_i32 s40, s20, 12
    s_mul_i32 s41, s23, 3
    s_add_u32 s41, s41, s40
    s_mul_i32 s42, s23, -3
    s_add_u32 s42, s42, s40
    s_add_u32 s42, s42, 3
    s_lshr_b32 s40, s20, 1
    s_mul_i32 s40, s40, 3
    s_and_b32 s46, s20, 1
    s_lshl_b32 s48, s46, 1
    s_add_u32 s48, s48, s40
    s_add_u32 s48, s48, 48
    s_add_u32 s40, s40, 49
    s_mul_i32 s36, s41, 5120
    s_add_u32 s36, s36, s28
    s_mul_i32 s37, s42, 5120
    s_add_u32 s37, s37, s28
    s_mul_i32 s38, s48, 5120
    s_add_u32 s38, s38, s28
    s_mul_i32 s39, s40, 5120
    s_add_u32 s39, s39, s28
    s_mul_i32 s28, s21, 221184
    s_lshl_b32 s40, s40, 10
    s_add_u32 s40, s40, s28
    s_lshl_b32 s41, s41, 10
    s_waitcnt lgkmcnt(0)
    s_mov_b32 s24, s4
    s_mov_b32 s25, s5
    buffer_store_byte v17, v19, s[24:27], s64 offen
    s_add_u32 s45, s30, 18354176
    s_add_u32 m0, s31, 0
    s_nop 0
    buffer_load_dwordx4 v6, s[24:27], s45 offen lds
    s_add_u32 s41, s41, s28
    s_lshl_b32 s42, s42, 10
    s_add_u32 s42, s42, s28
    s_lshl_b32 s48, s48, 10
    s_add_u32 s48, s48, s28
    v_lshrrev_b32 v30, 1, v2
    v_cmp_eq_u32 vcc, s46, v30
    s_nop 1
    v_cndmask_b32 v30, v18, v4, vcc
    s_xor_b32 s28, s20, 0
    s_mul_i32 s10, s28, 20480
    s_mul_i32 s14, s28, 55296
    s_xor_b32 s28, s20, 1
    s_mul_i32 s11, s28, 20480
    s_add_u32 s45, s30, 18387968
    s_add_u32 m0, s31, 1024
    s_nop 0
    buffer_load_dwordx4 v7, s[24:27], s45 offen lds
    s_mul_i32 s15, s28, 55296
    s_mul_i32 s28, s28, 36864
    s_add_u32 s28, s28, 15360
    v_add_u32 v21, s28, v4
    s_xor_b32 s28, s20, 2
    s_mul_i32 s12, s28, 20480
    s_mul_i32 s54, s28, 55296
    s_mul_i32 s28, s28, 36864
    s_add_u32 s28, s28, 15360
    v_add_u32 v22, s28, v4
    s_xor_b32 s28, s20, 3
    s_mul_i32 s13, s28, 20480
    s_mul_i32 s55, s28, 55296
    s_add_u32 s45, s30, 18421760
    s_add_u32 m0, s31, 2048
    s_nop 0
    buffer_load_dwordx4 v6, s[24:27], s45 offen lds
    s_mul_i32 s28, s28, 36864
    s_add_u32 s28, s28, 15360
    v_add_u32 v23, s28, v4
    v_add_u32 v20, s31, v4
    s_mul_i32 s52, s21, 81920
    s_mul_i32 s28, s20, 5120
    s_add_u32 s52, s52, s28
    s_lshr_b32 s65, s21, 2
    s_mul_i32 s65, s65, 256
    s_add_u32 s52, s52, s65
    s_and_b32 s46, s22, 1
    s_mul_i32 s28, s46, 80
    s_mul_i32 s3, s50, 36864
    s_add_u32 s45, s30, 18455552
    s_add_u32 m0, s31, 3072
    s_nop 0
    buffer_load_dwordx4 v7, s[24:27], s45 offen lds
    s_add_u32 s3, s3, 15360
    v_mul_u32_u24 v26, 20, v2
    v_add3_u32 v26, v26, v24, s28
    v_bfe_u32 v27, v26, 1, 1
    v_bfe_u32 v28, v26, 3, 1
    v_lshl_or_b32 v27, v28, 1, v27
    v_xor_b32 v27, s20, v27
    v_lshlrev_b32 v27, 5, v27
    v_lshl_or_b32 v27, v25, 3, v27
    v_lshl_or_b32 v27, v26, 7, v27
    v_add_u32 v32, s3, v27
    v_add_u32 v26, 4, v26
    v_bfe_u32 v27, v26, 1, 1
    s_add_u32 s45, s30, 18489344
    s_add_u32 m0, s31, 4096
    s_nop 0
    buffer_load_dwordx4 v6, s[24:27], s45 offen lds
    v_bfe_u32 v28, v26, 3, 1
    v_lshl_or_b32 v27, v28, 1, v27
    v_xor_b32 v27, s20, v27
    v_lshlrev_b32 v27, 5, v27
    v_lshl_or_b32 v27, v25, 3, v27
    v_lshl_or_b32 v27, v26, 7, v27
    v_add_u32 v33, s3, v27
    v_add_u32 v26, 4, v26
    v_bfe_u32 v27, v26, 1, 1
    v_bfe_u32 v28, v26, 3, 1
    v_lshl_or_b32 v27, v28, 1, v27
    v_xor_b32 v27, s20, v27
    v_lshlrev_b32 v27, 5, v27
    s_add_u32 s45, s30, 18523136
    s_add_u32 m0, s31, 5120
    s_nop 0
    buffer_load_dwordx4 v7, s[24:27], s45 offen lds
    v_lshl_or_b32 v27, v25, 3, v27
    v_lshl_or_b32 v27, v26, 7, v27
    v_add_u32 v34, s3, v27
    v_add_u32 v26, 4, v26
    v_bfe_u32 v27, v26, 1, 1
    v_bfe_u32 v28, v26, 3, 1
    v_lshl_or_b32 v27, v28, 1, v27
    v_xor_b32 v27, s20, v27
    v_lshlrev_b32 v27, 5, v27
    v_lshl_or_b32 v27, v25, 3, v27
    v_lshl_or_b32 v27, v26, 7, v27
    v_add_u32 v35, s3, v27
    v_add_u32 v26, 4, v26
    s_add_u32 s45, s30, 18556928
    s_add_u32 m0, s31, 6144
    s_nop 0
    buffer_load_dwordx4 v6, s[24:27], s45 offen lds
    v_bfe_u32 v27, v26, 1, 1
    v_bfe_u32 v28, v26, 3, 1
    v_lshl_or_b32 v27, v28, 1, v27
    v_xor_b32 v27, s20, v27
    v_lshlrev_b32 v27, 5, v27
    v_lshl_or_b32 v27, v25, 3, v27
    v_lshl_or_b32 v27, v26, 7, v27
    v_add_u32 v36, s3, v27
    s_mul_i32 s28, s20, 1280
    v_lshl_add_u32 v24, v3, 4, s28
    v_lshrrev_b32 v25, 2, v3
    v_cmp_eq_u32 vcc, v25, v2
    v_mov_b32 v25, 0x7f0000
    s_nop 0
    v_cndmask_b32 v24, v25, v24, vcc
    s_add_u32 s45, s30, 18590720
    s_add_u32 m0, s31, 7168
    s_nop 0
    buffer_load_dwordx4 v7, s[24:27], s45 offen lds
    v_and_b32 v25, 3, v3
    v_lshlrev_b32 v25, 2, v25
    v_lshl_add_u32 v25, v3, 4, v25
    v_add_u32 v25, s53, v25
    v_and_b32 v26, 1, v3
    v_lshl_add_u32 v26, s29, 1, v26
    v_lshlrev_b32 v27, 4, v26
    v_lshl_add_u32 v27, v2, 6, v27
    v_lshl_add_u32 v27, v15, 8, v27
    v_mul_u32_u24 v26, 20, v26
    v_add_u32 v26, 0x1000, v26
    v_cmp_gt_u32 vcc, 32, v1
    s_nop 1
    v_cndmask_b32 v25, v26, v25, vcc
    s_add_u32 s45, s32, 18182144
    s_add_u32 m0, s31, 33792
    s_nop 0
    buffer_load_dwordx4 v4, s[24:27], s45 offen lds
    v_add_u32 v28, s28, v12
    v_add_u32 v12, s31, v12
    s_lshr_b32 s28, s50, 1
    s_lshl_b32 s28, 1, s28
    s_sub_u32 s3, 0, s28
    s_cmp_eq_u32 s29, 0
    s_cselect_b32 s3, s28, s3
    s_lshl_b32 s28, s20, 4
    s_add_u32 s28, s28, s3
    v_add_u32 v37, s28, v3
    v_lshrrev_b32 v38, 4, v37
    v_mul_u32_u24 v38, 0x5000, v38
    v_and_b32 v39, 15, v37
    s_add_u32 s45, s34, 0
    s_add_u32 m0, s31, 34816
    s_nop 0
    buffer_load_dwordx4 v16, s[24:27], s45 offen lds
    v_lshl_add_u32 v38, v39, 4, v38
    v_lshl_add_u32 v38, v2, 8, v38
    v_cmp_gt_u32 vcc, 64, v37
    s_nop 1
    v_cndmask_b32 v29, v18, v38, vcc
    s_cmp_eq_u32 s29, 0
    s_cselect_b32 s28, -2, 64
    s_add_u32 s28, s28, s3
    s_cmp_eq_u32 s20, 0
    s_cselect_b32 s28, s28, 0x1000
    v_and_b32 v37, 1, v3
    v_add_u32 v37, s28, v37
    v_lshrrev_b32 v38, 4, v37
    v_mul_u32_u24 v38, 0x5000, v38
    s_add_u32 s45, s34, 17961728
    s_add_u32 m0, s31, 35840
    s_nop 0
    buffer_load_dwordx4 v4, s[24:27], s45 offen lds
    v_and_b32 v39, 15, v37
    v_lshl_add_u32 v38, v39, 4, v38
    v_lshl_add_u32 v38, v2, 8, v38
    v_cmp_gt_u32 vcc, 64, v37
    s_nop 1
    v_cndmask_b32 v31, v18, v38, vcc
    v_lshrrev_b32 v37, 1, v15
    v_lshlrev_b32 v37, 10, v37
    v_and_b32 v38, 1, v15
    v_lshl_add_u32 v37, v38, 3, v37
    s_lshl_b32 s28, s46, 11
    v_add_u32 v37, s28, v37
    s_lshl_b32 s3, s46, 3
    s_add_u32 s3, s3, 4096
    s_add_u32 s45, s30, 18624512
    s_add_u32 m0, s31, 8192
    s_nop 0
    buffer_load_dwordx4 v6, s[24:27], s45 offen lds
    v_mov_b32 v38, s3
    v_cmp_eq_u32 vcc, 4, v15
    s_nop 1
    v_cndmask_b32 v37, v37, v38, vcc
    v_add_u32 v31, v31, v37
    s_mul_i32 s66, s21, 81920
    s_add_u32 s65, s65, s66
    s_mul_i32 s66, s50, 5120
    s_add_u32 s65, s65, s66
    s_add_u32 s66, s65, s3
    s_add_u32 s3, s65, s28
    s_mul_i32 s28, s29, 31
    s_cmp_eq_u32 s28, s21
    s_cselect_b32 s29, 0, -1
    s_add_u32 s45, s30, 18658304
    s_add_u32 m0, s31, 9216
    s_nop 0
    buffer_load_dwordx4 v7, s[24:27], s45 offen lds
    s_add_u32 s67, s3, s10
    s_add_u32 s68, s66, s10
    s_mul_i32 s69, s21, 221184
    s_add_u32 s69, s69, s14
    s_xor_b32 s28, s21, 1
    s_mul_i32 s70, s28, 221184
    s_add_u32 s70, s70, s14
    s_mul_i32 s71, s51, 3072
    s_lshl_b32 s72, s21, 12
    s_add_u32 s72, s72, s53
    s_lshl_b32 s73, s50, 8
    s_lshl_b32 s28, s46, 3
    s_add_u32 s73, s73, s28
    s_add_u32 s45, s30, 18692096
    s_add_u32 m0, s31, 10240
    s_nop 0
    buffer_load_dwordx4 v6, s[24:27], s45 offen lds
    s_add_u32 s73, s73, s72
    s_mul_i32 s28, s51, 3
    v_add_u32 v17, s28, v2
    v_lshrrev_b32 v15, 1, v17
    v_lshlrev_b32 v15, 8, v15
    v_lshl_add_u32 v15, v3, 4, v15
    v_and_b32 v17, 1, v17
    v_lshl_add_u32 v15, v17, 3, v15
    v_cmp_gt_u32 vcc, 48, v1
    s_nop 1
    v_cndmask_b32 v15, v18, v15, vcc
    s_and_b32 s28, s8, 3
    s_lshl_b32 s28, s28, 3
    s_lshl_b32 s74, 1, s28
    s_add_u32 s45, s30, 18725888
    s_add_u32 m0, s31, 11264
    s_nop 0
    buffer_load_dwordx4 v7, s[24:27], s45 offen lds
    s_and_b32 s28, s28, 16
    s_lshl_b32 s8, 0x101, s28
    v_mov_b32 v17, 1
    s_waitcnt vmcnt(11)
    ds_read_b64_tr_b16 a[48:49], v8 offset:0
    ds_read_b64_tr_b16 a[50:51], v8 offset:512
    ds_read_b64_tr_b16 a[52:53], v9 offset:0
    ds_read_b64_tr_b16 a[54:55], v9 offset:512
    ds_read_b64_tr_b16 a[56:57], v10 offset:0
    ds_read_b64_tr_b16 a[58:59], v10 offset:512
    s_add_u32 s45, s30, 18759680
    s_add_u32 m0, s31, 12288
    s_nop 0
    buffer_load_dwordx4 v6, s[24:27], s45 offen lds
    ds_read_b64_tr_b16 a[60:61], v11 offset:0
    ds_read_b64_tr_b16 a[62:63], v11 offset:512
    s_add_u32 s45, s30, 18793472
    s_add_u32 m0, s31, 13312
    s_nop 0
    buffer_load_dwordx4 v7, s[24:27], s45 offen lds
    s_waitcnt vmcnt(9)
    ds_read_b64_tr_b16 a[64:65], v8 offset:4096
    ds_read_b64_tr_b16 a[66:67], v8 offset:4608
    ds_read_b64_tr_b16 a[68:69], v9 offset:4096
    ds_read_b64_tr_b16 a[70:71], v9 offset:4608
    s_add_u32 s45, s30, 18827264
    s_add_u32 m0, s31, 14336
    s_nop 0
    buffer_load_dwordx4 v6, s[24:27], s45 offen lds
    ds_read_b64_tr_b16 a[72:73], v10 offset:4096
    ds_read_b64_tr_b16 a[74:75], v10 offset:4608
    ds_read_b64_tr_b16 a[76:77], v11 offset:4096
    ds_read_b64_tr_b16 a[78:79], v11 offset:4608
    s_add_u32 s45, s30, 18861056
    s_add_u32 m0, s31, 15360
    s_nop 0
    buffer_load_dwordx4 v7, s[24:27], s45 offen lds
    s_add_u32 s45, s30, 18894848
    s_add_u32 m0, s31, 16384
    s_nop 0
    buffer_load_dwordx4 v6, s[24:27], s45 offen lds
    s_add_u32 s45, s30, 18928640
    s_add_u32 m0, s31, 17408
    s_nop 0
    buffer_load_dwordx4 v7, s[24:27], s45 offen lds
    s_add_u32 s45, s30, 18962432
    s_add_u32 m0, s31, 18432
    s_nop 0
    buffer_load_dwordx4 v6, s[24:27], s45 offen lds
    s_add_u32 s45, s30, 18996224
    s_add_u32 m0, s31, 19456
    s_nop 0
    buffer_load_dwordx4 v7, s[24:27], s45 offen lds
    s_add_u32 s45, s33, 21057536
    buffer_load_dwordx4 a[80:83], v4, s[24:27], s45 offen
    s_waitcnt vmcnt(9)
    ds_read_b64_tr_b16 a[84:85], v8 offset:8192
    ds_read_b64_tr_b16 a[86:87], v8 offset:8704
    ds_read_b64_tr_b16 a[88:89], v9 offset:8192
    ds_read_b64_tr_b16 a[90:91], v9 offset:8704
    buffer_load_dwordx4 a[92:95], v5, s[24:27], s45 offen offset:1024
    ds_read_b64_tr_b16 a[96:97], v10 offset:8192
    ds_read_b64_tr_b16 a[98:99], v10 offset:8704
    ds_read_b64_tr_b16 a[100:101], v11 offset:8192
    ds_read_b64_tr_b16 a[102:103], v11 offset:8704
    ds_read_b128 a[104:107], v12 offset:33792
    ds_read_b128 a[108:111], v12 offset:34048
    ds_read_b128 a[112:115], v12 offset:34304
    ds_read_b128 a[116:119], v12 offset:34560
    ds_read_b128 a[120:123], v12 offset:34816
    ds_read_b128 v[40:43], v20 offset:35072
    ds_read_b128 v[44:47], v20 offset:35392
    ds_read_b128 v[48:51], v20 offset:35712
    ds_read_b128 v[52:55], v20 offset:36032
    ds_read_b128 v[56:59], v20 offset:36352
    s_waitcnt lgkmcnt(15)
    v_mfma_f32_16x16x32_bf16 a[8:11], a[48:51], a[48:51], 0
    v_mfma_f32_16x16x32_bf16 a[12:15], a[0:3], a[48:51], 0
    s_add_u32 s45, s33, 21067776
    buffer_load_dwordx4 a[124:127], v4, s[24:27], s45 offen
    v_mfma_f32_16x16x32_bf16 a[16:19], a[52:55], a[52:55], 0
    v_mfma_f32_16x16x32_bf16 a[20:23], a[0:3], a[52:55], 0
    v_mfma_f32_16x16x32_bf16 a[24:27], a[56:59], a[56:59], 0
    v_mfma_f32_16x16x32_bf16 a[28:31], a[0:3], a[56:59], 0
    buffer_load_dwordx4 a[128:131], v5, s[24:27], s45 offen offset:1024
    v_mfma_f32_16x16x32_bf16 a[32:35], a[60:63], a[60:63], 0
    v_mfma_f32_16x16x32_bf16 a[36:39], a[0:3], a[60:63], 0
    s_waitcnt lgkmcnt(9)
    v_mfma_f32_16x16x32_bf16 a[40:43], a[104:107], a[104:107], 0
    v_mfma_f32_16x16x32_bf16 a[44:47], a[0:3], a[104:107], 0
    s_add_u32 s45, s33, 21078016
    buffer_load_dwordx4 a[132:135], v4, s[24:27], s45 offen
    v_mfma_f32_16x16x32_bf16 a[8:11], a[64:67], a[64:67], a[8:11]
    v_mfma_f32_16x16x32_bf16 a[12:15], a[0:3], a[64:67], a[12:15]
    v_mfma_f32_16x16x32_bf16 a[16:19], a[68:71], a[68:71], a[16:19]
    v_mfma_f32_16x16x32_bf16 a[20:23], a[0:3], a[68:71], a[20:23]
    s_add_u32 s45, s33, 21058560
    buffer_load_dwordx4 a[136:139], v4, s[24:27], s45 offen
    v_mfma_f32_16x16x32_bf16 a[24:27], a[72:75], a[72:75], a[24:27]
    v_mfma_f32_16x16x32_bf16 a[28:31], a[0:3], a[72:75], a[28:31]
    v_mfma_f32_16x16x32_bf16 a[32:35], a[76:79], a[76:79], a[32:35]
    v_mfma_f32_16x16x32_bf16 a[36:39], a[0:3], a[76:79], a[36:39]
    buffer_load_dwordx4 a[140:143], v5, s[24:27], s45 offen offset:1024
    s_waitcnt lgkmcnt(8)
    v_mfma_f32_16x16x32_bf16 a[40:43], a[108:111], a[108:111], a[40:43]
    v_mfma_f32_16x16x32_bf16 a[44:47], a[0:3], a[108:111], a[44:47]
    s_waitcnt vmcnt(11)
    ds_read_b64_tr_b16 a[144:145], v8 offset:12288
    ds_read_b64_tr_b16 a[146:147], v8 offset:12800
    ds_read_b64_tr_b16 a[148:149], v9 offset:12288
    ds_read_b64_tr_b16 a[150:151], v9 offset:12800
    s_add_u32 s45, s33, 21068800
    buffer_load_dwordx4 a[152:155], v4, s[24:27], s45 offen
    ds_read_b64_tr_b16 a[156:157], v10 offset:12288
    ds_read_b64_tr_b16 a[158:159], v10 offset:12800
    ds_read_b64_tr_b16 a[160:161], v11 offset:12288
    ds_read_b64_tr_b16 a[162:163], v11 offset:12800
    s_waitcnt lgkmcnt(11)
    v_pk_add_f32 v[40:41], v[40:41], v[44:45]
    v_pk_add_f32 v[42:43], v[42:43], v[46:47]
    s_waitcnt lgkmcnt(9)
    v_pk_add_f32 v[48:49], v[48:49], v[52:53]
    v_pk_add_f32 v[50:51], v[50:51], v[54:55]
    s_waitcnt lgkmcnt(8)
    v_pk_add_f32 v[40:41], v[40:41], v[56:57]
    v_pk_add_f32 v[42:43], v[42:43], v[58:59]
    v_pk_add_f32 v[40:41], v[40:41], v[48:49]
    v_pk_add_f32 v[42:43], v[42:43], v[50:51]
    ds_write_b128 v20, v[40:43] offset:35072
    s_load_dwordx8 s[56:63], s[24:25], s9
    v_mfma_f32_16x16x32_bf16 a[8:11], a[84:87], a[84:87], a[8:11]
    v_mfma_f32_16x16x32_bf16 a[12:15], a[0:3], a[84:87], a[12:15]
    buffer_load_dwordx4 a[164:167], v5, s[24:27], s45 offen offset:1024
    v_mfma_f32_16x16x32_bf16 a[16:19], a[88:91], a[88:91], a[16:19]
    v_mfma_f32_16x16x32_bf16 a[20:23], a[0:3], a[88:91], a[20:23]
    v_mfma_f32_16x16x32_bf16 a[24:27], a[96:99], a[96:99], a[24:27]
    v_mfma_f32_16x16x32_bf16 a[28:31], a[0:3], a[96:99], a[28:31]
    s_add_u32 s45, s33, 21079040
    buffer_load_dwordx4 a[168:171], v4, s[24:27], s45 offen
    v_mfma_f32_16x16x32_bf16 a[32:35], a[100:103], a[100:103], a[32:35]
    v_mfma_f32_16x16x32_bf16 a[36:39], a[0:3], a[100:103], a[36:39]
    v_mfma_f32_16x16x32_bf16 a[40:43], a[112:115], a[112:115], a[40:43]
    v_mfma_f32_16x16x32_bf16 a[44:47], a[0:3], a[112:115], a[44:47]
    s_add_u32 s45, s33, 21059584
    buffer_load_dwordx4 a[172:175], v4, s[24:27], s45 offen
    s_waitcnt vmcnt(11)
    ds_read_b64_tr_b16 a[176:177], v8 offset:16384
    ds_read_b64_tr_b16 a[178:179], v8 offset:16896
    ds_read_b64_tr_b16 a[180:181], v9 offset:16384
    ds_read_b64_tr_b16 a[182:183], v9 offset:16896
    ds_read_b64_tr_b16 a[184:185], v10 offset:16384
    ds_read_b64_tr_b16 a[186:187], v10 offset:16896
    buffer_load_dwordx4 a[188:191], v5, s[24:27], s45 offen offset:1024
    ds_read_b64_tr_b16 a[192:193], v11 offset:16384
    ds_read_b64_tr_b16 a[194:195], v11 offset:16896
    s_waitcnt lgkmcnt(15)
    v_mfma_f32_16x16x32_bf16 a[8:11], a[144:147], a[144:147], a[8:11]
    v_mfma_f32_16x16x32_bf16 a[12:15], a[0:3], a[144:147], a[12:15]
    s_waitcnt lgkmcnt(13)
    v_mfma_f32_16x16x32_bf16 a[16:19], a[148:151], a[148:151], a[16:19]
    v_mfma_f32_16x16x32_bf16 a[20:23], a[0:3], a[148:151], a[20:23]
    s_add_u32 s45, s33, 21069824
    buffer_load_dwordx4 a[196:199], v4, s[24:27], s45 offen
    s_waitcnt lgkmcnt(11)
    v_mfma_f32_16x16x32_bf16 a[24:27], a[156:159], a[156:159], a[24:27]
    v_mfma_f32_16x16x32_bf16 a[28:31], a[0:3], a[156:159], a[28:31]
    s_waitcnt lgkmcnt(9)
    v_mfma_f32_16x16x32_bf16 a[32:35], a[160:163], a[160:163], a[32:35]
    v_mfma_f32_16x16x32_bf16 a[36:39], a[0:3], a[160:163], a[36:39]
    buffer_load_dwordx4 a[200:203], v5, s[24:27], s45 offen offset:1024
    v_mfma_f32_16x16x32_bf16 a[40:43], a[116:119], a[116:119], a[40:43]
    v_mfma_f32_16x16x32_bf16 a[44:47], a[0:3], a[116:119], a[44:47]
    s_waitcnt lgkmcnt(6)
    v_mfma_f32_16x16x32_bf16 a[8:11], a[176:179], a[176:179], a[8:11]
    v_mfma_f32_16x16x32_bf16 a[12:15], a[0:3], a[176:179], a[12:15]
    s_add_u32 s45, s33, 21080064
    buffer_load_dwordx4 a[204:207], v4, s[24:27], s45 offen
    s_waitcnt lgkmcnt(4)
    v_mfma_f32_16x16x32_bf16 a[16:19], a[180:183], a[180:183], a[16:19]
    v_mfma_f32_16x16x32_bf16 a[20:23], a[0:3], a[180:183], a[20:23]
    s_waitcnt lgkmcnt(2)
    v_mfma_f32_16x16x32_bf16 a[24:27], a[184:187], a[184:187], a[24:27]
    v_mfma_f32_16x16x32_bf16 a[28:31], a[0:3], a[184:187], a[28:31]
    s_add_u32 s45, s33, 21060608
    buffer_load_dwordx4 a[208:211], v4, s[24:27], s45 offen
    s_waitcnt lgkmcnt(0)
    v_mfma_f32_16x16x32_bf16 a[32:35], a[192:195], a[192:195], a[32:35]
    v_mfma_f32_16x16x32_bf16 a[36:39], a[0:3], a[192:195], a[36:39]
    v_mfma_f32_16x16x32_bf16 a[40:43], a[120:123], a[120:123], a[40:43]
    v_mfma_f32_16x16x32_bf16 a[44:47], a[0:3], a[120:123], a[44:47]
    buffer_load_dwordx4 a[212:215], v5, s[24:27], s45 offen offset:1024
    s_waitcnt lgkmcnt(0)
    s_xor_b64 s[56:57], s[56:57], s[6:7]
    s_xor_b64 s[58:59], s[58:59], s[6:7]
    s_xor_b64 s[60:61], s[60:61], s[6:7]
    s_xor_b64 s[62:63], s[62:63], s[6:7]
    v_mov_b32 v9, v4
    v_mov_b32 v10, v15
    v_cmp_gt_u32 vcc, 16, v1
    s_nop 1
    v_cndmask_b32 v11, v18, v4, vcc
    s_or_b64 s[56:57], s[56:57], s[58:59]
    s_or_b64 s[60:61], s[60:61], s[62:63]
    s_or_b64 s[56:57], s[56:57], s[60:61]
    s_cselect_b32 s47, 0, 1
    s_cbranch_scc1 G_SE
G_SE_R:
    s_waitcnt vmcnt(16)
    v_mfma_f32_16x16x32_bf16 a[216:219], a[80:83], a[52:55], 0
    s_add_u32 s44, s67, 0
    buffer_store_dwordx4 a[4:7], v9, s[24:27], s44 offen
    v_mfma_f32_16x16x32_bf16 a[220:223], a[80:83], a[56:59], 0
    v_mfma_f32_16x16x32_bf16 a[224:227], a[80:83], a[60:63], 0
    v_xor_b32 v8, 0, v24
    ds_write_b128 v8, a[8:11]
    ds_write_b128 v8, a[12:15] offset:5120
    buffer_store_dwordx4 a[4:7], v9, s[24:27], s44 offen offset:1024
    v_mfma_f32_16x16x32_bf16 a[228:231], a[80:83], a[104:107], 0
    v_mfma_f32_16x16x32_bf16 v[124:127], a[80:83], a[48:51], 0
    v_xor_b32 v8, 1024, v24
    ds_write_b128 v8, a[16:19]
    ds_write_b128 v8, a[20:23] offset:5120
    s_add_u32 s44, s68, 0
    buffer_store_dwordx2 a[4:5], v9, s[24:27], s44 offen
    s_waitcnt vmcnt(18)
    v_mfma_f32_16x16x32_bf16 a[216:219], a[92:95], a[68:71], a[216:219]
    v_mfma_f32_16x16x32_bf16 a[220:223], a[92:95], a[72:75], a[220:223]
    v_xor_b32 v8, 2048, v24
    ds_write_b128 v8, a[24:27]
    ds_write_b128 v8, a[28:31] offset:5120
    s_add_u32 s45, s33, 21070848
    buffer_load_dwordx4 a[232:235], v4, s[24:27], s45 offen
    v_mfma_f32_16x16x32_bf16 a[224:227], a[92:95], a[76:79], a[224:227]
    v_mfma_f32_16x16x32_bf16 a[228:231], a[92:95], a[108:111], a[228:231]
    v_xor_b32 v8, 3072, v24
    ds_write_b128 v8, a[32:35]
    ds_write_b128 v8, a[36:39] offset:5120
    buffer_load_dwordx4 a[236:239], v5, s[24:27], s45 offen offset:1024
    v_mfma_f32_16x16x32_bf16 v[124:127], a[92:95], a[64:67], v[124:127]
    s_waitcnt vmcnt(19)
    v_mfma_f32_16x16x32_bf16 a[216:219], a[124:127], a[88:91], a[216:219]
    v_and_b32 v8, 0x7f03ff, v24
    v_or_b32 v8, 0x1000, v8
    ds_write_b128 v8, a[40:43]
    ds_write_b128 v8, a[44:47] offset:5120
    s_add_u32 s45, s33, 21081088
    buffer_load_dwordx4 a[240:243], v4, s[24:27], s45 offen
    v_mfma_f32_16x16x32_bf16 a[220:223], a[124:127], a[96:99], a[220:223]
    v_mfma_f32_16x16x32_bf16 a[224:227], a[124:127], a[100:103], a[224:227]
    s_waitcnt lgkmcnt(0)
    s_barrier
    s_add_u32 s45, s33, 21061632
    buffer_load_dwordx4 a[244:247], v4, s[24:27], s45 offen
    v_mfma_f32_16x16x32_bf16 a[228:231], a[124:127], a[112:115], a[228:231]
    ds_read_b128 v[60:63], v21 offset:35072
    v_mfma_f32_16x16x32_bf16 v[124:127], a[124:127], a[84:87], v[124:127]
    ds_read_b128 v[64:67], v22 offset:35072
    s_waitcnt vmcnt(20)
    v_mfma_f32_16x16x32_bf16 a[216:219], a[128:131], a[148:151], a[216:219]
    ds_read_b128 v[68:71], v23 offset:35072
    v_mfma_f32_16x16x32_bf16 a[220:223], a[128:131], a[156:159], a[220:223]
    ds_read2st64_b32 v[80:81], v25 offset0:0 offset1:20
    buffer_load_dwordx4 a[248:251], v5, s[24:27], s45 offen offset:1024
    v_mfma_f32_16x16x32_bf16 a[224:227], a[128:131], a[160:163], a[224:227]
    ds_read2st64_b32 v[82:83], v25 offset0:1 offset1:21
    v_mfma_f32_16x16x32_bf16 a[228:231], a[128:131], a[116:119], a[228:231]
    ds_read2st64_b32 v[84:85], v25 offset0:2 offset1:22
    s_waitcnt lgkmcnt(5)
    v_add_f32 v40, v40, v60
    v_add_f32 v41, v41, v61
    v_mfma_f32_16x16x32_bf16 v[124:127], a[128:131], a[144:147], v[124:127]
    ds_read2st64_b32 v[86:87], v25 offset0:3 offset1:23
    v_add_f32 v42, v42, v62
    v_add_f32 v43, v43, v63
    s_add_u32 s45, s33, 21071872
    buffer_load_dwordx4 a[252:255], v4, s[24:27], s45 offen
    s_waitcnt vmcnt(21)
    v_mfma_f32_16x16x32_bf16 a[216:219], a[132:135], a[180:183], a[216:219]
    ds_read_b64_tr_b16 v[96:97], v32
    s_waitcnt lgkmcnt(5)
    v_add_f32 v64, v64, v68
    v_add_f32 v65, v65, v69
    v_mfma_f32_16x16x32_bf16 a[220:223], a[132:135], a[184:187], a[220:223]
    ds_read_b64_tr_b16 v[98:99], v33
    v_add_f32 v66, v66, v70
    v_add_f32 v67, v67, v71
    v_mfma_f32_16x16x32_bf16 a[224:227], a[132:135], a[192:195], a[224:227]
    ds_read_b64_tr_b16 v[100:101], v34
    v_add_f32 v40, v40, v64
    v_add_f32 v41, v41, v65
    buffer_load_dwordx4 a[80:83], v5, s[24:27], s45 offen offset:1024
    v_mfma_f32_16x16x32_bf16 a[228:231], a[132:135], a[120:123], a[228:231]
    ds_read_b64_tr_b16 v[102:103], v35
    v_add_f32 v42, v42, v66
    v_add_f32 v43, v43, v67
    v_mfma_f32_16x16x32_bf16 v[124:127], a[132:135], a[176:179], v[124:127]
    ds_read_b64_tr_b16 v[104:105], v36
    s_waitcnt lgkmcnt(6)
    v_add_f32 v80, v80, v84
    v_add_f32 v81, v81, v85
    s_waitcnt vmcnt(21)
    v_mfma_f32_16x16x32_bf16 a[92:95], a[136:139], a[52:55], 0
    ds_write_b128 v20, v[40:43] offset:35840
    s_waitcnt lgkmcnt(6)
    v_add_f32 v82, v82, v86
    v_add_f32 v83, v83, v87
    s_add_u32 s45, s33, 21082112
    buffer_load_dwordx4 a[16:19], v4, s[24:27], s45 offen
    v_mfma_f32_16x16x32_bf16 a[0:3], a[136:139], a[56:59], 0
    ds_read_b128 v[40:43], v13 offset:35840
    v_add_f32 v80, v80, v82
    v_add_f32 v81, v81, v83
    v_mfma_f32_16x16x32_bf16 a[8:11], a[136:139], a[60:63], 0
    ds_read_b128 v[60:63], v13 offset:35856
    v_mul_f32 v81, 0x3acccccd, v81
    v_mul_f32 v80, 0x3acccccd, v80
    s_add_u32 s45, s33, 21876736
    buffer_load_dwordx4 a[20:23], v4, s[24:27], s45 offen
    v_mfma_f32_16x16x32_bf16 a[12:15], a[136:139], a[104:107], 0
    ds_read_b128 v[64:67], v13 offset:35872
    v_fma_f32 v80, -v81, v81, v80
    v_max_f32 v80, 0, v80
    v_mfma_f32_16x16x32_bf16 v[44:47], a[136:139], a[48:51], 0
    ds_read_b128 v[68:71], v13 offset:35888
    v_mov_b32 v82, v81
    v_cvt_pk_bf16_f32 v82, v82, v82
    s_waitcnt vmcnt(22)
    v_mfma_f32_16x16x32_bf16 a[92:95], a[140:143], a[68:71], a[92:95]
    ds_read_b128 v[72:75], v13 offset:35904
    v_lshlrev_b32 v82, 16, v82
    v_mov_b32 v83, v80
    buffer_load_dwordx4 a[24:27], v4, s[24:27], s45 offen offset:1024
    v_mfma_f32_16x16x32_bf16 a[0:3], a[140:143], a[72:75], a[0:3]
    ds_read_b128 v[76:79], v14 offset:35840
    v_cvt_pk_bf16_f32 v83, v83, v83
    v_lshlrev_b32 v83, 16, v83
    v_mfma_f32_16x16x32_bf16 a[8:11], a[140:143], a[76:79], a[8:11]
    ds_write_b128 v20, a[216:219] offset:21504
    v_add_f32 v83, 0x3727c5ac, v83
    v_cvt_pk_bf16_f32 v83, v83, v83
    v_mfma_f32_16x16x32_bf16 a[12:15], a[140:143], a[108:111], a[12:15]
    v_lshlrev_b32 v83, 16, v83
    v_sqrt_f32 v83, v83
    buffer_load_dwordx4 a[28:31], v4, s[24:27], s45 offen offset:2048
    v_mfma_f32_16x16x32_bf16 v[44:47], a[140:143], a[64:67], v[44:47]
    v_cvt_pk_bf16_f32 v83, v83, v83
    v_lshlrev_b32 v83, 16, v83
    s_waitcnt vmcnt(23)
    v_mfma_f32_16x16x32_bf16 a[92:95], a[152:155], a[88:91], a[92:95]
    ds_write_b128 v20, a[220:223] offset:22528
    v_rcp_f32 v83, v83
    v_mfma_f32_16x16x32_bf16 a[0:3], a[152:155], a[96:99], a[0:3]
    v_sub_f32 v84, v81, v82
    v_mul_f32 v84, v84, v83
    buffer_load_dwordx4 a[32:35], v4, s[24:27], s45 offen offset:3072
    v_mfma_f32_16x16x32_bf16 a[8:11], a[152:155], a[100:103], a[8:11]
    v_cvt_pk_bf16_f32 v84, v84, v84
    v_lshlrev_b32 v84, 16, v84
    v_mfma_f32_16x16x32_bf16 a[12:15], a[152:155], a[112:115], a[12:15]
    ds_write_b128 v20, a[224:227] offset:23552
    v_mul_f32 v85, v80, v83
    v_mul_f32 v85, v85, v83
    v_mfma_f32_16x16x32_bf16 v[44:47], a[152:155], a[84:87], v[44:47]
    v_cvt_pk_bf16_f32 v85, v85, v85
    v_lshlrev_b32 v85, 16, v85
    buffer_load_dwordx4 a[36:39], v5, s[24:27], s45 offen
    s_waitcnt vmcnt(24)
    v_mfma_f32_16x16x32_bf16 a[92:95], a[164:167], a[148:151], a[92:95]
    v_add_f32 v85, 0x3727c5ac, v85
    v_cvt_pk_bf16_f32 v85, v85, v85
    v_mfma_f32_16x16x32_bf16 a[0:3], a[164:167], a[156:159], a[0:3]
    ds_write_b128 v28, a[228:231] offset:10240
    v_lshlrev_b32 v85, 16, v85
    v_sqrt_f32 v85, v85
    v_mfma_f32_16x16x32_bf16 a[8:11], a[164:167], a[160:163], a[8:11]
    v_cvt_pk_bf16_f32 v85, v85, v85
    v_lshlrev_b32 v85, 16, v85
    v_mfma_f32_16x16x32_bf16 a[12:15], a[164:167], a[116:119], a[12:15]
    v_rcp_f32 v85, v85
    buffer_load_dwordx4 a[40:43], v5, s[24:27], s45 offen offset:1024
    v_mfma_f32_16x16x32_bf16 v[44:47], a[164:167], a[144:147], v[44:47]
    v_mul_f32 v86, v83, v85
    v_mul_f32 v108, 0xc0135761, v86
    s_waitcnt vmcnt(24)
    v_mfma_f32_16x16x32_bf16 a[92:95], a[168:171], a[180:183], a[92:95]
    v_mul_f32 v110, v86, v86
    v_mul_f32 v110, v110, v86
    v_mfma_f32_16x16x32_bf16 a[0:3], a[168:171], a[184:187], a[0:3]
    v_mul_f32 v110, 0xbdd2d3e8, v110
    v_rcp_f32 v116, v86
    v_mfma_f32_16x16x32_bf16 a[8:11], a[168:171], a[192:195], a[8:11]
    v_rcp_f32 v118, v83
    buffer_load_dwordx4 a[44:47], v5, s[24:27], s45 offen offset:2048
    v_mfma_f32_16x16x32_bf16 a[12:15], a[168:171], a[120:123], a[12:15]
    v_fma_f32 v118, -v84, v118, -v82
    v_mov_b32 v106, v82
    v_mfma_f32_16x16x32_bf16 v[44:47], a[168:171], a[176:179], v[44:47]
    v_mov_b32 v107, v83
    v_mov_b32 v112, v108
    s_waitcnt vmcnt(24)
    v_mfma_f32_16x16x32_bf16 a[124:127], a[172:175], a[52:55], 0
    v_mov_b32 v114, v110
    v_mov_b32 v120, v116
    v_mfma_f32_16x16x32_bf16 a[128:131], a[172:175], a[56:59], 0
    ds_write_b128 v20, a[92:95] offset:24576
    v_mov_b32 v122, v118
    v_permlane32_swap_b32 v108, v112
    buffer_load_dwordx4 a[140:143], v5, s[24:27], s45 offen offset:3072
    v_mfma_f32_16x16x32_bf16 a[132:135], a[172:175], a[60:63], 0
    v_permlane32_swap_b32 v110, v114
    v_permlane32_swap_b32 v116, v120
    v_mfma_f32_16x16x32_bf16 a[136:139], a[172:175], a[104:107], 0
    v_permlane32_swap_b32 v118, v122
    v_permlane32_swap_b32 v106, v82
    v_mfma_f32_16x16x32_bf16 v[48:51], a[172:175], a[48:51], 0
    ds_write_b128 v20, a[0:3] offset:25600
    v_permlane32_swap_b32 v107, v83
    s_waitcnt vmcnt(24)
    v_mfma_f32_16x16x32_bf16 a[124:127], a[188:191], a[68:71], a[124:127]
    s_add_u32 s45, s33, 21884928
    buffer_load_dwordx4 a[152:155], v4, s[24:27], s45 offen
    v_mfma_f32_16x16x32_bf16 a[128:131], a[188:191], a[72:75], a[128:131]
    v_mfma_f32_16x16x32_bf16 a[132:135], a[188:191], a[76:79], a[132:135]
    ds_write_b128 v20, a[8:11] offset:26624
    v_mfma_f32_16x16x32_bf16 a[136:139], a[188:191], a[108:111], a[136:139]
    v_mfma_f32_16x16x32_bf16 v[48:51], a[188:191], a[64:67], v[48:51]
    buffer_load_dwordx4 a[216:219], v4, s[24:27], s45 offen offset:1024
    s_waitcnt vmcnt(25)
    v_mfma_f32_16x16x32_bf16 a[124:127], a[196:199], a[88:91], a[124:127]
    ds_write_b128 v28, a[12:15] offset:10496
    v_mfma_f32_16x16x32_bf16 a[128:131], a[196:199], a[96:99], a[128:131]
    s_waitcnt vmcnt(18)
    s_waitcnt lgkmcnt(0)
    s_barrier
    buffer_load_dwordx4 a[220:223], v4, s[24:27], s45 offen offset:2048
    v_mfma_f32_16x16x32_bf16 a[132:135], a[196:199], a[100:103], a[132:135]
    s_cmp_eq_u32 s47, 0
    s_cbranch_scc1 G_RP1_S
    buffer_store_byte v17, v19, s[24:27], s64 offen offset:1024
G_RP1_R:
    v_mfma_f32_16x16x32_bf16 a[136:139], a[196:199], a[112:115], a[136:139]
    ds_read_b128 v[80:83], v21 offset:21504
    v_mfma_f32_16x16x32_bf16 v[48:51], a[196:199], a[84:87], v[48:51]
    ds_read_b128 v[84:87], v22 offset:22528
    v_mfma_f32_16x16x32_bf16 a[124:127], a[200:203], a[148:151], a[124:127]
    ds_read_b128 v[88:91], v23 offset:23552
    v_mfma_f32_16x16x32_bf16 a[128:131], a[200:203], a[156:159], a[128:131]
    ds_read_b128 v[92:95], v21 offset:24576
    buffer_load_dwordx4 a[224:227], v4, s[24:27], s45 offen offset:3072
    v_mfma_f32_16x16x32_bf16 a[132:135], a[200:203], a[160:163], a[132:135]
    ds_read_b128 v[32:35], v22 offset:25600
    v_mfma_f32_16x16x32_bf16 a[136:139], a[200:203], a[116:119], a[136:139]
    ds_read_b128 v[36:39], v23 offset:26624
    v_fmac_f32 v124, v40, v118
    v_fmac_f32 v125, v41, v118
    v_mfma_f32_16x16x32_bf16 v[48:51], a[200:203], a[144:147], v[48:51]
    v_fmac_f32 v126, v42, v118
    v_fmac_f32 v127, v43, v118
    v_mfma_f32_16x16x32_bf16 a[124:127], a[204:207], a[180:183], a[124:127]
    s_waitcnt lgkmcnt(4)
    v_add_f32 v80, v80, v84
    v_add_f32 v81, v81, v85
    buffer_load_dwordx4 a[228:231], v5, s[24:27], s45 offen
    v_mfma_f32_16x16x32_bf16 a[128:131], a[204:207], a[184:187], a[128:131]
    v_add_f32 v82, v82, v86
    v_add_f32 v83, v83, v87
    v_mfma_f32_16x16x32_bf16 a[132:135], a[204:207], a[192:195], a[132:135]
    s_waitcnt lgkmcnt(3)
    v_add_f32 v124, v124, v88
    v_add_f32 v125, v125, v89
    v_mfma_f32_16x16x32_bf16 a[136:139], a[204:207], a[120:123], a[136:139]
    v_add_f32 v126, v126, v90
    v_add_f32 v127, v127, v91
    v_mfma_f32_16x16x32_bf16 v[48:51], a[204:207], a[176:179], v[48:51]
    v_add_f32 v124, v124, v80
    v_add_f32 v125, v125, v81
    buffer_load_dwordx4 a[164:167], v5, s[24:27], s45 offen offset:1024
    v_mfma_f32_16x16x32_bf16 a[168:171], a[208:211], a[52:55], 0
    v_add_f32 v126, v126, v82
    v_add_f32 v127, v127, v83
    v_mfma_f32_16x16x32_bf16 a[172:175], a[208:211], a[56:59], 0
    ds_write_b128 v20, a[124:127] offset:27648
    v_fmac_f32 v44, v60, v118
    v_fmac_f32 v45, v61, v118
    v_mfma_f32_16x16x32_bf16 a[188:191], a[208:211], a[60:63], 0
    v_fmac_f32 v46, v62, v118
    v_fmac_f32 v47, v63, v118
    buffer_load_dwordx4 a[0:3], v5, s[24:27], s45 offen offset:2048
    v_mfma_f32_16x16x32_bf16 a[92:95], a[208:211], a[104:107], 0
    s_waitcnt lgkmcnt(2)
    v_add_f32 v92, v92, v32
    v_add_f32 v93, v93, v33
    v_mfma_f32_16x16x32_bf16 v[52:55], a[208:211], a[48:51], 0
    ds_write_b128 v20, a[128:131] offset:28672
    v_add_f32 v94, v94, v34
    v_add_f32 v95, v95, v35
    v_mfma_f32_16x16x32_bf16 a[168:171], a[212:215], a[68:71], a[168:171]
    s_waitcnt lgkmcnt(2)
    v_add_f32 v44, v44, v36
    v_add_f32 v45, v45, v37
    buffer_load_dwordx4 a[8:11], v5, s[24:27], s45 offen offset:3072
    v_mfma_f32_16x16x32_bf16 a[172:175], a[212:215], a[72:75], a[172:175]
    v_add_f32 v46, v46, v38
    v_add_f32 v47, v47, v39
    v_mfma_f32_16x16x32_bf16 a[188:191], a[212:215], a[76:79], a[188:191]
    ds_write_b128 v20, a[132:135] offset:29696
    v_add_f32 v44, v44, v92
    v_add_f32 v45, v45, v93
    v_mfma_f32_16x16x32_bf16 a[92:95], a[212:215], a[108:111], a[92:95]
    v_add_f32 v46, v46, v94
    v_add_f32 v47, v47, v95
    s_add_u32 s45, s33, 21893120
    buffer_load_dwordx4 a[12:15], v4, s[24:27], s45 offen
    v_mfma_f32_16x16x32_bf16 v[52:55], a[212:215], a[64:67], v[52:55]
    v_mul_f32 v80, v124, v124
    v_mul_f32 v81, v125, v125
    s_waitcnt vmcnt(25)
    v_mfma_f32_16x16x32_bf16 a[168:171], a[232:235], a[88:91], a[168:171]
    ds_write_b128 v28, a[136:139] offset:10752
    v_mul_f32 v82, v126, v126
    v_mul_f32 v83, v127, v127
    v_mfma_f32_16x16x32_bf16 a[172:175], a[232:235], a[96:99], a[172:175]
    v_mul_f32 v92, v44, v44
    v_mul_f32 v93, v45, v45
    buffer_load_dwordx4 a[196:199], v4, s[24:27], s45 offen offset:1024
    v_mfma_f32_16x16x32_bf16 a[188:191], a[232:235], a[100:103], a[188:191]
    v_mul_f32 v94, v46, v46
    v_mul_f32 v95, v47, v47
    v_mfma_f32_16x16x32_bf16 a[92:95], a[232:235], a[112:115], a[92:95]
    v_fma_f32 v80, v80, v110, v108
    v_fma_f32 v81, v81, v110, v108
    v_mfma_f32_16x16x32_bf16 v[52:55], a[232:235], a[84:87], v[52:55]
    v_fma_f32 v82, v82, v110, v108
    v_fma_f32 v83, v83, v110, v108
    s_waitcnt vmcnt(25)
    v_mfma_f32_16x16x32_bf16 a[168:171], a[236:239], a[148:151], a[168:171]
    v_fma_f32 v92, v92, v110, v108
    v_fma_f32 v93, v93, v110, v108
    buffer_load_dwordx4 a[200:203], v4, s[24:27], s45 offen offset:2048
    v_mfma_f32_16x16x32_bf16 a[172:175], a[236:239], a[156:159], a[172:175]
    v_fma_f32 v94, v94, v110, v108
    v_fma_f32 v95, v95, v110, v108
    v_mfma_f32_16x16x32_bf16 a[188:191], a[236:239], a[160:163], a[188:191]
    v_mul_f32 v80, v80, v124
    v_mul_f32 v81, v81, v125
    v_mfma_f32_16x16x32_bf16 a[92:95], a[236:239], a[116:119], a[92:95]
    v_mul_f32 v82, v82, v126
    v_mul_f32 v83, v83, v127
    v_mfma_f32_16x16x32_bf16 v[52:55], a[236:239], a[144:147], v[52:55]
    v_mul_f32 v92, v92, v44
    v_mul_f32 v93, v93, v45
    buffer_load_dwordx4 a[204:207], v4, s[24:27], s45 offen offset:3072
    s_waitcnt vmcnt(26)
    v_mfma_f32_16x16x32_bf16 a[168:171], a[240:243], a[180:183], a[168:171]
    v_mul_f32 v94, v94, v46
    v_mul_f32 v95, v95, v47
    v_mfma_f32_16x16x32_bf16 a[172:175], a[240:243], a[184:187], a[172:175]
    v_exp_f32 v80, v80
    v_mfma_f32_16x16x32_bf16 a[188:191], a[240:243], a[192:195], a[188:191]
    v_exp_f32 v81, v81
    v_mfma_f32_16x16x32_bf16 a[92:95], a[240:243], a[120:123], a[92:95]
    v_exp_f32 v82, v82
    buffer_load_dwordx4 a[208:211], v5, s[24:27], s45 offen
    v_mfma_f32_16x16x32_bf16 v[52:55], a[240:243], a[176:179], v[52:55]
    v_exp_f32 v83, v83
    s_waitcnt vmcnt(26)
    v_mfma_f32_16x16x32_bf16 a[212:215], a[244:247], a[52:55], 0
    v_exp_f32 v92, v92
    v_mfma_f32_16x16x32_bf16 a[124:127], a[244:247], a[56:59], 0
    ds_write_b128 v20, a[168:171] offset:30720
    v_exp_f32 v93, v93
    buffer_load_dwordx4 a[136:139], v5, s[24:27], s45 offen offset:1024
    v_mfma_f32_16x16x32_bf16 a[128:131], a[244:247], a[60:63], 0
    v_exp_f32 v94, v94
    v_mfma_f32_16x16x32_bf16 a[132:135], a[244:247], a[104:107], 0
    v_exp_f32 v95, v95
    v_mfma_f32_16x16x32_bf16 v[56:59], a[244:247], a[48:51], 0
    ds_write_b128 v20, a[172:175] offset:31744
    v_fma_f32 v80, v80, v116, v116
    v_fma_f32 v81, v81, v116, v116
    s_waitcnt vmcnt(26)
    v_mfma_f32_16x16x32_bf16 a[212:215], a[248:251], a[68:71], a[212:215]
    v_fma_f32 v82, v82, v116, v116
    v_fma_f32 v83, v83, v116, v116
    buffer_load_dwordx4 a[232:235], v5, s[24:27], s45 offen offset:2048
    v_mfma_f32_16x16x32_bf16 a[124:127], a[248:251], a[72:75], a[124:127]
    v_fma_f32 v92, v92, v116, v116
    v_fma_f32 v93, v93, v116, v116
    v_mfma_f32_16x16x32_bf16 a[128:131], a[248:251], a[76:79], a[128:131]
    ds_write_b128 v20, a[188:191] offset:32768
    v_fma_f32 v94, v94, v116, v116
    v_fma_f32 v95, v95, v116, v116
    v_mfma_f32_16x16x32_bf16 a[132:135], a[248:251], a[108:111], a[132:135]
    v_rcp_f32 v80, v80
    buffer_load_dwordx4 a[236:239], v5, s[24:27], s45 offen offset:3072
    v_mfma_f32_16x16x32_bf16 v[56:59], a[248:251], a[64:67], v[56:59]
    v_rcp_f32 v81, v81
    s_waitcnt vmcnt(27)
    v_mfma_f32_16x16x32_bf16 a[212:215], a[252:255], a[88:91], a[212:215]
    ds_write_b128 v28, a[92:95] offset:11008
    v_rcp_f32 v82, v82
    v_mfma_f32_16x16x32_bf16 a[124:127], a[252:255], a[96:99], a[124:127]
    s_waitcnt lgkmcnt(0)
    s_barrier
    v_rcp_f32 v83, v83
    s_add_u32 s45, s33, 21901312
    buffer_load_dwordx4 a[240:243], v4, s[24:27], s45 offen
    v_mfma_f32_16x16x32_bf16 a[128:131], a[252:255], a[100:103], a[128:131]
    v_rcp_f32 v92, v92
    v_mfma_f32_16x16x32_bf16 a[132:135], a[252:255], a[112:115], a[132:135]
    v_rcp_f32 v93, v93
    v_mfma_f32_16x16x32_bf16 v[56:59], a[252:255], a[84:87], v[56:59]
    v_rcp_f32 v94, v94
    s_waitcnt vmcnt(27)
    v_mfma_f32_16x16x32_bf16 a[212:215], a[80:83], a[148:151], a[212:215]
    v_rcp_f32 v95, v95
    s_add_u32 s45, s35, 22695936
    buffer_load_dwordx4 a[244:247], v4, s[24:27], s45 offen
    v_mfma_f32_16x16x32_bf16 a[124:127], a[80:83], a[156:159], a[124:127]
    v_mul_f32 v124, v124, v80
    v_mul_f32 v125, v125, v81
    v_mfma_f32_16x16x32_bf16 a[128:131], a[80:83], a[160:163], a[128:131]
    v_mul_f32 v126, v126, v82
    v_mul_f32 v127, v127, v83
    v_mfma_f32_16x16x32_bf16 a[132:135], a[80:83], a[116:119], a[132:135]
    v_mul_f32 v44, v44, v92
    v_mul_f32 v45, v45, v93
    v_mfma_f32_16x16x32_bf16 v[56:59], a[80:83], a[144:147], v[56:59]
    v_mul_f32 v46, v46, v94
    v_mul_f32 v47, v47, v95
    buffer_load_dwordx4 a[248:251], v4, s[24:27], s45 offen offset:1024
    s_waitcnt vmcnt(28)
    v_mfma_f32_16x16x32_bf16 a[212:215], a[16:19], a[180:183], a[212:215]
    v_cvt_pk_bf16_f32 v84, v124, v125
    v_cvt_pk_bf16_f32 v85, v126, v127
    v_mfma_f32_16x16x32_bf16 a[124:127], a[16:19], a[184:187], a[124:127]
    v_cvt_pk_bf16_f32 v86, v44, v45
    v_cvt_pk_bf16_f32 v87, v46, v47
    v_mfma_f32_16x16x32_bf16 a[128:131], a[16:19], a[192:195], a[128:131]
    s_cmp_eq_u32 s47, 0
    s_cbranch_scc1 G_S31_S
    s_add_u32 s28, s3, 0
    buffer_store_dwordx4 v[84:87], v29, s[24:27], s28 offen
G_S31_R:
    v_mfma_f32_16x16x32_bf16 a[132:135], a[16:19], a[120:123], a[132:135]
    ds_read_b128 v[80:83], v21 offset:27648
    v_mfma_f32_16x16x32_bf16 v[56:59], a[16:19], a[176:179], v[56:59]
    ds_read_b128 v[84:87], v22 offset:28672
    ds_read_b128 v[88:91], v23 offset:29696
    ds_read_b128 v[92:95], v21 offset:30720
    buffer_load_dwordx4 a[168:171], v4, s[24:27], s45 offen offset:2048
    ds_read_b128 v[32:35], v22 offset:31744
    ds_read_b128 v[36:39], v23 offset:32768
    v_pk_fma_f32 v[48:49], v[64:65], v[118:119], v[48:49] op_sel_hi:[1,0,1]
    v_pk_fma_f32 v[50:51], v[66:67], v[118:119], v[50:51] op_sel_hi:[1,0,1]
    s_waitcnt lgkmcnt(4)
    v_pk_add_f32 v[80:81], v[80:81], v[84:85]
    v_pk_add_f32 v[82:83], v[82:83], v[86:87]
    buffer_load_dwordx4 a[172:175], v4, s[24:27], s45 offen offset:3072
    ds_write_b128 v20, a[212:215] offset:33792
    s_waitcnt lgkmcnt(4)
    v_pk_add_f32 v[48:49], v[48:49], v[88:89]
    v_pk_add_f32 v[50:51], v[50:51], v[90:91]
    v_pk_add_f32 v[48:49], v[48:49], v[80:81]
    v_pk_add_f32 v[50:51], v[50:51], v[82:83]
    v_pk_fma_f32 v[52:53], v[68:69], v[118:119], v[52:53] op_sel_hi:[1,0,1]
    v_pk_fma_f32 v[54:55], v[70:71], v[118:119], v[54:55] op_sel_hi:[1,0,1]
    s_waitcnt lgkmcnt(2)
    v_pk_add_f32 v[92:93], v[92:93], v[32:33]
    v_pk_add_f32 v[94:95], v[94:95], v[34:35]
    s_add_u32 s44, s67, 2752512
    buffer_store_dwordx4 a[4:7], v9, s[24:27], s44 offen
    s_waitcnt lgkmcnt(1)
    v_pk_add_f32 v[52:53], v[52:53], v[36:37]
    v_pk_add_f32 v[54:55], v[54:55], v[38:39]
    v_pk_add_f32 v[52:53], v[52:53], v[92:93]
    v_pk_add_f32 v[54:55], v[54:55], v[94:95]
    ds_write_b128 v20, a[124:127] offset:34816
    v_pk_mul_f32 v[80:81], v[48:49], v[48:49]
    v_pk_mul_f32 v[82:83], v[50:51], v[50:51]
    v_pk_mul_f32 v[92:93], v[52:53], v[52:53]
    v_pk_mul_f32 v[94:95], v[54:55], v[54:55]
    buffer_load_dwordx4 a[188:191], v5, s[24:27], s45 offen
    v_pk_fma_f32 v[80:81], v[80:81], v[110:111], v[108:109] op_sel_hi:[1,0,0]
    v_pk_fma_f32 v[82:83], v[82:83], v[110:111], v[108:109] op_sel_hi:[1,0,0]
    v_pk_fma_f32 v[92:93], v[92:93], v[110:111], v[108:109] op_sel_hi:[1,0,0]
    v_pk_fma_f32 v[94:95], v[94:95], v[110:111], v[108:109] op_sel_hi:[1,0,0]
    v_pk_mul_f32 v[80:81], v[80:81], v[48:49]
    v_pk_mul_f32 v[82:83], v[82:83], v[50:51]
    v_pk_mul_f32 v[92:93], v[92:93], v[52:53]
    v_pk_mul_f32 v[94:95], v[94:95], v[54:55]
    buffer_store_dwordx4 a[4:7], v9, s[24:27], s44 offen offset:1024
    ds_write_b128 v20, a[128:131] offset:35840
    v_exp_f32 v80, v80
    v_exp_f32 v81, v81
    v_exp_f32 v82, v82
    v_exp_f32 v83, v83
    v_exp_f32 v92, v92
    v_exp_f32 v93, v93
    s_add_u32 s44, s68, 2752512
    buffer_store_dwordx2 a[4:5], v9, s[24:27], s44 offen
    ds_write_b128 v28, a[132:135] offset:11264
    s_waitcnt lgkmcnt(0)
    s_barrier
    v_exp_f32 v94, v94
    v_exp_f32 v95, v95
    buffer_load_dwordx4 a[92:95], v5, s[24:27], s45 offen offset:1024
    v_pk_fma_f32 v[80:81], v[80:81], v[116:117], v[116:117] op_sel_hi:[1,0,0]
    v_pk_fma_f32 v[82:83], v[82:83], v[116:117], v[116:117] op_sel_hi:[1,0,0]
    v_pk_fma_f32 v[92:93], v[92:93], v[116:117], v[116:117] op_sel_hi:[1,0,0]
    v_pk_fma_f32 v[94:95], v[94:95], v[116:117], v[116:117] op_sel_hi:[1,0,0]
    v_rcp_f32 v80, v80
    v_rcp_f32 v81, v81
    v_rcp_f32 v82, v82
    v_rcp_f32 v83, v83
    buffer_load_dwordx4 a[252:255], v5, s[24:27], s45 offen offset:2048
    v_rcp_f32 v92, v92
    v_rcp_f32 v93, v93
    v_rcp_f32 v94, v94
    v_rcp_f32 v95, v95
    v_pk_mul_f32 v[48:49], v[48:49], v[80:81]
    v_pk_mul_f32 v[50:51], v[50:51], v[82:83]
    v_pk_mul_f32 v[52:53], v[52:53], v[92:93]
    v_pk_mul_f32 v[54:55], v[54:55], v[94:95]
    s_add_u32 s44, s73, 17825792
    buffer_store_dwordx2 a[4:5], v11, s[24:27], s44 offen
    v_cvt_pk_bf16_f32 v84, v48, v49
    v_cvt_pk_bf16_f32 v85, v50, v51
    v_cvt_pk_bf16_f32 v86, v52, v53
    v_cvt_pk_bf16_f32 v87, v54, v55
    s_cmp_eq_u32 s47, 0
    s_cbranch_scc1 G_S33_S
    s_add_u32 s28, s3, 1024
    buffer_store_dwordx4 v[84:87], v29, s[24:27], s28 offen
G_S33_R:
    ds_read_b128 v[80:83], v21 offset:33792
    s_nop 0
    ds_read_b128 v[84:87], v22 offset:34816
    ds_read_b128 v[88:91], v23 offset:35840
    ds_read_b128 v[252:255], v27 offset:10240
    ds_read_b128 v[92:95], v27 offset:11520
    ds_read_b128 v[32:35], v27 offset:12800
    buffer_load_dwordx4 a[80:83], v5, s[24:27], s45 offen offset:3072
    ds_read_b128 v[36:39], v27 offset:14080
    v_pk_fma_f32 v[56:57], v[72:73], v[118:119], v[56:57] op_sel_hi:[1,0,1]
    v_pk_fma_f32 v[58:59], v[74:75], v[118:119], v[58:59] op_sel_hi:[1,0,1]
    s_waitcnt lgkmcnt(5)
    v_pk_add_f32 v[80:81], v[80:81], v[84:85]
    v_pk_add_f32 v[82:83], v[82:83], v[86:87]
    s_waitcnt lgkmcnt(4)
    v_pk_add_f32 v[56:57], v[56:57], v[88:89]
    v_pk_add_f32 v[58:59], v[58:59], v[90:91]
    v_pk_add_f32 v[56:57], v[56:57], v[80:81]
    v_pk_add_f32 v[58:59], v[58:59], v[82:83]
    s_add_u32 s45, s35, 22704128
    buffer_load_dwordx4 a[16:19], v4, s[24:27], s45 offen
    s_waitcnt lgkmcnt(3)
    v_pk_fma_f32 v[252:253], v[76:77], v[122:123], v[252:253] op_sel_hi:[1,0,1]
    v_pk_fma_f32 v[254:255], v[78:79], v[122:123], v[254:255] op_sel_hi:[1,0,1]
    s_waitcnt lgkmcnt(1)
    v_pk_add_f32 v[92:93], v[92:93], v[32:33]
    v_pk_add_f32 v[94:95], v[94:95], v[34:35]
    s_waitcnt lgkmcnt(0)
    v_pk_add_f32 v[252:253], v[252:253], v[36:37]
    v_pk_add_f32 v[254:255], v[254:255], v[38:39]
    v_pk_add_f32 v[252:253], v[252:253], v[92:93]
    v_pk_add_f32 v[254:255], v[254:255], v[94:95]
    s_add_u32 s44, s69, 10747904
    s_add_u32 s44, s44, s71
    buffer_store_dwordx4 a[4:7], v9, s[24:27], s44 offen
    s_cmp_eq_u32 s47, 0
    s_cbranch_scc1 G_RL1
    s_load_dwordx8 s[56:63], s[24:25], s9 offset:1024
G_RL1:
    v_pk_mul_f32 v[80:81], v[56:57], v[56:57]
    v_pk_mul_f32 v[82:83], v[58:59], v[58:59]
    v_pk_mul_f32 v[92:93], v[252:253], v[252:253]
    v_pk_mul_f32 v[94:95], v[254:255], v[254:255]
    v_pk_fma_f32 v[80:81], v[80:81], v[110:111], v[108:109] op_sel_hi:[1,0,0]
    v_pk_fma_f32 v[82:83], v[82:83], v[110:111], v[108:109] op_sel_hi:[1,0,0]
    v_pk_fma_f32 v[92:93], v[92:93], v[114:115], v[112:113] op_sel_hi:[1,0,0]
    buffer_load_dwordx4 a[48:51], v4, s[24:27], s45 offen offset:1024
    v_pk_fma_f32 v[94:95], v[94:95], v[114:115], v[112:113] op_sel_hi:[1,0,0]
    v_pk_mul_f32 v[80:81], v[80:81], v[56:57]
    v_pk_mul_f32 v[82:83], v[82:83], v[58:59]
    v_pk_mul_f32 v[92:93], v[92:93], v[252:253]
    v_pk_mul_f32 v[94:95], v[94:95], v[254:255]
    v_exp_f32 v80, v80
    v_exp_f32 v81, v81
    buffer_store_dwordx4 a[4:7], v9, s[24:27], s44 offen offset:1024
    v_exp_f32 v82, v82
    v_exp_f32 v83, v83
    v_exp_f32 v92, v92
    v_exp_f32 v93, v93
    v_exp_f32 v94, v94
    v_exp_f32 v95, v95
    v_pk_fma_f32 v[80:81], v[80:81], v[116:117], v[116:117] op_sel_hi:[1,0,0]
    v_pk_fma_f32 v[82:83], v[82:83], v[116:117], v[116:117] op_sel_hi:[1,0,0]
    v_pk_fma_f32 v[92:93], v[92:93], v[120:121], v[120:121] op_sel_hi:[1,0,0]
    v_pk_fma_f32 v[94:95], v[94:95], v[120:121], v[120:121] op_sel_hi:[1,0,0]
    buffer_load_dwordx4 a[52:55], v4, s[24:27], s45 offen offset:2048
    v_rcp_f32 v80, v80
    v_rcp_f32 v81, v81
    v_rcp_f32 v82, v82
    v_rcp_f32 v83, v83
    v_rcp_f32 v92, v92
    v_rcp_f32 v93, v93
    v_rcp_f32 v94, v94
    v_rcp_f32 v95, v95
    buffer_store_dwordx4 a[4:7], v9, s[24:27], s44 offen offset:2048
    v_pk_mul_f32 v[56:57], v[56:57], v[80:81]
    v_pk_mul_f32 v[58:59], v[58:59], v[82:83]
    v_pk_mul_f32 v[252:253], v[252:253], v[92:93]
    v_pk_mul_f32 v[254:255], v[254:255], v[94:95]
    v_cvt_pk_bf16_f32 v84, v56, v57
    v_cvt_pk_bf16_f32 v85, v58, v59
    v_cvt_pk_bf16_f32 v86, v252, v253
    v_cvt_pk_bf16_f32 v87, v254, v255
    v_and_b32 v86, s29, v86
    v_and_b32 v87, s29, v87
    s_cmp_eq_u32 s47, 0
    s_cbranch_scc1 G_S34_S
    s_add_u32 s28, s66, 0
    buffer_store_dwordx2 v[84:85], v29, s[24:27], s28 offen
    s_add_u32 s28, s65, 0
    buffer_store_dwordx2 v[86:87], v31, s[24:27], s28 offen
G_S34_R:
    v_sub_f32 v116, 0, v106
    v_mov_b32 v118, v107
    v_lshlrev_b32 v124, 16, v96
    v_and_b32 v125, 0xffff0000, v96
    v_lshlrev_b32 v126, 16, v97
    v_and_b32 v127, 0xffff0000, v97
    v_lshlrev_b32 v44, 16, v98
    v_and_b32 v45, 0xffff0000, v98
    v_lshlrev_b32 v46, 16, v99
    v_and_b32 v47, 0xffff0000, v99
    v_lshlrev_b32 v48, 16, v100
    v_and_b32 v49, 0xffff0000, v100
    v_lshlrev_b32 v50, 16, v101
    v_and_b32 v51, 0xffff0000, v101
    v_lshlrev_b32 v52, 16, v102
    v_and_b32 v53, 0xffff0000, v102
    buffer_load_dwordx4 a[56:59], v4, s[24:27], s45 offen offset:3072
    v_lshlrev_b32 v54, 16, v103
    v_and_b32 v55, 0xffff0000, v103
    v_lshlrev_b32 v56, 16, v104
    v_and_b32 v57, 0xffff0000, v104
    v_lshlrev_b32 v58, 16, v105
    v_and_b32 v59, 0xffff0000, v105
    v_pk_add_f32 v[124:125], v[124:125], v[116:117] op_sel_hi:[1,0]
    v_pk_add_f32 v[126:127], v[126:127], v[116:117] op_sel_hi:[1,0]
    v_pk_add_f32 v[44:45], v[44:45], v[116:117] op_sel_hi:[1,0]
    v_pk_add_f32 v[46:47], v[46:47], v[116:117] op_sel_hi:[1,0]
    v_pk_add_f32 v[48:49], v[48:49], v[116:117] op_sel_hi:[1,0]
    v_pk_add_f32 v[50:51], v[50:51], v[116:117] op_sel_hi:[1,0]
    buffer_load_dwordx4 a[60:63], v5, s[24:27], s45 offen
    v_pk_add_f32 v[52:53], v[52:53], v[116:117] op_sel_hi:[1,0]
    v_pk_add_f32 v[54:55], v[54:55], v[116:117] op_sel_hi:[1,0]
    v_pk_add_f32 v[56:57], v[56:57], v[116:117] op_sel_hi:[1,0]
    v_pk_add_f32 v[58:59], v[58:59], v[116:117] op_sel_hi:[1,0]
    v_cvt_pk_bf16_f32 v80, v124, v125
    v_cvt_pk_bf16_f32 v81, v126, v127
    v_cvt_pk_bf16_f32 v82, v44, v45
    v_cvt_pk_bf16_f32 v83, v46, v47
    v_cvt_pk_bf16_f32 v84, v48, v49
    v_cvt_pk_bf16_f32 v85, v50, v51
    v_cvt_pk_bf16_f32 v86, v52, v53
    v_cvt_pk_bf16_f32 v87, v54, v55
    s_add_u32 s44, s69, 10797056
    buffer_store_dwordx2 a[4:5], v10, s[24:27], s44 offen
    v_cvt_pk_bf16_f32 v88, v56, v57
    v_cvt_pk_bf16_f32 v89, v58, v59
    v_lshlrev_b32 v124, 16, v80
    v_and_b32 v125, 0xffff0000, v80
    v_lshlrev_b32 v126, 16, v81
    v_and_b32 v127, 0xffff0000, v81
    v_lshlrev_b32 v44, 16, v82
    v_and_b32 v45, 0xffff0000, v82
    v_lshlrev_b32 v46, 16, v83
    v_and_b32 v47, 0xffff0000, v83
    v_lshlrev_b32 v48, 16, v84
    v_and_b32 v49, 0xffff0000, v84
    v_lshlrev_b32 v50, 16, v85
    v_and_b32 v51, 0xffff0000, v85
    v_lshlrev_b32 v52, 16, v86
    v_and_b32 v53, 0xffff0000, v86
    buffer_load_dwordx4 a[64:67], v5, s[24:27], s45 offen offset:1024
    v_lshlrev_b32 v54, 16, v87
    v_and_b32 v55, 0xffff0000, v87
    v_lshlrev_b32 v56, 16, v88
    v_and_b32 v57, 0xffff0000, v88
    v_lshlrev_b32 v58, 16, v89
    v_and_b32 v59, 0xffff0000, v89
    v_pk_mul_f32 v[124:125], v[124:125], v[118:119] op_sel_hi:[1,0]
    v_pk_mul_f32 v[126:127], v[126:127], v[118:119] op_sel_hi:[1,0]
    v_pk_mul_f32 v[44:45], v[44:45], v[118:119] op_sel_hi:[1,0]
    v_pk_mul_f32 v[46:47], v[46:47], v[118:119] op_sel_hi:[1,0]
    v_pk_mul_f32 v[48:49], v[48:49], v[118:119] op_sel_hi:[1,0]
    v_pk_mul_f32 v[50:51], v[50:51], v[118:119] op_sel_hi:[1,0]
    s_add_u32 s44, s70, 10747904
    s_add_u32 s44, s44, s71
    buffer_store_dwordx4 a[4:7], v9, s[24:27], s44 offen
    v_pk_mul_f32 v[52:53], v[52:53], v[118:119] op_sel_hi:[1,0]
    v_pk_mul_f32 v[54:55], v[54:55], v[118:119] op_sel_hi:[1,0]
    v_pk_mul_f32 v[56:57], v[56:57], v[118:119] op_sel_hi:[1,0]
    v_pk_mul_f32 v[58:59], v[58:59], v[118:119] op_sel_hi:[1,0]
    v_cvt_pk_bf16_f32 v80, v124, v125
    v_cvt_pk_bf16_f32 v81, v126, v127
    v_cvt_pk_bf16_f32 v82, v44, v45
    v_cvt_pk_bf16_f32 v83, v46, v47
    v_cvt_pk_bf16_f32 v84, v48, v49
    v_cvt_pk_bf16_f32 v85, v50, v51
    v_cvt_pk_bf16_f32 v86, v52, v53
    v_cvt_pk_bf16_f32 v87, v54, v55
    buffer_load_dwordx4 a[68:71], v5, s[24:27], s45 offen offset:2048
    v_cvt_pk_bf16_f32 v88, v56, v57
    v_cvt_pk_bf16_f32 v89, v58, v59
    v_lshlrev_b32 v124, 16, v80
    v_and_b32 v125, 0xffff0000, v80
    v_lshlrev_b32 v126, 16, v81
    v_and_b32 v127, 0xffff0000, v81
    v_lshlrev_b32 v44, 16, v82
    v_and_b32 v45, 0xffff0000, v82
    v_lshlrev_b32 v46, 16, v83
    v_and_b32 v47, 0xffff0000, v83
    v_lshlrev_b32 v48, 16, v84
    v_and_b32 v49, 0xffff0000, v84
    v_lshlrev_b32 v50, 16, v85
    v_and_b32 v51, 0xffff0000, v85
    v_lshlrev_b32 v52, 16, v86
    v_and_b32 v53, 0xffff0000, v86
    buffer_store_dwordx4 a[4:7], v9, s[24:27], s44 offen offset:1024
    v_lshlrev_b32 v54, 16, v87
    v_and_b32 v55, 0xffff0000, v87
    v_lshlrev_b32 v56, 16, v88
    v_and_b32 v57, 0xffff0000, v88
    v_lshlrev_b32 v58, 16, v89
    v_and_b32 v59, 0xffff0000, v89
    v_mul_u32_u24 v13, 112, v2
    v_add_u32 v13, s53, v13
    v_add_u32 v12, s53, v4
    s_lshl_b32 s28, s21, 6
    s_lshl_b32 s29, s20, 4
    s_add_u32 s28, s28, s29
    v_add_u32 v6, s28, v3
    v_mul_u32_u24 v6, 0x500, v6
    v_mul_u32_u24 v7, 40, v2
    buffer_load_dwordx4 a[72:75], v5, s[24:27], s45 offen offset:3072
    s_mul_i32 s28, s22, 160
    v_add3_u32 v6, v6, v7, s28
    s_and_b32 s28, s21, 1
    s_mul_i32 s28, s28, -163840
    s_add_u32 s30, s52, s28
    s_add_u32 s30, s30, 81920
    s_xor_b32 s32, s72, 0x1000
    s_waitcnt lgkmcnt(0)
    s_and_b64 s[56:57], s[56:57], s[58:59]
    s_and_b64 s[60:61], s[60:61], s[62:63]
    s_and_b64 s[56:57], s[56:57], s[60:61]
    s_and_b32 s56, s56, s57
    s_and_b32 s56, s56, s74
    s_mul_i32 s56, s56, s47
    s_cmp_lg_u32 s56, s74
    s_cbranch_scc1 G_RC1
G_RC1_R:
    s_add_u32 s44, s52, s11
    buffer_load_dwordx4 a[76:79], v4, s[24:27], s44 offen sc1
    buffer_load_dwordx4 a[108:111], v4, s[24:27], s44 offen offset:1024 sc1
    buffer_load_dwordx4 a[112:115], v4, s[24:27], s44 offen offset:2048 sc1
    buffer_load_dwordx4 a[116:119], v4, s[24:27], s44 offen offset:3072 sc1
    buffer_load_dwordx4 a[120:123], v5, s[24:27], s44 offen sc1
    s_add_u32 s44, s52, s12
    buffer_load_dwordx4 a[144:147], v4, s[24:27], s44 offen sc1
    buffer_load_dwordx4 a[148:151], v4, s[24:27], s44 offen offset:1024 sc1
    buffer_load_dwordx4 a[156:159], v4, s[24:27], s44 offen offset:2048 sc1
    buffer_load_dwordx4 a[160:163], v4, s[24:27], s44 offen offset:3072 sc1
    buffer_load_dwordx4 a[176:179], v5, s[24:27], s44 offen sc1
    s_add_u32 s44, s52, s13
    buffer_load_dwordx4 a[180:183], v4, s[24:27], s44 offen sc1
    s_waitcnt vmcnt(10)
    v_mfma_f32_16x16x32_bf16 a[84:87], a[20:23], a[76:79], 0
    v_mfma_f32_16x16x32_bf16 a[88:91], a[24:27], a[76:79], 0
    v_mfma_f32_16x16x32_bf16 a[96:99], a[28:31], a[76:79], 0
    v_mfma_f32_16x16x32_bf16 a[100:103], a[32:35], a[76:79], 0
    v_mfma_f32_16x16x32_bf16 a[104:107], a[36:39], a[76:79], 0
    buffer_load_dwordx4 a[184:187], v4, s[24:27], s44 offen offset:1024 sc1
    s_waitcnt vmcnt(10)
    v_mfma_f32_16x16x32_bf16 a[84:87], a[40:43], a[108:111], a[84:87]
    v_mfma_f32_16x16x32_bf16 a[88:91], a[44:47], a[108:111], a[88:91]
    v_mfma_f32_16x16x32_bf16 a[96:99], a[140:143], a[108:111], a[96:99]
    v_mfma_f32_16x16x32_bf16 a[100:103], a[152:155], a[108:111], a[100:103]
    v_mfma_f32_16x16x32_bf16 a[104:107], a[216:219], a[108:111], a[104:107]
    buffer_load_dwordx4 a[192:195], v4, s[24:27], s44 offen offset:2048 sc1
    s_waitcnt vmcnt(10)
    v_mfma_f32_16x16x32_bf16 a[84:87], a[220:223], a[112:115], a[84:87]
    v_mfma_f32_16x16x32_bf16 a[88:91], a[224:227], a[112:115], a[88:91]
    v_mfma_f32_16x16x32_bf16 a[96:99], a[228:231], a[112:115], a[96:99]
    v_mfma_f32_16x16x32_bf16 a[100:103], a[164:167], a[112:115], a[100:103]
    buffer_load_dwordx4 a[212:215], v4, s[24:27], s44 offen offset:3072 sc1
    v_mfma_f32_16x16x32_bf16 a[104:107], a[0:3], a[112:115], a[104:107]
    s_waitcnt vmcnt(10)
    v_mfma_f32_16x16x32_bf16 a[84:87], a[8:11], a[116:119], a[84:87]
    v_mfma_f32_16x16x32_bf16 a[88:91], a[12:15], a[116:119], a[88:91]
    v_mfma_f32_16x16x32_bf16 a[96:99], a[196:199], a[116:119], a[96:99]
    buffer_load_dwordx4 a[124:127], v5, s[24:27], s44 offen sc1
    v_mfma_f32_16x16x32_bf16 a[100:103], a[200:203], a[116:119], a[100:103]
    v_mfma_f32_16x16x32_bf16 a[104:107], a[204:207], a[116:119], a[104:107]
    s_waitcnt vmcnt(10)
    v_mfma_f32_16x16x32_bf16 a[84:87], a[208:211], a[120:123], a[84:87]
    v_mfma_f32_16x16x32_bf16 a[88:91], a[136:139], a[120:123], a[88:91]
    s_add_u32 s44, s52, s10
    buffer_load_dwordx4 a[128:131], v4, s[24:27], s44 offen sc1
    v_mfma_f32_16x16x32_bf16 a[96:99], a[232:235], a[120:123], a[96:99]
    v_mfma_f32_16x16x32_bf16 a[100:103], a[236:239], a[120:123], a[100:103]
    v_mfma_f32_16x16x32_bf16 a[104:107], a[240:243], a[120:123], a[104:107]
    s_nop 1
    v_accvgpr_read_b32 v8, a84
    v_cmp_u_f32 vcc, v8, v8
    s_cbranch_vccnz G40
G40_R:
    s_waitcnt vmcnt(10)
    v_mfma_f32_16x16x32_bf16 a[132:135], a[20:23], a[144:147], 0
    ds_write_b128 v20, a[84:87] offset:0
    buffer_load_dwordx4 a[120:123], v4, s[24:27], s44 offen offset:1024 sc1
    v_mfma_f32_16x16x32_bf16 a[76:79], a[24:27], a[144:147], 0
    v_mfma_f32_16x16x32_bf16 a[108:111], a[28:31], a[144:147], 0
    v_mfma_f32_16x16x32_bf16 a[112:115], a[32:35], a[144:147], 0
    ds_write_b128 v20, a[88:91] offset:1024
    v_mfma_f32_16x16x32_bf16 a[116:119], a[36:39], a[144:147], 0
    buffer_load_dwordx4 v[248:251], v4, s[24:27], s44 offen offset:2048 sc1
    s_waitcnt vmcnt(11)
    v_mfma_f32_16x16x32_bf16 a[132:135], a[40:43], a[148:151], a[132:135]
    v_mfma_f32_16x16x32_bf16 a[76:79], a[44:47], a[148:151], a[76:79]
    ds_write_b128 v20, a[96:99] offset:2048
    v_mfma_f32_16x16x32_bf16 a[108:111], a[140:143], a[148:151], a[108:111]
    v_mfma_f32_16x16x32_bf16 a[112:115], a[152:155], a[148:151], a[112:115]
    buffer_load_dwordx4 v[244:247], v4, s[24:27], s44 offen offset:3072 sc1
    v_mfma_f32_16x16x32_bf16 a[116:119], a[216:219], a[148:151], a[116:119]
    ds_write_b128 v20, a[100:103] offset:3072
    s_waitcnt vmcnt(11)
    v_mfma_f32_16x16x32_bf16 a[132:135], a[220:223], a[156:159], a[132:135]
    v_mfma_f32_16x16x32_bf16 a[76:79], a[224:227], a[156:159], a[76:79]
    v_mfma_f32_16x16x32_bf16 a[108:111], a[228:231], a[156:159], a[108:111]
    ds_write_b128 v20, a[104:107] offset:4096
    buffer_load_dwordx4 v[240:243], v5, s[24:27], s44 offen sc1
    v_mfma_f32_16x16x32_bf16 a[112:115], a[164:167], a[156:159], a[112:115]
    v_mfma_f32_16x16x32_bf16 a[116:119], a[0:3], a[156:159], a[116:119]
    s_waitcnt vmcnt(11)
    v_mfma_f32_16x16x32_bf16 a[132:135], a[8:11], a[160:163], a[132:135]
    v_mfma_f32_16x16x32_bf16 a[76:79], a[12:15], a[160:163], a[76:79]
    s_add_u32 s45, s35, 22712320
    buffer_load_dwordx4 a[84:87], v4, s[24:27], s45 offen
    v_mfma_f32_16x16x32_bf16 a[108:111], a[196:199], a[160:163], a[108:111]
    v_mfma_f32_16x16x32_bf16 a[112:115], a[200:203], a[160:163], a[112:115]
    v_mfma_f32_16x16x32_bf16 a[116:119], a[204:207], a[160:163], a[116:119]
    s_waitcnt vmcnt(11)
    v_mfma_f32_16x16x32_bf16 a[132:135], a[208:211], a[176:179], a[132:135]
    buffer_load_dwordx4 a[88:91], v4, s[24:27], s45 offen offset:1024
    v_mfma_f32_16x16x32_bf16 a[76:79], a[136:139], a[176:179], a[76:79]
    v_mfma_f32_16x16x32_bf16 a[108:111], a[232:235], a[176:179], a[108:111]
    v_mfma_f32_16x16x32_bf16 a[112:115], a[236:239], a[176:179], a[112:115]
    v_mfma_f32_16x16x32_bf16 a[116:119], a[240:243], a[176:179], a[116:119]
    s_nop 2
    v_accvgpr_read_b32 v8, a132
    v_cmp_u_f32 vcc, v8, v8
    s_cbranch_vccnz G41
G41_R:
    s_waitcnt vmcnt(11)
    v_mfma_f32_16x16x32_bf16 a[96:99], a[20:23], a[180:183], 0
    ds_write_b128 v20, a[132:135] offset:7168
    buffer_load_dwordx4 a[156:159], v4, s[24:27], s45 offen offset:2048
    v_mfma_f32_16x16x32_bf16 a[100:103], a[24:27], a[180:183], 0
    v_mfma_f32_16x16x32_bf16 a[104:107], a[28:31], a[180:183], 0
    v_mfma_f32_16x16x32_bf16 a[144:147], a[32:35], a[180:183], 0
    ds_write_b128 v20, a[76:79] offset:8192
    v_mfma_f32_16x16x32_bf16 a[148:151], a[36:39], a[180:183], 0
    buffer_load_dwordx4 a[160:163], v4, s[24:27], s45 offen offset:3072
    s_waitcnt vmcnt(12)
    v_mfma_f32_16x16x32_bf16 a[96:99], a[40:43], a[184:187], a[96:99]
    v_mfma_f32_16x16x32_bf16 a[100:103], a[44:47], a[184:187], a[100:103]
    ds_write_b128 v20, a[108:111] offset:9216
    v_mfma_f32_16x16x32_bf16 a[104:107], a[140:143], a[184:187], a[104:107]
    v_mfma_f32_16x16x32_bf16 a[144:147], a[152:155], a[184:187], a[144:147]
    s_add_u32 s44, s70, 10749952
    s_add_u32 s44, s44, s71
    buffer_store_dwordx4 a[4:7], v9, s[24:27], s44 offen
    v_mfma_f32_16x16x32_bf16 a[148:151], a[216:219], a[184:187], a[148:151]
    ds_write_b128 v20, a[112:115] offset:10240
    s_waitcnt vmcnt(12)
    v_mfma_f32_16x16x32_bf16 a[96:99], a[220:223], a[192:195], a[96:99]
    v_mfma_f32_16x16x32_bf16 a[100:103], a[224:227], a[192:195], a[100:103]
    v_mfma_f32_16x16x32_bf16 a[104:107], a[228:231], a[192:195], a[104:107]
    ds_write_b128 v20, a[116:119] offset:11264
    buffer_load_dwordx4 a[176:179], v5, s[24:27], s45 offen
    v_mfma_f32_16x16x32_bf16 a[144:147], a[164:167], a[192:195], a[144:147]
    v_mfma_f32_16x16x32_bf16 a[148:151], a[0:3], a[192:195], a[148:151]
    s_waitcnt vmcnt(12)
    v_mfma_f32_16x16x32_bf16 a[96:99], a[8:11], a[212:215], a[96:99]
    s_waitcnt lgkmcnt(0)
    s_barrier
    s_add_u32 s44, s70, 10797056
    buffer_store_dwordx2 a[4:5], v10, s[24:27], s44 offen
    v_mfma_f32_16x16x32_bf16 a[100:103], a[12:15], a[212:215], a[100:103]
    ds_read_b128 v[40:43], v21 offset:0
    v_mfma_f32_16x16x32_bf16 a[104:107], a[196:199], a[212:215], a[104:107]
    ds_read_b128 v[60:63], v21 offset:1024
    v_mfma_f32_16x16x32_bf16 a[144:147], a[200:203], a[212:215], a[144:147]
    ds_read_b128 v[64:67], v21 offset:2048
    v_mfma_f32_16x16x32_bf16 a[148:151], a[204:207], a[212:215], a[148:151]
    ds_read_b128 v[68:71], v21 offset:3072
    buffer_load_dwordx4 a[132:135], v5, s[24:27], s45 offen offset:1024
    s_waitcnt vmcnt(13)
    v_mfma_f32_16x16x32_bf16 a[96:99], a[208:211], a[124:127], a[96:99]
    ds_read_b128 v[72:75], v21 offset:4096
    v_mfma_f32_16x16x32_bf16 a[100:103], a[136:139], a[124:127], a[100:103]
    ds_read_b128 v[76:79], v22 offset:7168
    v_mfma_f32_16x16x32_bf16 a[104:107], a[232:235], a[124:127], a[104:107]
    ds_read_b128 v[108:111], v22 offset:8192
    v_mfma_f32_16x16x32_bf16 a[144:147], a[236:239], a[124:127], a[144:147]
    ds_read_b128 v[112:115], v22 offset:9216
    v_mfma_f32_16x16x32_bf16 a[148:151], a[240:243], a[124:127], a[148:151]
    s_waitcnt lgkmcnt(2)
    v_add_f32 v40, v40, v76
    v_add_f32 v41, v41, v77
    v_accvgpr_read_b32 v8, a96
    v_cmp_u_f32 vcc, v8, v8
    s_cbranch_vccnz G42
G42_R:
    s_waitcnt vmcnt(12)
    v_mfma_f32_16x16x32_bf16 v[120:123], a[20:23], a[128:131], v[124:127]
    v_add_f32 v42, v42, v78
    v_add_f32 v43, v43, v79
    buffer_load_dwordx4 a[76:79], v5, s[24:27], s45 offen offset:2048
    v_mfma_f32_16x16x32_bf16 v[116:119], a[24:27], a[128:131], v[44:47]
    ds_read_b128 v[76:79], v22 offset:10240
    s_waitcnt lgkmcnt(2)
    v_add_f32 v60, v60, v108
    v_add_f32 v61, v61, v109
    v_mfma_f32_16x16x32_bf16 v[236:239], a[28:31], a[128:131], v[48:51]
    v_add_f32 v62, v62, v110
    v_add_f32 v63, v63, v111
    v_mfma_f32_16x16x32_bf16 v[232:235], a[32:35], a[128:131], v[52:55]
    ds_read_b128 v[108:111], v22 offset:11264
    s_waitcnt lgkmcnt(2)
    v_add_f32 v64, v64, v112
    v_add_f32 v65, v65, v113
    v_mfma_f32_16x16x32_bf16 v[228:231], a[36:39], a[128:131], v[56:59]
    ds_write_b128 v20, a[96:99] offset:14336
    v_add_f32 v66, v66, v114
    v_add_f32 v67, v67, v115
    s_waitcnt vmcnt(12)
    v_mfma_f32_16x16x32_bf16 v[120:123], a[40:43], a[120:123], v[120:123]
    s_waitcnt lgkmcnt(2)
    v_add_f32 v68, v68, v76
    v_add_f32 v69, v69, v77
    v_mfma_f32_16x16x32_bf16 v[116:119], a[44:47], a[120:123], v[116:119]
    v_add_f32 v70, v70, v78
    v_add_f32 v71, v71, v79
    v_mfma_f32_16x16x32_bf16 v[236:239], a[140:143], a[120:123], v[236:239]
    ds_write_b128 v20, a[100:103] offset:15360
    s_waitcnt lgkmcnt(2)
    v_add_f32 v72, v72, v108
    v_add_f32 v73, v73, v109
    v_mfma_f32_16x16x32_bf16 v[232:235], a[152:155], a[120:123], v[232:235]
    v_add_f32 v74, v74, v110
    v_add_f32 v75, v75, v111
    v_mfma_f32_16x16x32_bf16 v[228:231], a[216:219], a[120:123], v[228:231]
    buffer_load_dwordx4 a[108:111], v5, s[24:27], s45 offen offset:3072
    s_waitcnt vmcnt(12)
    v_mfma_f32_16x16x32_bf16 v[120:123], a[220:223], v[248:251], v[120:123]
    ds_write_b128 v20, a[104:107] offset:16384
    v_mfma_f32_16x16x32_bf16 v[116:119], a[224:227], v[248:251], v[116:119]
    v_mfma_f32_16x16x32_bf16 v[236:239], a[228:231], v[248:251], v[236:239]
    v_mfma_f32_16x16x32_bf16 v[232:235], a[164:167], v[248:251], v[232:235]
    ds_write_b128 v20, a[144:147] offset:17408
    v_mfma_f32_16x16x32_bf16 v[228:231], a[0:3], v[248:251], v[228:231]
    s_waitcnt vmcnt(11)
    v_mfma_f32_16x16x32_bf16 v[120:123], a[8:11], v[244:247], v[120:123]
    v_mfma_f32_16x16x32_bf16 v[116:119], a[12:15], v[244:247], v[116:119]
    ds_write_b128 v20, a[148:151] offset:18432
    v_mfma_f32_16x16x32_bf16 v[236:239], a[196:199], v[244:247], v[236:239]
    v_mfma_f32_16x16x32_bf16 v[232:235], a[200:203], v[244:247], v[232:235]
    v_mfma_f32_16x16x32_bf16 v[228:231], a[204:207], v[244:247], v[228:231]
    s_waitcnt vmcnt(3)
    s_waitcnt lgkmcnt(0)
    s_barrier
    s_add_u32 s45, s35, 22720512
    buffer_load_dwordx4 a[112:115], v4, s[24:27], s45 offen
    v_mfma_f32_16x16x32_bf16 v[120:123], a[208:211], v[240:243], v[120:123]
    s_cmp_eq_u32 s47, 0
    s_cbranch_scc1 G_RP2_S
    buffer_store_byte v17, v19, s[24:27], s64 offen offset:2048
G_RP2_R:
    v_mfma_f32_16x16x32_bf16 v[116:119], a[136:139], v[240:243], v[116:119]
    ds_read_b128 v[76:79], v23 offset:14336
    v_mfma_f32_16x16x32_bf16 v[236:239], a[232:235], v[240:243], v[236:239]
    ds_read_b128 v[108:111], v23 offset:15360
    v_mfma_f32_16x16x32_bf16 v[232:235], a[236:239], v[240:243], v[232:235]
    ds_read_b128 v[112:115], v23 offset:16384
    v_mfma_f32_16x16x32_bf16 v[228:231], a[240:243], v[240:243], v[228:231]
    s_waitcnt lgkmcnt(2)
    v_add_f32 v40, v40, v76
    v_add_f32 v41, v41, v77
    buffer_load_dwordx4 a[116:119], v4, s[24:27], s45 offen offset:1024
    v_cmp_u_f32 vcc, v120, v120
    s_cbranch_vccnz G43
G43_R:
    v_add_f32 v42, v42, v78
    v_add_f32 v43, v43, v79
    s_waitcnt lgkmcnt(1)
    v_add_f32 v60, v60, v108
    v_add_f32 v61, v61, v109
    ds_read_b128 v[76:79], v23 offset:17408
    v_add_f32 v62, v62, v110
    v_add_f32 v63, v63, v111
    s_waitcnt lgkmcnt(1)
    v_add_f32 v64, v64, v112
    v_add_f32 v65, v65, v113
    ds_read_b128 v[108:111], v23 offset:18432
    v_add_f32 v66, v66, v114
    v_add_f32 v67, v67, v115
    s_waitcnt lgkmcnt(1)
    v_add_f32 v68, v68, v76
    v_add_f32 v69, v69, v77
    v_add_f32 v70, v70, v78
    v_add_f32 v71, v71, v79
    s_waitcnt lgkmcnt(0)
    v_add_f32 v72, v72, v108
    v_add_f32 v73, v73, v109
    buffer_load_dwordx4 a[4:7], v4, s[24:27], s45 offen offset:2048
    v_add_f32 v74, v74, v110
    v_add_f32 v75, v75, v111
    v_pk_add_f32 v[120:121], v[120:121], v[40:41]
    v_pk_add_f32 v[122:123], v[122:123], v[42:43]
    v_pk_add_f32 v[116:117], v[116:117], v[60:61]
    v_pk_add_f32 v[118:119], v[118:119], v[62:63]
    v_pk_add_f32 v[236:237], v[236:237], v[64:65]
    v_pk_add_f32 v[238:239], v[238:239], v[66:67]
    v_pk_add_f32 v[232:233], v[232:233], v[68:69]
    v_pk_add_f32 v[234:235], v[234:235], v[70:71]
    v_pk_add_f32 v[228:229], v[228:229], v[72:73]
    v_pk_add_f32 v[230:231], v[230:231], v[74:75]
    v_cvt_pk_bf16_f32 v80, v120, v121
    v_cvt_pk_bf16_f32 v81, v122, v123
    v_cvt_pk_bf16_f32 v82, v116, v117
    v_cvt_pk_bf16_f32 v83, v118, v119
    v_cvt_pk_bf16_f32 v84, v236, v237
    v_cvt_pk_bf16_f32 v85, v238, v239
    v_cvt_pk_bf16_f32 v86, v232, v233
    v_cvt_pk_bf16_f32 v87, v234, v235
    v_cvt_pk_bf16_f32 v88, v228, v229
    v_cvt_pk_bf16_f32 v89, v230, v231
    s_cmp_eq_u32 s47, 0
    s_cbranch_scc1 G_SX_S
    s_add_u32 s28, s67, 2752512
    buffer_store_dwordx4 v[80:83], v4, s[24:27], s28 offen
    buffer_store_dwordx4 v[84:87], v4, s[24:27], s28 offen offset:1024
    s_add_u32 s28, s68, 2752512
    buffer_store_dwordx2 v[88:89], v4, s[24:27], s28 offen
G_SX_R:
    v_lshlrev_b32 v120, 16, v80
    v_and_b32 v121, 0xffff0000, v80
    v_lshlrev_b32 v122, 16, v81
    v_and_b32 v123, 0xffff0000, v81
    v_lshlrev_b32 v116, 16, v82
    v_and_b32 v117, 0xffff0000, v82
    v_lshlrev_b32 v118, 16, v83
    v_and_b32 v119, 0xffff0000, v83
    v_lshlrev_b32 v236, 16, v84
    v_and_b32 v237, 0xffff0000, v84
    v_lshlrev_b32 v238, 16, v85
    v_and_b32 v239, 0xffff0000, v85
    v_lshlrev_b32 v232, 16, v86
    v_and_b32 v233, 0xffff0000, v86
    v_lshlrev_b32 v234, 16, v87
    v_and_b32 v235, 0xffff0000, v87
    v_lshlrev_b32 v228, 16, v88
    buffer_load_dwordx4 a[180:183], v4, s[24:27], s45 offen offset:3072
    v_and_b32 v229, 0xffff0000, v88
    v_lshlrev_b32 v230, 16, v89
    v_and_b32 v231, 0xffff0000, v89
    v_pk_add_f32 v[92:93], v[120:121], v[122:123]
    v_pk_mul_f32 v[94:95], v[120:121], v[120:121]
    v_pk_fma_f32 v[94:95], v[122:123], v[122:123], v[94:95]
    v_pk_add_f32 v[92:93], v[92:93], v[116:117]
    v_pk_fma_f32 v[94:95], v[116:117], v[116:117], v[94:95]
    v_pk_add_f32 v[92:93], v[92:93], v[118:119]
    v_pk_fma_f32 v[94:95], v[118:119], v[118:119], v[94:95]
    v_pk_add_f32 v[92:93], v[92:93], v[236:237]
    v_pk_fma_f32 v[94:95], v[236:237], v[236:237], v[94:95]
    buffer_load_dwordx4 a[184:187], v5, s[24:27], s45 offen
    v_pk_add_f32 v[92:93], v[92:93], v[238:239]
    v_pk_fma_f32 v[94:95], v[238:239], v[238:239], v[94:95]
    v_pk_add_f32 v[92:93], v[92:93], v[232:233]
    v_pk_fma_f32 v[94:95], v[232:233], v[232:233], v[94:95]
    v_pk_add_f32 v[92:93], v[92:93], v[234:235]
    v_pk_fma_f32 v[94:95], v[234:235], v[234:235], v[94:95]
    v_pk_add_f32 v[92:93], v[92:93], v[228:229]
    v_pk_fma_f32 v[94:95], v[228:229], v[228:229], v[94:95]
    buffer_load_dwordx4 a[192:195], v5, s[24:27], s45 offen offset:1024
    v_pk_add_f32 v[92:93], v[92:93], v[230:231]
    v_pk_fma_f32 v[94:95], v[230:231], v[230:231], v[94:95]
    v_add_f32 v92, v92, v93
    v_add_f32 v93, v94, v95
    v_mov_b32 v94, v92
    s_nop 1
    v_permlane16_swap_b32 v92, v94
    v_add_f32 v92, v92, v94
    v_mov_b32 v94, v92
    s_nop 1
    v_permlane32_swap_b32 v92, v94
    v_add_f32 v92, v92, v94
    v_mov_b32 v95, v93
    s_nop 1
    v_permlane16_swap_b32 v93, v95
    v_add_f32 v93, v93, v95
    v_mov_b32 v95, v93
    s_nop 1
    v_permlane32_swap_b32 v93, v95
    v_add_f32 v93, v93, v95
    s_cmp_eq_u32 s47, 0
    s_cbranch_scc1 G_SS_S
    s_add_u32 s28, s73, 17825792
    s_mov_b64 exec, 0xffff
    buffer_store_dwordx2 v[92:93], v4, s[24:27], s28 offen
    s_mov_b64 exec, -1
G_SS_R:
    s_cmp_eq_u32 s47, 0
    s_cbranch_scc1 G_RL2
    s_load_dwordx8 s[56:63], s[24:25], s9 offset:2048
G_RL2:
    v_lshlrev_b32 v40, 16, v96
    v_and_b32 v41, 0xffff0000, v96
    v_lshlrev_b32 v42, 16, v97
    v_and_b32 v43, 0xffff0000, v97
    v_lshlrev_b32 v60, 16, v98
    v_and_b32 v61, 0xffff0000, v98
    v_lshlrev_b32 v62, 16, v99
    v_and_b32 v63, 0xffff0000, v99
    v_lshlrev_b32 v64, 16, v100
    v_and_b32 v65, 0xffff0000, v100
    buffer_load_dwordx4 a[212:215], v5, s[24:27], s45 offen offset:2048
    v_lshlrev_b32 v66, 16, v101
    v_and_b32 v67, 0xffff0000, v101
    v_lshlrev_b32 v68, 16, v102
    v_and_b32 v69, 0xffff0000, v102
    v_lshlrev_b32 v70, 16, v103
    v_and_b32 v71, 0xffff0000, v103
    v_lshlrev_b32 v72, 16, v104
    v_and_b32 v73, 0xffff0000, v104
    v_lshlrev_b32 v74, 16, v105
    v_and_b32 v75, 0xffff0000, v105
    v_pk_add_f32 v[120:121], v[120:121], v[40:41]
    v_pk_add_f32 v[122:123], v[122:123], v[42:43]
    v_pk_add_f32 v[116:117], v[116:117], v[60:61]
    v_pk_add_f32 v[118:119], v[118:119], v[62:63]
    v_pk_add_f32 v[236:237], v[236:237], v[64:65]
    v_pk_add_f32 v[238:239], v[238:239], v[66:67]
    v_pk_add_f32 v[232:233], v[232:233], v[68:69]
    v_pk_add_f32 v[234:235], v[234:235], v[70:71]
    v_pk_add_f32 v[228:229], v[228:229], v[72:73]
    v_pk_add_f32 v[230:231], v[230:231], v[74:75]
    s_waitcnt lgkmcnt(0)
    s_and_b64 s[56:57], s[56:57], s[58:59]
    s_and_b64 s[60:61], s[60:61], s[62:63]
    s_and_b64 s[56:57], s[56:57], s[60:61]
    s_and_b32 s56, s56, s57
    s_and_b32 s56, s56, s8
    s_mul_i32 s56, s56, s47
    s_cmp_lg_u32 s56, s8
    s_cbranch_scc1 G_RC2
G_RC2_R:
    buffer_load_dwordx4 a[124:127], v5, s[24:27], s45 offen offset:3072
    ds_write_b128 v20, v[120:123] offset:21504
    ds_write_b128 v20, v[116:119] offset:22528
    ds_write_b128 v20, v[236:239] offset:23552
    ds_write_b128 v20, v[232:235] offset:24576
    s_add_u32 s45, s35, 22728704
    buffer_load_dwordx4 a[96:99], v4, s[24:27], s45 offen
    ds_write_b128 v20, v[228:231] offset:25600
    s_add_u32 s44, s52, 2752512
    s_add_u32 s44, s44, s11
    buffer_load_dwordx4 a[24:27], v4, s[24:27], s44 offen sc1
    buffer_load_dwordx4 a[28:31], v4, s[24:27], s44 offen offset:1024 sc1
    buffer_load_dwordx4 a[32:35], v4, s[24:27], s44 offen offset:2048 sc1
    buffer_load_dwordx4 a[36:39], v4, s[24:27], s44 offen offset:3072 sc1
    buffer_load_dwordx4 a[40:43], v5, s[24:27], s44 offen sc1
    buffer_load_dwordx4 a[44:47], v4, s[24:27], s45 offen offset:1024
    buffer_load_dwordx4 a[140:143], v4, s[24:27], s45 offen offset:2048
    s_add_u32 s44, s52, 2752512
    s_add_u32 s44, s44, s12
    buffer_load_dwordx4 a[152:155], v4, s[24:27], s44 offen sc1
    s_add_u32 s45, s43, 18014208
    s_add_u32 m0, s53, 0
    s_nop 0
    buffer_load_dwordx4 v4, s[24:27], s45 offen lds
    s_add_u32 s45, s43, 18015232
    s_add_u32 m0, s53, 4096
    s_nop 0
    buffer_load_dwordx4 v4, s[24:27], s45 offen lds
    s_add_u32 s45, s43, 18016256
    s_add_u32 m0, s53, 8192
    s_nop 0
    buffer_load_dwordx4 v4, s[24:27], s45 offen lds
    s_waitcnt vmcnt(10)
    v_mfma_f32_16x16x32_bf16 a[100:103], a[244:247], a[24:27], 0
    v_mfma_f32_16x16x32_bf16 a[104:107], a[248:251], a[24:27], 0
    v_mfma_f32_16x16x32_bf16 a[144:147], a[168:171], a[24:27], 0
    v_mfma_f32_16x16x32_bf16 a[148:151], a[172:175], a[24:27], 0
    v_mfma_f32_16x16x32_bf16 a[128:131], a[188:191], a[24:27], 0
    buffer_load_dwordx4 a[216:219], v4, s[24:27], s44 offen offset:1024 sc1
    v_mfma_f32_16x16x32_bf16 a[120:123], a[92:95], a[24:27], 0
    v_mfma_f32_16x16x32_bf16 a[20:23], a[252:255], a[24:27], 0
    s_waitcnt vmcnt(10)
    v_mfma_f32_16x16x32_bf16 a[100:103], a[80:83], a[28:31], a[100:103]
    v_mfma_f32_16x16x32_bf16 a[104:107], a[16:19], a[28:31], a[104:107]
    v_mfma_f32_16x16x32_bf16 a[144:147], a[48:51], a[28:31], a[144:147]
    buffer_load_dwordx4 a[220:223], v4, s[24:27], s44 offen offset:2048 sc1
    v_mfma_f32_16x16x32_bf16 a[148:151], a[52:55], a[28:31], a[148:151]
    v_mfma_f32_16x16x32_bf16 a[128:131], a[56:59], a[28:31], a[128:131]
    v_mfma_f32_16x16x32_bf16 a[120:123], a[60:63], a[28:31], a[120:123]
    v_mfma_f32_16x16x32_bf16 a[20:23], a[64:67], a[28:31], a[20:23]
    buffer_load_dwordx4 a[224:227], v4, s[24:27], s44 offen offset:3072 sc1
    s_waitcnt vmcnt(11)
    v_mfma_f32_16x16x32_bf16 a[100:103], a[68:71], a[32:35], a[100:103]
    v_mfma_f32_16x16x32_bf16 a[104:107], a[72:75], a[32:35], a[104:107]
    v_mfma_f32_16x16x32_bf16 a[144:147], a[84:87], a[32:35], a[144:147]
    v_mfma_f32_16x16x32_bf16 a[148:151], a[88:91], a[32:35], a[148:151]
    buffer_load_dwordx4 a[228:231], v5, s[24:27], s44 offen sc1
    v_mfma_f32_16x16x32_bf16 a[128:131], a[156:159], a[32:35], a[128:131]
    v_mfma_f32_16x16x32_bf16 a[120:123], a[160:163], a[32:35], a[120:123]
    v_mfma_f32_16x16x32_bf16 a[20:23], a[176:179], a[32:35], a[20:23]
    s_waitcnt vmcnt(11)
    v_mfma_f32_16x16x32_bf16 a[100:103], a[132:135], a[36:39], a[100:103]
    s_add_u32 s44, s52, 2752512
    s_add_u32 s44, s44, s13
    buffer_load_dwordx4 a[164:167], v4, s[24:27], s44 offen sc1
    v_mfma_f32_16x16x32_bf16 a[104:107], a[76:79], a[36:39], a[104:107]
    v_mfma_f32_16x16x32_bf16 a[144:147], a[108:111], a[36:39], a[144:147]
    v_mfma_f32_16x16x32_bf16 a[148:151], a[112:115], a[36:39], a[148:151]
    v_mfma_f32_16x16x32_bf16 a[128:131], a[116:119], a[36:39], a[128:131]
    buffer_load_dwordx4 a[0:3], v4, s[24:27], s44 offen offset:1024 sc1
    v_mfma_f32_16x16x32_bf16 a[120:123], a[4:7], a[36:39], a[120:123]
    v_mfma_f32_16x16x32_bf16 a[20:23], a[180:183], a[36:39], a[20:23]
    s_waitcnt vmcnt(12)
    v_mfma_f32_16x16x32_bf16 a[100:103], a[184:187], a[40:43], a[100:103]
    v_mfma_f32_16x16x32_bf16 a[104:107], a[192:195], a[40:43], a[104:107]
    buffer_load_dwordx4 a[8:11], v4, s[24:27], s44 offen offset:2048 sc1
    v_mfma_f32_16x16x32_bf16 a[144:147], a[212:215], a[40:43], a[144:147]
    v_mfma_f32_16x16x32_bf16 a[148:151], a[124:127], a[40:43], a[148:151]
    v_mfma_f32_16x16x32_bf16 a[128:131], a[96:99], a[40:43], a[128:131]
    s_waitcnt vmcnt(12)
    v_mfma_f32_16x16x32_bf16 a[120:123], a[44:47], a[40:43], a[120:123]
    buffer_load_dwordx4 a[12:15], v4, s[24:27], s44 offen offset:3072 sc1
    s_waitcnt vmcnt(12)
    v_mfma_f32_16x16x32_bf16 a[20:23], a[140:143], a[40:43], a[20:23]
    v_accvgpr_read_b32 v8, a100
    v_cmp_u_f32 vcc, v8, v8
    s_cbranch_vccnz G5a0
G5a0_R:
    s_waitcnt vmcnt(11)
    v_mfma_f32_16x16x32_bf16 a[196:199], a[244:247], a[152:155], 0
    ds_write_b128 v20, a[100:103] offset:0
    v_mfma_f32_16x16x32_bf16 a[200:203], a[248:251], a[152:155], 0
    v_mfma_f32_16x16x32_bf16 a[204:207], a[168:171], a[152:155], 0
    ds_write_b128 v20, a[104:107] offset:1024
    buffer_load_dwordx4 a[240:243], v5, s[24:27], s44 offen sc1
    v_mfma_f32_16x16x32_bf16 a[208:211], a[172:175], a[152:155], 0
    v_mfma_f32_16x16x32_bf16 a[136:139], a[188:191], a[152:155], 0
    ds_write_b128 v20, a[144:147] offset:2048
    v_mfma_f32_16x16x32_bf16 a[232:235], a[92:95], a[152:155], 0
    v_mfma_f32_16x16x32_bf16 a[236:239], a[252:255], a[152:155], 0
    ds_write_b128 v20, a[148:151] offset:3072
    s_add_u32 s44, s72, 17825792
    buffer_load_dwordx4 v[112:115], v4, s[24:27], s44 offen sc1
    s_waitcnt vmcnt(9)
    v_mfma_f32_16x16x32_bf16 a[196:199], a[80:83], a[216:219], a[196:199]
    v_mfma_f32_16x16x32_bf16 a[200:203], a[16:19], a[216:219], a[200:203]
    ds_write_b128 v20, a[128:131] offset:4096
    v_mfma_f32_16x16x32_bf16 a[204:207], a[48:51], a[216:219], a[204:207]
    v_mfma_f32_16x16x32_bf16 a[208:211], a[52:55], a[216:219], a[208:211]
    ds_write_b128 v20, a[120:123] offset:5120
    s_add_u32 s44, s52, 2752512
    s_add_u32 s44, s44, s10
    buffer_load_dwordx4 a[24:27], v4, s[24:27], s44 offen sc1
    v_mfma_f32_16x16x32_bf16 a[136:139], a[56:59], a[216:219], a[136:139]
    v_mfma_f32_16x16x32_bf16 a[232:235], a[60:63], a[216:219], a[232:235]
    ds_write_b128 v20, a[20:23] offset:6144
    v_mfma_f32_16x16x32_bf16 a[236:239], a[64:67], a[216:219], a[236:239]
    s_waitcnt vmcnt(9)
    v_mfma_f32_16x16x32_bf16 a[196:199], a[68:71], a[220:223], a[196:199]
    s_waitcnt lgkmcnt(0)
    s_barrier
    buffer_load_dwordx4 a[28:31], v4, s[24:27], s44 offen offset:1024 sc1
    v_mfma_f32_16x16x32_bf16 a[200:203], a[72:75], a[220:223], a[200:203]
    ds_read_b128 a[100:103], v22 offset:0
    v_mfma_f32_16x16x32_bf16 a[204:207], a[84:87], a[220:223], a[204:207]
    ds_read_b128 a[104:107], v22 offset:1024
    v_mfma_f32_16x16x32_bf16 a[208:211], a[88:91], a[220:223], a[208:211]
    ds_read_b128 a[144:147], v22 offset:2048
    v_mfma_f32_16x16x32_bf16 a[136:139], a[156:159], a[220:223], a[136:139]
    ds_read_b128 a[148:151], v22 offset:3072
    buffer_load_dwordx4 a[32:35], v4, s[24:27], s44 offen offset:2048 sc1
    v_mfma_f32_16x16x32_bf16 a[232:235], a[160:163], a[220:223], a[232:235]
    ds_read_b128 a[128:131], v22 offset:4096
    v_mfma_f32_16x16x32_bf16 a[236:239], a[176:179], a[220:223], a[236:239]
    ds_read_b128 a[120:123], v22 offset:5120
    s_waitcnt vmcnt(10)
    v_mfma_f32_16x16x32_bf16 a[196:199], a[132:135], a[224:227], a[196:199]
    ds_read_b128 a[20:23], v22 offset:6144
    v_mfma_f32_16x16x32_bf16 a[200:203], a[76:79], a[224:227], a[200:203]
    ds_read_b128 v[48:51], v12 offset:0
    buffer_load_dwordx4 a[36:39], v4, s[24:27], s44 offen offset:3072 sc1
    v_mfma_f32_16x16x32_bf16 a[204:207], a[108:111], a[224:227], a[204:207]
    ds_read_b128 v[52:55], v12 offset:512
    v_mfma_f32_16x16x32_bf16 a[208:211], a[112:115], a[224:227], a[208:211]
    ds_read_b128 v[56:59], v12 offset:4096
    v_mfma_f32_16x16x32_bf16 a[136:139], a[116:119], a[224:227], a[136:139]
    ds_read_b128 v[76:79], v12 offset:4608
    v_mfma_f32_16x16x32_bf16 a[232:235], a[4:7], a[224:227], a[232:235]
    ds_read_b128 v[108:111], v12 offset:8192
    buffer_load_dwordx4 a[40:43], v5, s[24:27], s44 offen sc1
    v_mfma_f32_16x16x32_bf16 a[236:239], a[180:183], a[224:227], a[236:239]
    s_waitcnt vmcnt(11)
    v_mfma_f32_16x16x32_bf16 a[196:199], a[184:187], a[228:231], a[196:199]
    v_mfma_f32_16x16x32_bf16 a[200:203], a[192:195], a[228:231], a[200:203]
    s_waitcnt lgkmcnt(3)
    v_add_f32 v48, v48, v52
    v_add_f32 v49, v49, v53
    v_mfma_f32_16x16x32_bf16 a[204:207], a[212:215], a[228:231], a[204:207]
    v_add_f32 v50, v50, v54
    v_add_f32 v51, v51, v55
    s_add_u32 s45, s37, 25025536
    s_add_u32 m0, s31, 26624
    s_nop 0
    buffer_load_dwordx4 v4, s[24:27], s45 offen lds
    v_mfma_f32_16x16x32_bf16 a[208:211], a[124:127], a[228:231], a[208:211]
    s_waitcnt lgkmcnt(1)
    v_add_f32 v56, v56, v76
    v_add_f32 v57, v57, v77
    v_mfma_f32_16x16x32_bf16 a[136:139], a[96:99], a[228:231], a[136:139]
    v_add_f32 v58, v58, v78
    v_add_f32 v59, v59, v79
    v_mfma_f32_16x16x32_bf16 a[232:235], a[44:47], a[228:231], a[232:235]
    s_waitcnt lgkmcnt(0)
    v_add_f32 v48, v48, v108
    v_add_f32 v49, v49, v109
    v_mfma_f32_16x16x32_bf16 a[236:239], a[140:143], a[228:231], a[236:239]
    v_add_f32 v50, v50, v110
    v_add_f32 v51, v51, v111
    s_add_u32 s45, s37, 25026560
    s_add_u32 m0, s31, 27648
    s_nop 0
    buffer_load_dwordx4 v4, s[24:27], s45 offen lds
    v_accvgpr_read_b32 v8, a196
    v_cmp_u_f32 vcc, v8, v8
    s_cbranch_vccnz G5a1
G5a1_R:
    s_waitcnt vmcnt(12)
    v_mfma_f32_16x16x32_bf16 a[152:155], a[244:247], a[164:167], a[100:103]
    v_add_f32 v48, v48, v56
    v_add_f32 v49, v49, v57
    v_mfma_f32_16x16x32_bf16 a[216:219], a[248:251], a[164:167], a[104:107]
    v_add_f32 v50, v50, v58
    v_add_f32 v51, v51, v59
    s_add_u32 s44, s30, 2752512
    s_add_u32 s44, s44, s11
    buffer_load_dwordx4 a[220:223], v4, s[24:27], s44 offen sc1
    s_waitcnt vmcnt(12)
    v_mfma_f32_16x16x32_bf16 a[152:155], a[80:83], a[0:3], a[152:155]
    ds_write_b128 v12, v[48:51]
    s_waitcnt vmcnt(8)
    v_add_f32 v125, v112, v114
    v_add_f32 v127, v113, v115
    v_add_f32 v45, v125, v127
    v_cmp_u_f32 vcc, v45, v45
    s_cbranch_vccnz G5a_T
G5a_TR:
    v_mfma_f32_16x16x32_bf16 a[216:219], a[16:19], a[0:3], a[216:219]
    ds_write_b128 v20, a[196:199] offset:7168
    v_mov_b32 v45, v125
    s_nop 1
    v_permlane16_swap_b32 v125, v45
    buffer_load_dwordx4 a[224:227], v4, s[24:27], s44 offen offset:1024 sc1
    v_mfma_f32_16x16x32_bf16 a[152:155], a[68:71], a[8:11], a[152:155]
    v_add_f32 v125, v125, v45
    v_mov_b32 v45, v125
    v_mfma_f32_16x16x32_bf16 a[216:219], a[72:75], a[8:11], a[216:219]
    ds_write_b128 v20, a[200:203] offset:8192
    v_permlane32_swap_b32 v125, v45
    v_add_f32 v125, v125, v45
    v_mfma_f32_16x16x32_bf16 a[152:155], a[132:135], a[12:15], a[152:155]
    v_mov_b32 v47, v127
    s_nop 1
    v_permlane16_swap_b32 v127, v47
    buffer_load_dwordx4 a[228:231], v4, s[24:27], s44 offen offset:2048 sc1
    v_mfma_f32_16x16x32_bf16 a[216:219], a[76:79], a[12:15], a[216:219]
    ds_write_b128 v20, a[204:207] offset:9216
    v_add_f32 v127, v127, v47
    v_mov_b32 v47, v127
    v_mfma_f32_16x16x32_bf16 a[152:155], a[184:187], a[240:243], a[152:155]
    s_nop 0
    v_permlane32_swap_b32 v127, v47
    v_add_f32 v127, v127, v47
    v_mfma_f32_16x16x32_bf16 a[216:219], a[192:195], a[240:243], a[216:219]
    ds_write_b128 v20, a[208:211] offset:10240
    v_mul_f32 v125, 0x3acccccd, v125
    v_mul_f32 v127, 0x3acccccd, v127
    buffer_load_dwordx4 v[224:227], v4, s[24:27], s44 offen offset:3072 sc1
    v_fma_f32 v127, -v125, v125, v127
    v_max_f32 v127, 0, v127
    v_accvgpr_read_b32 v8, a152
    v_cmp_u_f32 vcc, v8, v8
    s_cbranch_vccnz G5a2
G5a2_R:
    v_mfma_f32_16x16x32_bf16 a[144:147], a[168:171], a[164:167], a[144:147]
    ds_write_b128 v20, a[136:139] offset:11264
    v_cvt_pk_bf16_f32 v125, v125, v125
    v_lshlrev_b32 v125, 16, v125
    v_mfma_f32_16x16x32_bf16 a[148:151], a[172:175], a[164:167], a[148:151]
    v_cvt_pk_bf16_f32 v127, v127, v127
    v_lshlrev_b32 v127, 16, v127
    buffer_load_dwordx4 a[100:103], v5, s[24:27], s44 offen sc1
    v_mfma_f32_16x16x32_bf16 a[144:147], a[48:51], a[0:3], a[144:147]
    ds_write_b128 v20, a[232:235] offset:12288
    v_add_f32 v127, 0x3727c5ac, v127
    v_cvt_pk_bf16_f32 v127, v127, v127
    v_mfma_f32_16x16x32_bf16 a[148:151], a[52:55], a[0:3], a[148:151]
    v_lshlrev_b32 v127, 16, v127
    v_sqrt_f32 v127, v127
    v_mfma_f32_16x16x32_bf16 a[144:147], a[84:87], a[8:11], a[144:147]
    ds_write_b128 v20, a[236:239] offset:13312
    v_cvt_pk_bf16_f32 v127, v127, v127
    v_lshlrev_b32 v127, 16, v127
    s_add_u32 s44, s32, 17825792
    buffer_load_dwordx4 v[84:87], v4, s[24:27], s44 offen sc1
    v_mfma_f32_16x16x32_bf16 a[148:151], a[88:91], a[8:11], a[148:151]
    v_rcp_f32 v127, v127
    v_mfma_f32_16x16x32_bf16 a[144:147], a[108:111], a[12:15], a[144:147]
    s_waitcnt lgkmcnt(0)
    s_barrier
    v_mul_f32 v124, 0xc0135761, v127
    v_mul_f32 v126, v127, v127
    s_add_u32 s45, s37, 25027584
    s_add_u32 m0, s31, 28672
    s_nop 0
    buffer_load_dwordx4 v4, s[24:27], s45 offen lds
    v_mfma_f32_16x16x32_bf16 a[148:151], a[112:115], a[12:15], a[148:151]
    ds_read_b128 v[120:123], v22 offset:7168
    v_mul_f32 v126, v126, v127
    v_mul_f32 v126, 0xbdd2d3e8, v126
    v_mfma_f32_16x16x32_bf16 a[144:147], a[212:215], a[240:243], a[144:147]
    ds_read_b128 v[116:119], v22 offset:8192
    v_rcp_f32 v44, v127
    v_mfma_f32_16x16x32_bf16 a[148:151], a[124:127], a[240:243], a[148:151]
    ds_read_b128 v[40:43], v22 offset:9216
    v_sub_f32 v46, 0, v125
    s_add_u32 s45, s37, 25028608
    s_add_u32 m0, s31, 29696
    s_nop 0
    buffer_load_dwordx4 v4, s[24:27], s45 offen lds
    v_mfma_f32_16x16x32_bf16 a[128:131], a[188:191], a[164:167], a[128:131]
    ds_read_b128 v[60:63], v22 offset:10240
    v_mfma_f32_16x16x32_bf16 a[120:123], a[92:95], a[164:167], a[120:123]
    ds_read_b128 v[64:67], v22 offset:11264
    v_mfma_f32_16x16x32_bf16 a[20:23], a[252:255], a[164:167], a[20:23]
    ds_read_b128 v[68:71], v22 offset:12288
    v_mfma_f32_16x16x32_bf16 a[128:131], a[56:59], a[0:3], a[128:131]
    ds_read_b128 v[72:75], v22 offset:13312
    s_add_u32 s45, s37, 25029632
    s_add_u32 m0, s31, 30720
    s_nop 0
    buffer_load_dwordx4 v4, s[24:27], s45 offen lds
    v_mfma_f32_16x16x32_bf16 a[120:123], a[60:63], a[0:3], a[120:123]
    ds_read_b128 v[96:99], v4 offset:0
    v_mfma_f32_16x16x32_bf16 a[20:23], a[64:67], a[0:3], a[20:23]
    ds_read_b128 v[100:103], v4 offset:1024
    v_mfma_f32_16x16x32_bf16 a[128:131], a[156:159], a[8:11], a[128:131]
    ds_read_b128 v[104:107], v4 offset:2048
    v_mfma_f32_16x16x32_bf16 a[120:123], a[160:163], a[8:11], a[120:123]
    ds_read_b128 v[80:83], v4 offset:3072
    s_add_u32 s45, s37, 25030656
    s_add_u32 m0, s31, 31744
    s_nop 0
    buffer_load_dwordx4 v4, s[24:27], s45 offen lds
    v_mfma_f32_16x16x32_bf16 a[20:23], a[176:179], a[8:11], a[20:23]
    v_mfma_f32_16x16x32_bf16 a[128:131], a[116:119], a[12:15], a[128:131]
    v_mfma_f32_16x16x32_bf16 a[120:123], a[4:7], a[12:15], a[120:123]
    s_waitcnt lgkmcnt(2)
    v_add_f32 v96, v96, v100
    v_add_f32 v97, v97, v101
    v_mfma_f32_16x16x32_bf16 a[20:23], a[180:183], a[12:15], a[20:23]
    v_add_f32 v98, v98, v102
    v_add_f32 v99, v99, v103
    s_add_u32 s45, s37, 25031680
    s_add_u32 m0, s31, 32768
    s_nop 0
    buffer_load_dwordx4 v4, s[24:27], s45 offen lds
    v_mfma_f32_16x16x32_bf16 a[128:131], a[96:99], a[240:243], a[128:131]
    s_waitcnt lgkmcnt(0)
    v_add_f32 v104, v104, v80
    v_add_f32 v105, v105, v81
    v_mfma_f32_16x16x32_bf16 a[120:123], a[44:47], a[240:243], a[120:123]
    v_add_f32 v106, v106, v82
    v_add_f32 v107, v107, v83
    v_mfma_f32_16x16x32_bf16 a[20:23], a[140:143], a[240:243], a[20:23]
    v_add_f32 v96, v96, v104
    v_add_f32 v97, v97, v105
    s_waitcnt vmcnt(17)
    v_mfma_f32_16x16x32_bf16 v[220:223], a[244:247], a[24:27], v[120:123]
    v_add_f32 v98, v98, v106
    v_add_f32 v99, v99, v107
    s_add_u32 s44, s30, 2752512
    s_add_u32 s44, s44, s12
    buffer_load_dwordx4 a[104:107], v4, s[24:27], s44 offen sc1
    v_mfma_f32_16x16x32_bf16 v[216:219], a[248:251], a[24:27], v[116:119]
    ds_write_b128 v12, v[96:99] offset:4096
    s_waitcnt vmcnt(17)
    v_mfma_f32_16x16x32_bf16 v[220:223], a[80:83], a[28:31], v[220:223]
    ds_write_b128 v20, a[152:155] offset:0
    buffer_load_dwordx4 a[196:199], v4, s[24:27], s44 offen offset:1024 sc1
    v_mfma_f32_16x16x32_bf16 v[216:219], a[16:19], a[28:31], v[216:219]
    s_waitcnt vmcnt(17)
    v_mfma_f32_16x16x32_bf16 v[220:223], a[68:71], a[32:35], v[220:223]
    ds_write_b128 v20, a[216:219] offset:1024
    v_mfma_f32_16x16x32_bf16 v[216:219], a[72:75], a[32:35], v[216:219]
    s_waitcnt vmcnt(16)
    v_mfma_f32_16x16x32_bf16 v[220:223], a[132:135], a[36:39], v[220:223]
    ds_write_b128 v20, a[144:147] offset:2048
    buffer_load_dwordx4 a[200:203], v4, s[24:27], s44 offen offset:2048 sc1
    v_mfma_f32_16x16x32_bf16 v[216:219], a[76:79], a[36:39], v[216:219]
    s_waitcnt vmcnt(16)
    v_mfma_f32_16x16x32_bf16 v[220:223], a[184:187], a[40:43], v[220:223]
    ds_write_b128 v20, a[148:151] offset:3072
    v_mfma_f32_16x16x32_bf16 v[216:219], a[192:195], a[40:43], v[216:219]
    ds_write_b128 v20, a[128:131] offset:4096
    buffer_load_dwordx4 a[204:207], v4, s[24:27], s44 offen offset:3072 sc1
    s_nop 3
    v_cmp_u_f32 vcc, v220, v220
    s_cbranch_vccnz G5a3
G5a3_R:
    v_mfma_f32_16x16x32_bf16 v[40:43], a[168:171], a[24:27], v[40:43]
    v_mfma_f32_16x16x32_bf16 v[60:63], a[172:175], a[24:27], v[60:63]
    ds_write_b128 v20, a[120:123] offset:5120
    v_mfma_f32_16x16x32_bf16 v[40:43], a[48:51], a[28:31], v[40:43]
    v_mfma_f32_16x16x32_bf16 v[60:63], a[52:55], a[28:31], v[60:63]
    ds_write_b128 v20, a[20:23] offset:6144
    buffer_load_dwordx4 a[208:211], v5, s[24:27], s44 offen sc1
    v_mfma_f32_16x16x32_bf16 v[40:43], a[84:87], a[32:35], v[40:43]
    v_mfma_f32_16x16x32_bf16 v[60:63], a[88:91], a[32:35], v[60:63]
    s_waitcnt lgkmcnt(0)
    s_barrier
    s_add_u32 s45, s37, 25032704
    s_add_u32 m0, s31, 33792
    s_nop 0
    buffer_load_dwordx4 v4, s[24:27], s45 offen lds
    v_mfma_f32_16x16x32_bf16 v[40:43], a[108:111], a[36:39], v[40:43]
    ds_read_b128 v[88:91], v23 offset:0
    v_mfma_f32_16x16x32_bf16 v[60:63], a[112:115], a[36:39], v[60:63]
    ds_read_b128 v[92:95], v23 offset:1024
    v_mfma_f32_16x16x32_bf16 v[40:43], a[212:215], a[40:43], v[40:43]
    ds_read_b128 v[32:35], v23 offset:2048
    v_mfma_f32_16x16x32_bf16 v[60:63], a[124:127], a[40:43], v[60:63]
    ds_read_b128 v[36:39], v23 offset:3072
    s_add_u32 s45, s37, 25033728
    s_add_u32 m0, s31, 34816
    s_nop 0
    buffer_load_dwordx4 v4, s[24:27], s45 offen lds
    v_mfma_f32_16x16x32_bf16 v[64:67], a[188:191], a[24:27], v[64:67]
    ds_read_b128 v[48:51], v23 offset:4096
    v_mfma_f32_16x16x32_bf16 v[68:71], a[92:95], a[24:27], v[68:71]
    ds_read_b128 v[52:55], v23 offset:5120
    v_mfma_f32_16x16x32_bf16 v[72:75], a[252:255], a[24:27], v[72:75]
    ds_read_b128 v[56:59], v23 offset:6144
    v_mfma_f32_16x16x32_bf16 v[64:67], a[56:59], a[28:31], v[64:67]
    ds_read_b128 v[76:79], v13 offset:4096
    s_add_u32 s45, s37, 25034752
    s_add_u32 m0, s31, 35840
    s_nop 0
    buffer_load_dwordx4 v4, s[24:27], s45 offen lds
    v_mfma_f32_16x16x32_bf16 v[68:71], a[60:63], a[28:31], v[68:71]
    ds_read_b128 v[108:111], v13 offset:4112
    v_mfma_f32_16x16x32_bf16 v[72:75], a[64:67], a[28:31], v[72:75]
    ds_read_b128 v[112:115], v13 offset:4128
    v_mfma_f32_16x16x32_bf16 v[64:67], a[156:159], a[32:35], v[64:67]
    s_waitcnt lgkmcnt(2)
    v_fmac_f32 v88, v76, v46
    v_fmac_f32 v89, v77, v46
    v_mfma_f32_16x16x32_bf16 v[68:71], a[160:163], a[32:35], v[68:71]
    v_fmac_f32 v90, v78, v46
    v_fmac_f32 v91, v79, v46
    s_add_u32 s45, s36, 24989696
    buffer_load_dwordx4 a[136:139], v4, s[24:27], s45 offen
    v_mfma_f32_16x16x32_bf16 v[72:75], a[176:179], a[32:35], v[72:75]
    ds_read_b128 v[76:79], v13 offset:4144
    s_waitcnt lgkmcnt(2)
    v_fmac_f32 v92, v108, v46
    v_fmac_f32 v93, v109, v46
    v_mfma_f32_16x16x32_bf16 v[64:67], a[116:119], a[36:39], v[64:67]
    v_fmac_f32 v94, v110, v46
    v_fmac_f32 v95, v111, v46
    v_mfma_f32_16x16x32_bf16 v[68:71], a[4:7], a[36:39], v[68:71]
    ds_read_b128 v[108:111], v13 offset:4160
    v_add_f32 v220, v220, v88
    v_add_f32 v221, v221, v89
    buffer_load_dwordx4 a[232:235], v4, s[24:27], s45 offen offset:1024
    v_mfma_f32_16x16x32_bf16 v[72:75], a[180:183], a[36:39], v[72:75]
    v_add_f32 v222, v222, v90
    v_add_f32 v223, v223, v91
    v_mfma_f32_16x16x32_bf16 v[64:67], a[96:99], a[40:43], v[64:67]
    v_add_f32 v216, v216, v92
    v_add_f32 v217, v217, v93
    v_mfma_f32_16x16x32_bf16 v[68:71], a[44:47], a[40:43], v[68:71]
    v_add_f32 v218, v218, v94
    v_add_f32 v219, v219, v95
    v_mfma_f32_16x16x32_bf16 v[72:75], a[140:143], a[40:43], v[72:75]
    v_mul_f32 v88, v220, v220
    v_mul_f32 v89, v221, v221
    buffer_load_dwordx4 a[236:239], v4, s[24:27], s45 offen offset:2048
    s_waitcnt vmcnt(21)
    v_mfma_f32_16x16x32_bf16 a[164:167], a[244:247], a[220:223], 0
    v_mul_f32 v90, v222, v222
    v_mul_f32 v91, v223, v223
    v_mul_f32 v92, v216, v216
    v_mfma_f32_16x16x32_bf16 a[0:3], a[248:251], a[220:223], 0
    v_mul_f32 v93, v217, v217
    v_mul_f32 v94, v218, v218
    v_mul_f32 v95, v219, v219
    v_mfma_f32_16x16x32_bf16 a[8:11], a[168:171], a[220:223], 0
    v_fma_f32 v88, v88, v126, v124
    v_fma_f32 v89, v89, v126, v124
    v_fma_f32 v90, v90, v126, v124
    s_add_u32 s44, s30, 2752512
    s_add_u32 s44, s44, s13
    buffer_load_dwordx4 a[144:147], v4, s[24:27], s44 offen sc1
    v_mfma_f32_16x16x32_bf16 a[12:15], a[172:175], a[220:223], 0
    v_fma_f32 v91, v91, v126, v124
    v_fma_f32 v92, v92, v126, v124
    v_fma_f32 v93, v93, v126, v124
    v_mfma_f32_16x16x32_bf16 a[240:243], a[188:191], a[220:223], 0
    v_fma_f32 v94, v94, v126, v124
    v_fma_f32 v95, v95, v126, v124
    v_mul_f32 v88, v88, v220
    v_mfma_f32_16x16x32_bf16 a[152:155], a[92:95], a[220:223], 0
    v_mul_f32 v89, v89, v221
    v_mul_f32 v90, v90, v222
    v_mul_f32 v91, v91, v223
    buffer_load_dwordx4 a[148:151], v4, s[24:27], s44 offen offset:1024 sc1
    v_mfma_f32_16x16x32_bf16 a[216:219], a[252:255], a[220:223], 0
    v_mul_f32 v92, v92, v216
    v_mul_f32 v93, v93, v217
    v_mul_f32 v94, v94, v218
    s_waitcnt vmcnt(22)
    v_mfma_f32_16x16x32_bf16 a[164:167], a[80:83], a[224:227], a[164:167]
    v_mul_f32 v95, v95, v219
    v_exp_f32 v88, v88
    v_mfma_f32_16x16x32_bf16 a[0:3], a[16:19], a[224:227], a[0:3]
    v_exp_f32 v89, v89
    v_exp_f32 v90, v90
    buffer_load_dwordx4 a[128:131], v4, s[24:27], s44 offen offset:2048 sc1
    v_mfma_f32_16x16x32_bf16 a[8:11], a[48:51], a[224:227], a[8:11]
    v_exp_f32 v91, v91
    v_exp_f32 v92, v92
    v_mfma_f32_16x16x32_bf16 a[12:15], a[52:55], a[224:227], a[12:15]
    v_exp_f32 v93, v93
    v_exp_f32 v94, v94
    v_mfma_f32_16x16x32_bf16 a[240:243], a[56:59], a[224:227], a[240:243]
    v_exp_f32 v95, v95
    v_fma_f32 v88, v88, v44, v44
    buffer_load_dwordx4 a[120:123], v4, s[24:27], s44 offen offset:3072 sc1
    v_mfma_f32_16x16x32_bf16 a[152:155], a[60:63], a[224:227], a[152:155]
    v_fma_f32 v89, v89, v44, v44
    v_fma_f32 v90, v90, v44, v44
    v_fma_f32 v91, v91, v44, v44
    v_mfma_f32_16x16x32_bf16 a[216:219], a[64:67], a[224:227], a[216:219]
    v_fma_f32 v92, v92, v44, v44
    v_fma_f32 v93, v93, v44, v44
    v_fma_f32 v94, v94, v44, v44
    s_waitcnt vmcnt(23)
    v_mfma_f32_16x16x32_bf16 a[164:167], a[68:71], a[228:231], a[164:167]
    v_fma_f32 v95, v95, v44, v44
    v_rcp_f32 v88, v88
    buffer_load_dwordx4 a[20:23], v5, s[24:27], s44 offen sc1
    v_mfma_f32_16x16x32_bf16 a[0:3], a[72:75], a[228:231], a[0:3]
    v_rcp_f32 v89, v89
    v_rcp_f32 v90, v90
    v_mfma_f32_16x16x32_bf16 a[8:11], a[84:87], a[228:231], a[8:11]
    v_rcp_f32 v91, v91
    v_rcp_f32 v92, v92
    v_mfma_f32_16x16x32_bf16 a[12:15], a[88:91], a[228:231], a[12:15]
    v_rcp_f32 v93, v93
    v_rcp_f32 v94, v94
    buffer_load_dwordx4 a[24:27], v4, s[24:27], s45 offen offset:3072
    v_mfma_f32_16x16x32_bf16 a[240:243], a[156:159], a[228:231], a[240:243]
    v_rcp_f32 v95, v95
    v_mul_f32 v220, v220, v88
    v_mfma_f32_16x16x32_bf16 a[152:155], a[160:163], a[228:231], a[152:155]
    v_mul_f32 v221, v221, v89
    v_mul_f32 v222, v222, v90
    v_mul_f32 v223, v223, v91
    v_mfma_f32_16x16x32_bf16 a[216:219], a[176:179], a[228:231], a[216:219]
    v_mul_f32 v216, v216, v92
    v_mul_f32 v217, v217, v93
    v_mul_f32 v218, v218, v94
    buffer_load_dwordx4 a[28:31], v5, s[24:27], s45 offen
    s_waitcnt vmcnt(25)
    v_mfma_f32_16x16x32_bf16 a[164:167], a[132:135], v[224:227], a[164:167]
    v_mul_f32 v219, v219, v95
    v_cvt_pk_bf16_f32 v212, v220, v221
    v_cvt_pk_bf16_f32 v213, v222, v223
    v_mfma_f32_16x16x32_bf16 a[0:3], a[76:79], v[224:227], a[0:3]
    v_cvt_pk_bf16_f32 v214, v216, v217
    v_cvt_pk_bf16_f32 v215, v218, v219
    s_cmp_eq_u32 s47, 0
    s_cbranch_scc1 G5aS0_S
    s_add_u32 s28, s69, s71
    s_add_u32 s28, s28, 10747904
    buffer_store_dwordx4 v[212:215], v4, s[24:27], s28 offen
G5aS0_R:
    v_mfma_f32_16x16x32_bf16 a[8:11], a[108:111], v[224:227], a[8:11]
    s_waitcnt lgkmcnt(2)
    v_fmac_f32 v32, v112, v46
    v_fmac_f32 v33, v113, v46
    v_fmac_f32 v34, v114, v46
    v_mfma_f32_16x16x32_bf16 a[12:15], a[112:115], v[224:227], a[12:15]
    v_fmac_f32 v35, v115, v46
    s_waitcnt lgkmcnt(1)
    v_fmac_f32 v36, v76, v46
    v_fmac_f32 v37, v77, v46
    v_mfma_f32_16x16x32_bf16 a[240:243], a[116:119], v[224:227], a[240:243]
    ds_read_b128 v[112:115], v13 offset:4176
    v_fmac_f32 v38, v78, v46
    v_fmac_f32 v39, v79, v46
    v_add_f32 v40, v40, v32
    buffer_load_dwordx4 a[32:35], v5, s[24:27], s45 offen offset:1024
    v_mfma_f32_16x16x32_bf16 a[152:155], a[4:7], v[224:227], a[152:155]
    ds_read_b128 v[76:79], v13 offset:4192
    v_add_f32 v41, v41, v33
    v_add_f32 v42, v42, v34
    v_add_f32 v43, v43, v35
    v_mfma_f32_16x16x32_bf16 a[216:219], a[180:183], v[224:227], a[216:219]
    v_add_f32 v60, v60, v36
    v_add_f32 v61, v61, v37
    v_add_f32 v62, v62, v38
    s_waitcnt vmcnt(26)
    v_mfma_f32_16x16x32_bf16 a[164:167], a[184:187], a[100:103], a[164:167]
    v_add_f32 v63, v63, v39
    v_mul_f32 v32, v40, v40
    v_mul_f32 v33, v41, v41
    buffer_load_dwordx4 a[36:39], v5, s[24:27], s45 offen offset:2048
    v_mfma_f32_16x16x32_bf16 a[0:3], a[192:195], a[100:103], a[0:3]
    v_mul_f32 v34, v42, v42
    v_mul_f32 v35, v43, v43
    v_mul_f32 v36, v60, v60
    v_mfma_f32_16x16x32_bf16 a[8:11], a[212:215], a[100:103], a[8:11]
    v_mul_f32 v37, v61, v61
    v_mul_f32 v38, v62, v62
    v_mul_f32 v39, v63, v63
    v_mfma_f32_16x16x32_bf16 a[12:15], a[124:127], a[100:103], a[12:15]
    v_fma_f32 v32, v32, v126, v124
    v_fma_f32 v33, v33, v126, v124
    v_fma_f32 v34, v34, v126, v124
    buffer_load_dwordx4 a[40:43], v5, s[24:27], s45 offen offset:3072
    v_mfma_f32_16x16x32_bf16 a[240:243], a[96:99], a[100:103], a[240:243]
    v_fma_f32 v35, v35, v126, v124
    v_fma_f32 v36, v36, v126, v124
    v_fma_f32 v37, v37, v126, v124
    v_mfma_f32_16x16x32_bf16 a[152:155], a[44:47], a[100:103], a[152:155]
    v_fma_f32 v38, v38, v126, v124
    v_fma_f32 v39, v39, v126, v124
    v_mul_f32 v32, v32, v40
    v_mfma_f32_16x16x32_bf16 a[216:219], a[140:143], a[100:103], a[216:219]
    v_mul_f32 v33, v33, v41
    v_mul_f32 v34, v34, v42
    v_mul_f32 v35, v35, v43
    s_add_u32 s45, s36, 24997888
    buffer_load_dwordx4 v[204:207], v4, s[24:27], s45 offen
    v_accvgpr_read_b32 v8, a164
    v_cmp_u_f32 vcc, v8, v8
    s_cbranch_vccnz G5b0
G5b0_R:
    s_waitcnt vmcnt(22)
    v_mfma_f32_16x16x32_bf16 a[220:223], a[244:247], a[104:107], 0
    ds_write_b128 v20, a[164:167] offset:7168
    v_mul_f32 v36, v36, v60
    v_mul_f32 v37, v37, v61
    v_mul_f32 v38, v38, v62
    v_mfma_f32_16x16x32_bf16 a[224:227], a[248:251], a[104:107], 0
    v_mul_f32 v39, v39, v63
    v_exp_f32 v32, v32
    s_add_u32 s44, s30, 2752512
    s_add_u32 s44, s44, s10
    buffer_load_dwordx4 v[188:191], v4, s[24:27], s44 offen sc1
    v_mfma_f32_16x16x32_bf16 a[228:231], a[168:171], a[104:107], 0
    ds_write_b128 v20, a[0:3] offset:8192
    v_exp_f32 v33, v33
    v_exp_f32 v34, v34
    v_mfma_f32_16x16x32_bf16 a[100:103], a[172:175], a[104:107], 0
    v_exp_f32 v35, v35
    v_exp_f32 v36, v36
    buffer_load_dwordx4 v[184:187], v4, s[24:27], s44 offen offset:1024 sc1
    v_mfma_f32_16x16x32_bf16 v[200:203], a[188:191], a[104:107], 0
    ds_write_b128 v20, a[8:11] offset:9216
    v_exp_f32 v37, v37
    v_exp_f32 v38, v38
    v_mfma_f32_16x16x32_bf16 v[196:199], a[92:95], a[104:107], 0
    v_exp_f32 v39, v39
    v_fma_f32 v32, v32, v44, v44
    v_mfma_f32_16x16x32_bf16 v[192:195], a[252:255], a[104:107], 0
    ds_write_b128 v20, a[12:15] offset:10240
    v_fma_f32 v33, v33, v44, v44
    v_fma_f32 v34, v34, v44, v44
    v_fma_f32 v35, v35, v44, v44
    buffer_load_dwordx4 v[180:183], v4, s[24:27], s44 offen offset:2048 sc1
    s_waitcnt vmcnt(24)
    v_mfma_f32_16x16x32_bf16 a[220:223], a[80:83], a[196:199], a[220:223]
    v_fma_f32 v36, v36, v44, v44
    v_fma_f32 v37, v37, v44, v44
    v_fma_f32 v38, v38, v44, v44
    v_mfma_f32_16x16x32_bf16 a[224:227], a[16:19], a[196:199], a[224:227]
    ds_write_b128 v20, a[240:243] offset:11264
    v_fma_f32 v39, v39, v44, v44
    v_rcp_f32 v32, v32
    v_mfma_f32_16x16x32_bf16 a[228:231], a[48:51], a[196:199], a[228:231]
    v_rcp_f32 v33, v33
    v_rcp_f32 v34, v34
    buffer_load_dwordx4 v[176:179], v4, s[24:27], s44 offen offset:3072 sc1
    v_mfma_f32_16x16x32_bf16 a[100:103], a[52:55], a[196:199], a[100:103]
    ds_write_b128 v20, a[152:155] offset:12288
    v_rcp_f32 v35, v35
    v_rcp_f32 v36, v36
    v_mfma_f32_16x16x32_bf16 v[200:203], a[56:59], a[196:199], v[200:203]
    v_rcp_f32 v37, v37
    v_rcp_f32 v38, v38
    buffer_load_dwordx4 v[172:175], v5, s[24:27], s44 offen sc1
    v_mfma_f32_16x16x32_bf16 v[196:199], a[60:63], a[196:199], v[196:199]
    ds_write_b128 v20, a[216:219] offset:13312
    v_rcp_f32 v39, v39
    v_mul_f32 v40, v40, v32
    v_mfma_f32_16x16x32_bf16 v[192:195], a[64:67], a[196:199], v[192:195]
    v_mul_f32 v41, v41, v33
    v_mul_f32 v42, v42, v34
    v_mul_f32 v43, v43, v35
    s_waitcnt vmcnt(25)
    v_mfma_f32_16x16x32_bf16 a[220:223], a[68:71], a[200:203], a[220:223]
    s_waitcnt lgkmcnt(0)
    s_barrier
    v_mul_f32 v60, v60, v36
    v_mul_f32 v61, v61, v37
    v_mul_f32 v62, v62, v38
    buffer_load_dwordx4 v[168:171], v4, s[24:27], s45 offen offset:1024
    v_mfma_f32_16x16x32_bf16 a[224:227], a[72:75], a[200:203], a[224:227]
    ds_read_b128 a[164:167], v22 offset:7168
    v_mul_f32 v63, v63, v39
    v_cvt_pk_bf16_f32 v208, v40, v41
    v_cvt_pk_bf16_f32 v209, v42, v43
    v_mfma_f32_16x16x32_bf16 a[228:231], a[84:87], a[200:203], a[228:231]
    ds_read_b128 a[0:3], v22 offset:8192
    v_cvt_pk_bf16_f32 v210, v60, v61
    v_cvt_pk_bf16_f32 v211, v62, v63
    s_cmp_eq_u32 s47, 0
    s_cbranch_scc1 G5aS1_S
    s_add_u32 s28, s69, s71
    s_add_u32 s28, s28, 10748928
    buffer_store_dwordx4 v[208:211], v4, s[24:27], s28 offen
G5aS1_R:
    v_mfma_f32_16x16x32_bf16 a[100:103], a[88:91], a[200:203], a[100:103]
    ds_read_b128 a[8:11], v22 offset:9216
    v_fmac_f32 v48, v108, v46
    v_fmac_f32 v49, v109, v46
    v_fmac_f32 v50, v110, v46
    v_mfma_f32_16x16x32_bf16 v[200:203], a[156:159], a[200:203], v[200:203]
    ds_read_b128 a[12:15], v22 offset:10240
    v_fmac_f32 v51, v111, v46
    v_fmac_f32 v52, v112, v46
    v_fmac_f32 v53, v113, v46
    v_mfma_f32_16x16x32_bf16 v[196:199], a[160:163], a[200:203], v[196:199]
    ds_read_b128 a[240:243], v22 offset:11264
    v_fmac_f32 v54, v114, v46
    v_fmac_f32 v55, v115, v46
    v_add_f32 v64, v64, v48
    buffer_load_dwordx4 v[164:167], v4, s[24:27], s45 offen offset:2048
    v_mfma_f32_16x16x32_bf16 v[192:195], a[176:179], a[200:203], v[192:195]
    ds_read_b128 a[152:155], v22 offset:12288
    v_add_f32 v65, v65, v49
    v_add_f32 v66, v66, v50
    v_add_f32 v67, v67, v51
    s_waitcnt vmcnt(27)
    v_mfma_f32_16x16x32_bf16 a[220:223], a[132:135], a[204:207], a[220:223]
    ds_read_b128 a[216:219], v22 offset:13312
    v_add_f32 v68, v68, v52
    v_add_f32 v69, v69, v53
    v_add_f32 v70, v70, v54
    v_mfma_f32_16x16x32_bf16 a[224:227], a[76:79], a[204:207], a[224:227]
    v_add_f32 v71, v71, v55
    v_mul_f32 v48, v64, v64
    v_mul_f32 v49, v65, v65
    buffer_load_dwordx4 v[160:163], v4, s[24:27], s45 offen offset:3072
    v_mfma_f32_16x16x32_bf16 a[228:231], a[108:111], a[204:207], a[228:231]
    v_mul_f32 v50, v66, v66
    v_mul_f32 v51, v67, v67
    v_mul_f32 v52, v68, v68
    v_mfma_f32_16x16x32_bf16 a[100:103], a[112:115], a[204:207], a[100:103]
    v_mul_f32 v53, v69, v69
    v_mul_f32 v54, v70, v70
    v_mul_f32 v55, v71, v71
    v_mfma_f32_16x16x32_bf16 v[200:203], a[116:119], a[204:207], v[200:203]
    v_fma_f32 v48, v48, v126, v124
    v_fma_f32 v49, v49, v126, v124
    v_fma_f32 v50, v50, v126, v124
    buffer_load_dwordx4 v[156:159], v5, s[24:27], s45 offen
    v_mfma_f32_16x16x32_bf16 v[196:199], a[4:7], a[204:207], v[196:199]
    v_fma_f32 v51, v51, v126, v124
    v_fma_f32 v52, v52, v126, v124
    v_fma_f32 v53, v53, v126, v124
    v_mfma_f32_16x16x32_bf16 v[192:195], a[180:183], a[204:207], v[192:195]
    v_fma_f32 v54, v54, v126, v124
    v_fma_f32 v55, v55, v126, v124
    v_mul_f32 v48, v48, v64
    s_waitcnt vmcnt(28)
    v_mfma_f32_16x16x32_bf16 a[220:223], a[184:187], a[208:211], a[220:223]
    v_mul_f32 v49, v49, v65
    v_mul_f32 v50, v50, v66
    v_mul_f32 v51, v51, v67
    buffer_load_dwordx4 v[152:155], v5, s[24:27], s45 offen offset:1024
    v_mfma_f32_16x16x32_bf16 a[224:227], a[192:195], a[208:211], a[224:227]
    v_mul_f32 v52, v52, v68
    v_mul_f32 v53, v53, v69
    v_mul_f32 v54, v54, v70
    v_mfma_f32_16x16x32_bf16 a[228:231], a[212:215], a[208:211], a[228:231]
    v_mul_f32 v55, v55, v71
    v_exp_f32 v48, v48
    v_mfma_f32_16x16x32_bf16 a[100:103], a[124:127], a[208:211], a[100:103]
    v_exp_f32 v49, v49
    v_exp_f32 v50, v50
    buffer_load_dwordx4 v[148:151], v5, s[24:27], s45 offen offset:2048
    v_mfma_f32_16x16x32_bf16 v[200:203], a[96:99], a[208:211], v[200:203]
    v_exp_f32 v51, v51
    v_exp_f32 v52, v52
    v_mfma_f32_16x16x32_bf16 v[196:199], a[44:47], a[208:211], v[196:199]
    v_exp_f32 v53, v53
    v_exp_f32 v54, v54
    v_mfma_f32_16x16x32_bf16 v[192:195], a[140:143], a[208:211], v[192:195]
    v_exp_f32 v55, v55
    v_fma_f32 v48, v48, v44, v44
    s_add_u32 s45, s36, 25020416
    buffer_load_dwordx4 v[144:147], v4, s[24:27], s45 offen
    v_accvgpr_read_b32 v8, a220
    v_cmp_u_f32 vcc, v8, v8
    s_cbranch_vccnz G5b1
G5b1_R:
    s_waitcnt vmcnt(24) lgkmcnt(6)
    v_mfma_f32_16x16x32_bf16 a[104:107], a[244:247], a[144:147], a[164:167]
    ds_write_b128 v20, a[220:223] offset:0
    v_fma_f32 v49, v49, v44, v44
    v_fma_f32 v50, v50, v44, v44
    v_fma_f32 v51, v51, v44, v44
    s_waitcnt lgkmcnt(6)
    v_mfma_f32_16x16x32_bf16 a[196:199], a[248:251], a[144:147], a[0:3]
    v_fma_f32 v52, v52, v44, v44
    v_fma_f32 v53, v53, v44, v44
    v_fma_f32 v54, v54, v44, v44
    buffer_load_dwordx4 a[200:203], v4, s[24:27], s45 offen offset:1024
    s_waitcnt vmcnt(24)
    v_mfma_f32_16x16x32_bf16 a[104:107], a[80:83], a[148:151], a[104:107]
    ds_write_b128 v20, a[224:227] offset:1024
    v_fma_f32 v55, v55, v44, v44
    v_rcp_f32 v48, v48
    v_mfma_f32_16x16x32_bf16 a[196:199], a[16:19], a[148:151], a[196:199]
    v_rcp_f32 v49, v49
    v_rcp_f32 v50, v50
    s_waitcnt vmcnt(23)
    v_mfma_f32_16x16x32_bf16 a[104:107], a[68:71], a[128:131], a[104:107]
    ds_write_b128 v20, a[228:231] offset:2048
    v_rcp_f32 v51, v51
    v_rcp_f32 v52, v52
    buffer_load_dwordx4 a[204:207], v4, s[24:27], s45 offen offset:2048
    v_mfma_f32_16x16x32_bf16 a[196:199], a[72:75], a[128:131], a[196:199]
    v_rcp_f32 v53, v53
    v_rcp_f32 v54, v54
    s_waitcnt vmcnt(23)
    v_mfma_f32_16x16x32_bf16 a[104:107], a[132:135], a[120:123], a[104:107]
    ds_write_b128 v20, a[100:103] offset:3072
    v_rcp_f32 v55, v55
    v_mul_f32 v64, v64, v48
    v_mfma_f32_16x16x32_bf16 a[196:199], a[76:79], a[120:123], a[196:199]
    v_mul_f32 v65, v65, v49
    v_mul_f32 v66, v66, v50
    v_mul_f32 v67, v67, v51
    buffer_load_dwordx4 a[208:211], v4, s[24:27], s45 offen offset:3072
    s_waitcnt vmcnt(23)
    v_mfma_f32_16x16x32_bf16 a[104:107], a[184:187], a[20:23], a[104:107]
    ds_write_b128 v20, v[200:203] offset:4096
    v_mul_f32 v68, v68, v52
    v_mul_f32 v69, v69, v53
    v_mul_f32 v70, v70, v54
    v_mfma_f32_16x16x32_bf16 a[196:199], a[192:195], a[20:23], a[196:199]
    v_mul_f32 v71, v71, v55
    v_cvt_pk_bf16_f32 v212, v64, v65
    v_cvt_pk_bf16_f32 v213, v66, v67
    ds_write_b128 v20, v[196:199] offset:5120
    v_cvt_pk_bf16_f32 v214, v68, v69
    v_cvt_pk_bf16_f32 v215, v70, v71
    s_cmp_eq_u32 s47, 0
    s_cbranch_scc1 G5aS2_S
    s_add_u32 s28, s69, s71
    s_add_u32 s28, s28, 10749952
    buffer_store_dwordx4 v[212:215], v4, s[24:27], s28 offen
G5aS2_R:
    v_accvgpr_read_b32 v8, a104
    v_cmp_u_f32 vcc, v8, v8
    s_cbranch_vccnz G5b2
G5b2_R:
    s_waitcnt lgkmcnt(10)
    v_mfma_f32_16x16x32_bf16 a[8:11], a[168:171], a[144:147], a[8:11]
    v_fmac_f32 v56, v76, v46
    v_fmac_f32 v57, v77, v46
    v_fmac_f32 v58, v78, v46
    s_waitcnt lgkmcnt(9)
    v_mfma_f32_16x16x32_bf16 a[12:15], a[172:175], a[144:147], a[12:15]
    ds_write_b128 v20, v[192:195] offset:6144
    v_fmac_f32 v59, v79, v46
    v_add_f32 v72, v72, v56
    v_add_f32 v73, v73, v57
    buffer_load_dwordx4 a[164:167], v5, s[24:27], s45 offen
    v_mfma_f32_16x16x32_bf16 a[8:11], a[48:51], a[148:151], a[8:11]
    v_add_f32 v74, v74, v58
    v_add_f32 v75, v75, v59
    v_mul_f32 v56, v72, v72
    v_mfma_f32_16x16x32_bf16 a[12:15], a[52:55], a[148:151], a[12:15]
    s_waitcnt lgkmcnt(0)
    s_barrier
    v_mul_f32 v57, v73, v73
    v_mul_f32 v58, v74, v74
    v_mul_f32 v59, v75, v75
    buffer_load_dwordx4 a[0:3], v5, s[24:27], s45 offen offset:1024
    v_mfma_f32_16x16x32_bf16 a[8:11], a[84:87], a[128:131], a[8:11]
    ds_read_b128 v[104:107], v22 offset:0
    v_fma_f32 v56, v56, v126, v124
    v_fma_f32 v57, v57, v126, v124
    v_fma_f32 v58, v58, v126, v124
    v_mfma_f32_16x16x32_bf16 a[12:15], a[88:91], a[128:131], a[12:15]
    ds_read_b128 v[80:83], v22 offset:1024
    v_fma_f32 v59, v59, v126, v124
    v_mul_f32 v56, v56, v72
    v_mul_f32 v57, v57, v73
    v_mfma_f32_16x16x32_bf16 a[8:11], a[108:111], a[120:123], a[8:11]
    ds_read_b128 v[120:123], v22 offset:2048
    v_mul_f32 v58, v58, v74
    v_mul_f32 v59, v59, v75
    v_exp_f32 v56, v56
    buffer_load_dwordx4 a[220:223], v5, s[24:27], s45 offen offset:2048
    v_mfma_f32_16x16x32_bf16 a[12:15], a[112:115], a[120:123], a[12:15]
    ds_read_b128 v[116:119], v22 offset:3072
    v_exp_f32 v57, v57
    v_exp_f32 v58, v58
    v_mfma_f32_16x16x32_bf16 a[8:11], a[212:215], a[20:23], a[8:11]
    ds_read_b128 v[88:91], v22 offset:4096
    v_exp_f32 v59, v59
    v_fma_f32 v56, v56, v44, v44
    v_mfma_f32_16x16x32_bf16 a[12:15], a[124:127], a[20:23], a[12:15]
    ds_read_b128 v[92:95], v22 offset:5120
    v_fma_f32 v57, v57, v44, v44
    v_fma_f32 v58, v58, v44, v44
    v_fma_f32 v59, v59, v44, v44
    buffer_load_dwordx4 a[224:227], v5, s[24:27], s45 offen offset:3072
    v_mfma_f32_16x16x32_bf16 a[240:243], a[188:191], a[144:147], a[240:243]
    ds_read_b128 v[40:43], v22 offset:6144
    v_rcp_f32 v56, v56
    v_rcp_f32 v57, v57
    v_mfma_f32_16x16x32_bf16 a[152:155], a[92:95], a[144:147], a[152:155]
    v_rcp_f32 v58, v58
    v_rcp_f32 v59, v59
    v_mfma_f32_16x16x32_bf16 a[216:219], a[252:255], a[144:147], a[216:219]
    v_mul_f32 v72, v72, v56
    v_mul_f32 v73, v73, v57
    v_mul_f32 v74, v74, v58
    s_add_u32 s45, s36, 25028608
    buffer_load_dwordx4 a[228:231], v4, s[24:27], s45 offen
    v_mfma_f32_16x16x32_bf16 a[240:243], a[56:59], a[148:151], a[240:243]
    v_mul_f32 v75, v75, v59
    v_cvt_pk_bf16_f32 v208, v72, v73
    v_cvt_pk_bf16_f32 v209, v74, v75
    v_mfma_f32_16x16x32_bf16 a[152:155], a[60:63], a[148:151], a[152:155]
    s_cmp_eq_u32 s47, 0
    s_cbranch_scc1 G5aS3_S
    s_add_u32 s28, s69, 10797056
    buffer_store_dwordx2 v[208:209], v15, s[24:27], s28 offen
G5aS3_R:
    v_add_f32 v97, v84, v86
    v_add_f32 v99, v85, v87
    v_add_f32 v101, v97, v99
    v_cmp_u_f32 vcc, v101, v101
    s_cbranch_vccnz G5b_T
G5b_TR:
    v_mfma_f32_16x16x32_bf16 a[216:219], a[64:67], a[148:151], a[216:219]
    v_mov_b32 v101, v97
    s_nop 1
    v_permlane16_swap_b32 v97, v101
    v_add_f32 v97, v97, v101
    v_mfma_f32_16x16x32_bf16 a[240:243], a[156:159], a[128:131], a[240:243]
    v_mov_b32 v101, v97
    s_nop 1
    v_permlane32_swap_b32 v97, v101
    v_add_f32 v97, v97, v101
    buffer_load_dwordx4 a[100:103], v4, s[24:27], s45 offen offset:1024
    v_mfma_f32_16x16x32_bf16 a[152:155], a[160:163], a[128:131], a[152:155]
    v_mov_b32 v103, v99
    s_nop 1
    v_permlane16_swap_b32 v99, v103
    v_add_f32 v99, v99, v103
    v_mfma_f32_16x16x32_bf16 a[216:219], a[176:179], a[128:131], a[216:219]
    v_mov_b32 v103, v99
    s_nop 1
    v_permlane32_swap_b32 v99, v103
    v_add_f32 v99, v99, v103
    v_mfma_f32_16x16x32_bf16 a[240:243], a[116:119], a[120:123], a[240:243]
    v_mul_f32 v97, 0x3acccccd, v97
    v_mul_f32 v99, 0x3acccccd, v99
    v_fma_f32 v99, -v97, v97, v99
    buffer_load_dwordx4 v[140:143], v4, s[24:27], s45 offen offset:2048
    v_mfma_f32_16x16x32_bf16 a[152:155], a[4:7], a[120:123], a[152:155]
    v_max_f32 v99, 0, v99
    v_cvt_pk_bf16_f32 v97, v97, v97
    v_lshlrev_b32 v97, 16, v97
    v_mfma_f32_16x16x32_bf16 a[216:219], a[180:183], a[120:123], a[216:219]
    v_cvt_pk_bf16_f32 v99, v99, v99
    v_lshlrev_b32 v99, 16, v99
    v_add_f32 v99, 0x3727c5ac, v99
    v_mfma_f32_16x16x32_bf16 a[240:243], a[96:99], a[20:23], a[240:243]
    v_cvt_pk_bf16_f32 v99, v99, v99
    v_lshlrev_b32 v99, 16, v99
    v_sqrt_f32 v99, v99
    buffer_load_dwordx4 v[136:139], v4, s[24:27], s45 offen offset:3072
    v_mfma_f32_16x16x32_bf16 a[152:155], a[44:47], a[20:23], a[152:155]
    v_cvt_pk_bf16_f32 v99, v99, v99
    v_lshlrev_b32 v99, 16, v99
    v_rcp_f32 v99, v99
    v_mfma_f32_16x16x32_bf16 a[216:219], a[140:143], a[20:23], a[216:219]
    v_mul_f32 v96, 0xc0135761, v99
    v_mul_f32 v98, v99, v99
    v_mul_f32 v98, v98, v99
    s_waitcnt vmcnt(25) lgkmcnt(6)
    v_mfma_f32_16x16x32_bf16 v[72:75], a[244:247], v[188:191], v[104:107]
    ds_write_b128 v20, a[104:107] offset:7168
    v_mul_f32 v98, 0xbdd2d3e8, v98
    v_rcp_f32 v100, v99
    buffer_load_dwordx4 a[144:147], v5, s[24:27], s45 offen
    s_waitcnt lgkmcnt(6)
    v_mfma_f32_16x16x32_bf16 v[56:59], a[248:251], v[188:191], v[80:83]
    v_sub_f32 v102, 0, v97
    s_waitcnt vmcnt(25)
    v_mfma_f32_16x16x32_bf16 v[72:75], a[80:83], v[184:187], v[72:75]
    ds_write_b128 v20, a[196:199] offset:8192
    v_mfma_f32_16x16x32_bf16 v[56:59], a[16:19], v[184:187], v[56:59]
    s_waitcnt vmcnt(24)
    v_mfma_f32_16x16x32_bf16 v[72:75], a[68:71], v[180:183], v[72:75]
    ds_write_b128 v20, a[8:11] offset:9216
    buffer_load_dwordx4 a[148:151], v5, s[24:27], s45 offen offset:1024
    v_mfma_f32_16x16x32_bf16 v[56:59], a[72:75], v[180:183], v[56:59]
    s_waitcnt vmcnt(24)
    v_mfma_f32_16x16x32_bf16 v[72:75], a[132:135], v[176:179], v[72:75]
    ds_write_b128 v20, a[12:15] offset:10240
    v_mfma_f32_16x16x32_bf16 v[56:59], a[76:79], v[176:179], v[56:59]
    s_waitcnt vmcnt(23)
    v_mfma_f32_16x16x32_bf16 v[72:75], a[184:187], v[172:175], v[72:75]
    ds_write_b128 v20, a[240:243] offset:11264
    buffer_load_dwordx4 a[128:131], v5, s[24:27], s45 offen offset:2048
    v_mfma_f32_16x16x32_bf16 v[56:59], a[192:195], v[172:175], v[56:59]
    ds_write_b128 v20, a[152:155] offset:12288
    s_nop 3
    v_cmp_u_f32 vcc, v72, v72
    s_cbranch_vccnz G5b3
G5b3_R:
    s_waitcnt lgkmcnt(10)
    v_mfma_f32_16x16x32_bf16 v[120:123], a[168:171], v[188:191], v[120:123]
    s_add_u32 s45, s37, 24989696
    buffer_load_dwordx4 a[120:123], v4, s[24:27], s45 offen
    s_waitcnt lgkmcnt(9)
    v_mfma_f32_16x16x32_bf16 v[116:119], a[172:175], v[188:191], v[116:119]
    ds_write_b128 v20, a[216:219] offset:13312
    v_mfma_f32_16x16x32_bf16 v[120:123], a[48:51], v[184:187], v[120:123]
    v_mfma_f32_16x16x32_bf16 v[116:119], a[52:55], v[184:187], v[116:119]
    s_waitcnt lgkmcnt(0)
    s_barrier
    buffer_load_dwordx4 a[20:23], v4, s[24:27], s45 offen offset:1024
    v_mfma_f32_16x16x32_bf16 v[120:123], a[84:87], v[180:183], v[120:123]
    ds_read_b128 v[60:63], v23 offset:7168
    v_mfma_f32_16x16x32_bf16 v[116:119], a[88:91], v[180:183], v[116:119]
    ds_read_b128 v[32:35], v23 offset:8192
    v_mfma_f32_16x16x32_bf16 v[120:123], a[108:111], v[176:179], v[120:123]
    ds_read_b128 v[36:39], v23 offset:9216
    v_mfma_f32_16x16x32_bf16 v[116:119], a[112:115], v[176:179], v[116:119]
    ds_read_b128 v[64:67], v23 offset:10240
    buffer_load_dwordx4 a[244:247], v4, s[24:27], s45 offen offset:2048
    v_mfma_f32_16x16x32_bf16 v[120:123], a[212:215], v[172:175], v[120:123]
    ds_read_b128 v[68:71], v23 offset:11264
    v_mfma_f32_16x16x32_bf16 v[116:119], a[124:127], v[172:175], v[116:119]
    ds_read_b128 v[48:51], v23 offset:12288
    v_mfma_f32_16x16x32_bf16 v[88:91], a[188:191], v[188:191], v[88:91]
    ds_read_b128 v[52:55], v23 offset:13312
    v_mfma_f32_16x16x32_bf16 v[92:95], a[92:95], v[188:191], v[92:95]
    ds_read_b128 v[76:79], v13 offset:4096
    buffer_load_dwordx4 a[248:251], v4, s[24:27], s45 offen offset:3072
    v_mfma_f32_16x16x32_bf16 v[40:43], a[252:255], v[188:191], v[40:43]
    ds_read_b128 v[108:111], v13 offset:4112
    v_mfma_f32_16x16x32_bf16 v[88:91], a[56:59], v[184:187], v[88:91]
    ds_read_b128 v[112:115], v13 offset:4128
    v_mfma_f32_16x16x32_bf16 v[92:95], a[60:63], v[184:187], v[92:95]
    s_waitcnt lgkmcnt(2)
    v_fmac_f32 v60, v76, v102
    v_fmac_f32 v61, v77, v102
    v_fmac_f32 v62, v78, v102
    v_mfma_f32_16x16x32_bf16 v[40:43], a[64:67], v[184:187], v[40:43]
    v_fmac_f32 v63, v79, v102
    s_waitcnt lgkmcnt(1)
    v_fmac_f32 v32, v108, v102
    v_fmac_f32 v33, v109, v102
    buffer_load_dwordx4 a[80:83], v5, s[24:27], s45 offen
    v_mfma_f32_16x16x32_bf16 v[88:91], a[156:159], v[180:183], v[88:91]
    ds_read_b128 v[76:79], v13 offset:4144
    v_fmac_f32 v34, v110, v102
    v_fmac_f32 v35, v111, v102
    v_add_f32 v72, v72, v60
    v_mfma_f32_16x16x32_bf16 v[92:95], a[160:163], v[180:183], v[92:95]
    ds_read_b128 v[108:111], v13 offset:4160
    v_add_f32 v73, v73, v61
    v_add_f32 v74, v74, v62
    v_add_f32 v75, v75, v63
    v_mfma_f32_16x16x32_bf16 v[40:43], a[176:179], v[180:183], v[40:43]
    v_add_f32 v56, v56, v32
    v_add_f32 v57, v57, v33
    v_add_f32 v58, v58, v34
    buffer_load_dwordx4 a[16:19], v5, s[24:27], s45 offen offset:1024
    v_mfma_f32_16x16x32_bf16 v[88:91], a[116:119], v[176:179], v[88:91]
    v_add_f32 v59, v59, v35
    v_mul_f32 v60, v72, v72
    v_mul_f32 v61, v73, v73
    v_mfma_f32_16x16x32_bf16 v[92:95], a[4:7], v[176:179], v[92:95]
    v_mul_f32 v62, v74, v74
    v_mul_f32 v63, v75, v75
    v_mul_f32 v32, v56, v56
    v_mfma_f32_16x16x32_bf16 v[40:43], a[180:183], v[176:179], v[40:43]
    v_mul_f32 v33, v57, v57
    v_mul_f32 v34, v58, v58
    v_mul_f32 v35, v59, v59
    buffer_load_dwordx4 a[68:71], v5, s[24:27], s45 offen offset:2048
    v_mfma_f32_16x16x32_bf16 v[88:91], a[96:99], v[172:175], v[88:91]
    v_fma_f32 v60, v60, v98, v96
    v_fma_f32 v61, v61, v98, v96
    v_fma_f32 v62, v62, v98, v96
    v_mfma_f32_16x16x32_bf16 v[92:95], a[44:47], v[172:175], v[92:95]
    v_fma_f32 v63, v63, v98, v96
    v_fma_f32 v32, v32, v98, v96
    v_fma_f32 v33, v33, v98, v96
    v_mfma_f32_16x16x32_bf16 v[40:43], a[140:143], v[172:175], v[40:43]
    v_fma_f32 v34, v34, v98, v96
    v_fma_f32 v35, v35, v98, v96
    v_mul_f32 v60, v60, v72
    buffer_load_dwordx4 a[72:75], v5, s[24:27], s45 offen offset:3072
    v_mul_f32 v61, v61, v73
    v_mul_f32 v62, v62, v74
    v_mul_f32 v63, v63, v75
    v_mul_f32 v32, v32, v56
    v_mul_f32 v33, v33, v57
    v_mul_f32 v34, v34, v58
    v_mul_f32 v35, v35, v59
    v_exp_f32 v60, v60
    v_exp_f32 v61, v61
    v_exp_f32 v62, v62
    v_exp_f32 v63, v63
    v_exp_f32 v32, v32
    s_add_u32 s44, s41, 10747904
    s_add_u32 s44, s44, s15
    buffer_load_dwordx4 a[132:135], v4, s[24:27], s44 offen sc1
    v_exp_f32 v33, v33
    v_exp_f32 v34, v34
    v_exp_f32 v35, v35
    v_fma_f32 v60, v60, v100, v100
    v_fma_f32 v61, v61, v100, v100
    v_fma_f32 v62, v62, v100, v100
    v_fma_f32 v63, v63, v100, v100
    v_fma_f32 v32, v32, v100, v100
    v_fma_f32 v33, v33, v100, v100
    v_fma_f32 v34, v34, v100, v100
    v_fma_f32 v35, v35, v100, v100
    v_rcp_f32 v60, v60
    buffer_load_dwordx4 a[76:79], v4, s[24:27], s44 offen offset:1024 sc1
    v_rcp_f32 v61, v61
    v_rcp_f32 v62, v62
    v_rcp_f32 v63, v63
    v_rcp_f32 v32, v32
    v_rcp_f32 v33, v33
    v_rcp_f32 v34, v34
    v_rcp_f32 v35, v35
    v_mul_f32 v72, v72, v60
    v_mul_f32 v73, v73, v61
    buffer_load_dwordx4 a[184:187], v4, s[24:27], s44 offen offset:2048 sc1
    v_mul_f32 v74, v74, v62
    v_mul_f32 v75, v75, v63
    v_mul_f32 v56, v56, v32
    v_mul_f32 v57, v57, v33
    v_mul_f32 v58, v58, v34
    v_mul_f32 v59, v59, v35
    v_cvt_pk_bf16_f32 v124, v72, v73
    v_cvt_pk_bf16_f32 v125, v74, v75
    v_cvt_pk_bf16_f32 v126, v56, v57
    v_cvt_pk_bf16_f32 v127, v58, v59
    s_cmp_eq_u32 s47, 0
    s_cbranch_scc1 G5bS0_S
    s_add_u32 s28, s70, s71
    s_add_u32 s28, s28, 10747904
    buffer_store_dwordx4 v[124:127], v4, s[24:27], s28 offen
G5bS0_R:
    s_waitcnt lgkmcnt(2)
    v_pk_fma_f32 v[36:37], v[112:113], v[102:103], v[36:37] op_sel_hi:[1,0,1]
    v_pk_fma_f32 v[38:39], v[114:115], v[102:103], v[38:39] op_sel_hi:[1,0,1]
    s_waitcnt lgkmcnt(1)
    v_pk_fma_f32 v[64:65], v[76:77], v[102:103], v[64:65] op_sel_hi:[1,0,1]
    v_pk_fma_f32 v[66:67], v[78:79], v[102:103], v[66:67] op_sel_hi:[1,0,1]
    v_pk_add_f32 v[120:121], v[120:121], v[36:37]
    ds_read_b128 v[112:115], v13 offset:4176
    ds_read_b128 v[76:79], v13 offset:4192
    v_pk_add_f32 v[122:123], v[122:123], v[38:39]
    v_pk_add_f32 v[116:117], v[116:117], v[64:65]
    v_pk_add_f32 v[118:119], v[118:119], v[66:67]
    v_pk_mul_f32 v[36:37], v[120:121], v[120:121]
    buffer_load_dwordx4 a[192:195], v5, s[24:27], s44 offen offset:2048 sc1
    ds_read_b128 v[84:87], v20 offset:21504
    ds_read_b128 v[104:107], v20 offset:22528
    v_pk_mul_f32 v[38:39], v[122:123], v[122:123]
    v_pk_mul_f32 v[64:65], v[116:117], v[116:117]
    v_pk_mul_f32 v[66:67], v[118:119], v[118:119]
    v_pk_fma_f32 v[36:37], v[36:37], v[98:99], v[96:97] op_sel_hi:[1,0,0]
    ds_read_b128 v[80:83], v20 offset:23552
    ds_read_b128 v[132:135], v20 offset:24576
    v_pk_fma_f32 v[38:39], v[38:39], v[98:99], v[96:97] op_sel_hi:[1,0,0]
    v_pk_fma_f32 v[64:65], v[64:65], v[98:99], v[96:97] op_sel_hi:[1,0,0]
    v_pk_fma_f32 v[66:67], v[66:67], v[98:99], v[96:97] op_sel_hi:[1,0,0]
    v_pk_mul_f32 v[36:37], v[36:37], v[120:121]
    buffer_load_dwordx4 a[168:171], v5, s[24:27], s44 offen offset:3072 sc1
    ds_read_b128 v[128:131], v20 offset:25600
    v_pk_mul_f32 v[38:39], v[38:39], v[122:123]
    v_pk_mul_f32 v[64:65], v[64:65], v[116:117]
    v_pk_mul_f32 v[66:67], v[66:67], v[118:119]
    v_exp_f32 v36, v36
    v_exp_f32 v37, v37
    v_exp_f32 v38, v38
    v_exp_f32 v39, v39
    v_exp_f32 v64, v64
    s_add_u32 s44, s41, 10756096
    s_add_u32 s44, s44, s15
    buffer_load_dwordx4 a[172:175], v4, s[24:27], s44 offen sc1
    v_exp_f32 v65, v65
    v_exp_f32 v66, v66
    v_exp_f32 v67, v67
    v_pk_fma_f32 v[36:37], v[36:37], v[100:101], v[100:101] op_sel_hi:[1,0,0]
    v_pk_fma_f32 v[38:39], v[38:39], v[100:101], v[100:101] op_sel_hi:[1,0,0]
    v_pk_fma_f32 v[64:65], v[64:65], v[100:101], v[100:101] op_sel_hi:[1,0,0]
    v_pk_fma_f32 v[66:67], v[66:67], v[100:101], v[100:101] op_sel_hi:[1,0,0]
    v_rcp_f32 v36, v36
    s_add_u32 s44, s41, 10747904
    s_add_u32 s44, s44, s54
    buffer_load_dwordx4 a[48:51], v4, s[24:27], s44 offen sc1
    v_rcp_f32 v37, v37
    v_rcp_f32 v38, v38
    v_rcp_f32 v39, v39
    v_rcp_f32 v64, v64
    v_rcp_f32 v65, v65
    v_rcp_f32 v66, v66
    v_rcp_f32 v67, v67
    v_pk_mul_f32 v[120:121], v[120:121], v[36:37]
    v_pk_mul_f32 v[122:123], v[122:123], v[38:39]
    buffer_load_dwordx4 a[104:107], v4, s[24:27], s44 offen offset:1024 sc1
    v_pk_mul_f32 v[116:117], v[116:117], v[64:65]
    v_pk_mul_f32 v[118:119], v[118:119], v[66:67]
    v_cvt_pk_bf16_f32 v44, v120, v121
    v_cvt_pk_bf16_f32 v45, v122, v123
    v_cvt_pk_bf16_f32 v46, v116, v117
    v_cvt_pk_bf16_f32 v47, v118, v119
    s_cmp_eq_u32 s47, 0
    s_cbranch_scc1 G5bS1_S
    s_add_u32 s28, s70, s71
    s_add_u32 s28, s28, 10748928
    buffer_store_dwordx4 v[44:47], v4, s[24:27], s28 offen
G5bS1_R:
    s_waitcnt lgkmcnt(7)
    v_pk_fma_f32 v[68:69], v[108:109], v[102:103], v[68:69] op_sel_hi:[1,0,1]
    v_pk_fma_f32 v[70:71], v[110:111], v[102:103], v[70:71] op_sel_hi:[1,0,1]
    s_waitcnt lgkmcnt(6)
    v_pk_fma_f32 v[48:49], v[112:113], v[102:103], v[48:49] op_sel_hi:[1,0,1]
    v_pk_fma_f32 v[50:51], v[114:115], v[102:103], v[50:51] op_sel_hi:[1,0,1]
    v_pk_add_f32 v[88:89], v[88:89], v[68:69]
    v_pk_add_f32 v[90:91], v[90:91], v[70:71]
    v_pk_add_f32 v[92:93], v[92:93], v[48:49]
    v_pk_add_f32 v[94:95], v[94:95], v[50:51]
    v_pk_mul_f32 v[68:69], v[88:89], v[88:89]
    buffer_load_dwordx4 a[196:199], v4, s[24:27], s44 offen offset:2048 sc1
    v_pk_mul_f32 v[70:71], v[90:91], v[90:91]
    v_pk_mul_f32 v[48:49], v[92:93], v[92:93]
    v_pk_mul_f32 v[50:51], v[94:95], v[94:95]
    v_pk_fma_f32 v[68:69], v[68:69], v[98:99], v[96:97] op_sel_hi:[1,0,0]
    v_pk_fma_f32 v[70:71], v[70:71], v[98:99], v[96:97] op_sel_hi:[1,0,0]
    v_pk_fma_f32 v[48:49], v[48:49], v[98:99], v[96:97] op_sel_hi:[1,0,0]
    v_pk_fma_f32 v[50:51], v[50:51], v[98:99], v[96:97] op_sel_hi:[1,0,0]
    v_pk_mul_f32 v[68:69], v[68:69], v[88:89]
    buffer_load_dwordx4 a[8:11], v5, s[24:27], s44 offen offset:2048 sc1
    v_pk_mul_f32 v[70:71], v[70:71], v[90:91]
    v_pk_mul_f32 v[48:49], v[48:49], v[92:93]
    v_pk_mul_f32 v[50:51], v[50:51], v[94:95]
    v_exp_f32 v68, v68
    v_exp_f32 v69, v69
    v_exp_f32 v70, v70
    v_exp_f32 v71, v71
    v_exp_f32 v48, v48
    buffer_load_dwordx4 a[12:15], v5, s[24:27], s44 offen offset:3072 sc1
    v_exp_f32 v49, v49
    v_exp_f32 v50, v50
    v_exp_f32 v51, v51
    v_pk_fma_f32 v[68:69], v[68:69], v[100:101], v[100:101] op_sel_hi:[1,0,0]
    v_pk_fma_f32 v[70:71], v[70:71], v[100:101], v[100:101] op_sel_hi:[1,0,0]
    v_pk_fma_f32 v[48:49], v[48:49], v[100:101], v[100:101] op_sel_hi:[1,0,0]
    v_pk_fma_f32 v[50:51], v[50:51], v[100:101], v[100:101] op_sel_hi:[1,0,0]
    v_rcp_f32 v68, v68
    s_add_u32 s44, s41, 10756096
    s_add_u32 s44, s44, s54
    buffer_load_dwordx4 a[240:243], v4, s[24:27], s44 offen sc1
    v_rcp_f32 v69, v69
    v_rcp_f32 v70, v70
    v_rcp_f32 v71, v71
    v_rcp_f32 v48, v48
    v_rcp_f32 v49, v49
    v_rcp_f32 v50, v50
    v_rcp_f32 v51, v51
    v_pk_mul_f32 v[88:89], v[88:89], v[68:69]
    v_pk_mul_f32 v[90:91], v[90:91], v[70:71]
    s_add_u32 s45, s37, 24997888
    buffer_load_dwordx4 a[152:155], v4, s[24:27], s45 offen
    v_pk_mul_f32 v[92:93], v[92:93], v[48:49]
    v_pk_mul_f32 v[94:95], v[94:95], v[50:51]
    v_cvt_pk_bf16_f32 v124, v88, v89
    v_cvt_pk_bf16_f32 v125, v90, v91
    v_cvt_pk_bf16_f32 v126, v92, v93
    v_cvt_pk_bf16_f32 v127, v94, v95
    s_cmp_eq_u32 s47, 0
    s_cbranch_scc1 G5bS2_S
    s_add_u32 s28, s70, s71
    s_add_u32 s28, s28, 10749952
    buffer_store_dwordx4 v[124:127], v4, s[24:27], s28 offen
G5bS2_R:
    s_waitcnt lgkmcnt(5)
    v_pk_fma_f32 v[52:53], v[76:77], v[102:103], v[52:53] op_sel_hi:[1,0,1]
    v_pk_fma_f32 v[54:55], v[78:79], v[102:103], v[54:55] op_sel_hi:[1,0,1]
    v_pk_add_f32 v[40:41], v[40:41], v[52:53]
    v_pk_add_f32 v[42:43], v[42:43], v[54:55]
    v_pk_mul_f32 v[52:53], v[40:41], v[40:41]
    v_pk_mul_f32 v[54:55], v[42:43], v[42:43]
    v_pk_fma_f32 v[52:53], v[52:53], v[98:99], v[96:97] op_sel_hi:[1,0,0]
    v_pk_fma_f32 v[54:55], v[54:55], v[98:99], v[96:97] op_sel_hi:[1,0,0]
    v_pk_mul_f32 v[52:53], v[52:53], v[40:41]
    buffer_load_dwordx4 a[216:219], v4, s[24:27], s45 offen offset:1024
    v_pk_mul_f32 v[54:55], v[54:55], v[42:43]
    v_exp_f32 v52, v52
    v_exp_f32 v53, v53
    v_exp_f32 v54, v54
    v_exp_f32 v55, v55
    v_pk_fma_f32 v[52:53], v[52:53], v[100:101], v[100:101] op_sel_hi:[1,0,0]
    v_pk_fma_f32 v[54:55], v[54:55], v[100:101], v[100:101] op_sel_hi:[1,0,0]
    v_rcp_f32 v52, v52
    buffer_load_dwordx4 a[52:55], v4, s[24:27], s45 offen offset:2048
    v_rcp_f32 v53, v53
    v_rcp_f32 v54, v54
    v_rcp_f32 v55, v55
    v_pk_mul_f32 v[40:41], v[40:41], v[52:53]
    v_pk_mul_f32 v[42:43], v[42:43], v[54:55]
    v_cvt_pk_bf16_f32 v44, v40, v41
    v_cvt_pk_bf16_f32 v45, v42, v43
    s_cmp_eq_u32 s47, 0
    s_cbranch_scc1 G5bS3_S
    s_add_u32 s28, s70, 10797056
    buffer_store_dwordx2 v[44:45], v15, s[24:27], s28 offen
G5bS3_R:
    s_waitcnt vmcnt(18)
    v_mfma_f32_16x16x32_bf16 a[84:87], a[136:139], a[132:135], 0
    v_mfma_f32_16x16x32_bf16 a[88:91], a[232:235], a[132:135], 0
    v_mfma_f32_16x16x32_bf16 a[108:111], a[236:239], a[132:135], 0
    v_mfma_f32_16x16x32_bf16 a[112:115], a[24:27], a[132:135], 0
    s_add_u32 s44, s41, 10747904
    s_add_u32 s44, s44, s55
    buffer_load_dwordx4 a[124:127], v4, s[24:27], s44 offen sc1
    v_mfma_f32_16x16x32_bf16 a[212:215], a[28:31], a[132:135], 0
    s_waitcnt vmcnt(18)
    v_mfma_f32_16x16x32_bf16 a[84:87], a[32:35], a[76:79], a[84:87]
    v_mfma_f32_16x16x32_bf16 a[88:91], a[36:39], a[76:79], a[88:91]
    v_mfma_f32_16x16x32_bf16 a[108:111], a[40:43], a[76:79], a[108:111]
    buffer_load_dwordx4 a[188:191], v4, s[24:27], s44 offen offset:1024 sc1
    v_mfma_f32_16x16x32_bf16 a[112:115], v[204:207], a[76:79], a[112:115]
    v_mfma_f32_16x16x32_bf16 a[212:215], v[168:171], a[76:79], a[212:215]
    s_waitcnt vmcnt(18)
    v_mfma_f32_16x16x32_bf16 a[84:87], v[164:167], a[184:187], a[84:87]
    v_mfma_f32_16x16x32_bf16 a[88:91], v[160:163], a[184:187], a[88:91]
    buffer_load_dwordx4 a[92:95], v4, s[24:27], s44 offen offset:2048 sc1
    v_mfma_f32_16x16x32_bf16 a[108:111], v[156:159], a[184:187], a[108:111]
    v_mfma_f32_16x16x32_bf16 a[112:115], v[152:155], a[184:187], a[112:115]
    v_mfma_f32_16x16x32_bf16 a[212:215], v[148:151], a[184:187], a[212:215]
    s_waitcnt vmcnt(17)
    v_mfma_f32_16x16x32_bf16 a[84:87], v[144:147], a[192:195], a[84:87]
    buffer_load_dwordx4 a[252:255], v5, s[24:27], s44 offen offset:2048 sc1
    v_mfma_f32_16x16x32_bf16 a[88:91], a[200:203], a[192:195], a[88:91]
    v_mfma_f32_16x16x32_bf16 a[108:111], a[204:207], a[192:195], a[108:111]
    v_mfma_f32_16x16x32_bf16 a[112:115], a[208:211], a[192:195], a[112:115]
    v_mfma_f32_16x16x32_bf16 a[212:215], a[164:167], a[192:195], a[212:215]
    buffer_load_dwordx4 a[56:59], v5, s[24:27], s44 offen offset:3072 sc1
    s_waitcnt vmcnt(18)
    v_mfma_f32_16x16x32_bf16 a[84:87], a[0:3], a[168:171], a[84:87]
    v_mfma_f32_16x16x32_bf16 a[88:91], a[220:223], a[168:171], a[88:91]
    v_mfma_f32_16x16x32_bf16 a[108:111], a[224:227], a[168:171], a[108:111]
    v_mfma_f32_16x16x32_bf16 a[112:115], a[228:231], a[168:171], a[112:115]
    s_add_u32 s44, s41, 10756096
    s_add_u32 s44, s44, s55
    buffer_load_dwordx4 a[60:63], v4, s[24:27], s44 offen sc1
    v_mfma_f32_16x16x32_bf16 a[212:215], a[100:103], a[168:171], a[212:215]
    s_waitcnt vmcnt(18)
    v_mfma_f32_16x16x32_bf16 a[84:87], v[140:143], a[172:175], a[84:87]
    v_mfma_f32_16x16x32_bf16 a[88:91], v[136:139], a[172:175], a[88:91]
    v_mfma_f32_16x16x32_bf16 a[108:111], a[144:147], a[172:175], a[108:111]
    buffer_load_dwordx4 a[64:67], v4, s[24:27], s45 offen offset:3072
    v_mfma_f32_16x16x32_bf16 a[112:115], a[148:151], a[172:175], a[112:115]
    v_mfma_f32_16x16x32_bf16 a[212:215], a[128:131], a[172:175], a[212:215]
    s_nop 2
    v_accvgpr_read_b32 v8, a84
    v_cmp_u_f32 vcc, v8, v8
    s_cbranch_vccnz G6e0
G6e0_R:
    s_waitcnt vmcnt(18)
    v_mfma_f32_16x16x32_bf16 a[156:159], a[136:139], a[48:51], 0
    v_mfma_f32_16x16x32_bf16 a[160:163], a[232:235], a[48:51], 0
    s_add_u32 s44, s41, 10747904
    s_add_u32 s44, s44, s14
    buffer_load_dwordx4 a[180:183], v4, s[24:27], s44 offen sc1
    v_mfma_f32_16x16x32_bf16 a[176:179], a[236:239], a[48:51], 0
    v_mfma_f32_16x16x32_bf16 a[116:119], a[24:27], a[48:51], 0
    v_mfma_f32_16x16x32_bf16 a[4:7], a[28:31], a[48:51], 0
    s_waitcnt vmcnt(18)
    v_mfma_f32_16x16x32_bf16 a[156:159], a[32:35], a[104:107], a[156:159]
    buffer_load_dwordx4 a[96:99], v4, s[24:27], s44 offen offset:1024 sc1
    v_mfma_f32_16x16x32_bf16 a[160:163], a[36:39], a[104:107], a[160:163]
    v_mfma_f32_16x16x32_bf16 a[176:179], a[40:43], a[104:107], a[176:179]
    v_mfma_f32_16x16x32_bf16 a[116:119], v[204:207], a[104:107], a[116:119]
    v_mfma_f32_16x16x32_bf16 a[4:7], v[168:171], a[104:107], a[4:7]
    buffer_load_dwordx4 a[44:47], v4, s[24:27], s44 offen offset:2048 sc1
    s_waitcnt vmcnt(18)
    v_mfma_f32_16x16x32_bf16 a[156:159], v[164:167], a[196:199], a[156:159]
    v_mfma_f32_16x16x32_bf16 a[160:163], v[160:163], a[196:199], a[160:163]
    v_mfma_f32_16x16x32_bf16 a[176:179], v[156:159], a[196:199], a[176:179]
    v_mfma_f32_16x16x32_bf16 a[116:119], v[152:155], a[196:199], a[116:119]
    v_mfma_f32_16x16x32_bf16 a[4:7], v[148:151], a[196:199], a[4:7]
    buffer_load_dwordx4 a[140:143], v5, s[24:27], s44 offen offset:2048 sc1
    s_waitcnt vmcnt(18)
    v_mfma_f32_16x16x32_bf16 a[156:159], v[144:147], a[8:11], a[156:159]
    v_mfma_f32_16x16x32_bf16 a[160:163], a[200:203], a[8:11], a[160:163]
    v_mfma_f32_16x16x32_bf16 a[176:179], a[204:207], a[8:11], a[176:179]
    v_mfma_f32_16x16x32_bf16 a[116:119], a[208:211], a[8:11], a[116:119]
    buffer_load_dwordx4 a[132:135], v5, s[24:27], s44 offen offset:3072 sc1
    v_mfma_f32_16x16x32_bf16 a[4:7], a[164:167], a[8:11], a[4:7]
    s_waitcnt vmcnt(18)
    v_mfma_f32_16x16x32_bf16 a[156:159], a[0:3], a[12:15], a[156:159]
    v_mfma_f32_16x16x32_bf16 a[160:163], a[220:223], a[12:15], a[160:163]
    v_mfma_f32_16x16x32_bf16 a[176:179], a[224:227], a[12:15], a[176:179]
    s_add_u32 s44, s41, 10756096
    s_add_u32 s44, s44, s14
    buffer_load_dwordx4 a[76:79], v4, s[24:27], s44 offen sc1
    v_mfma_f32_16x16x32_bf16 a[116:119], a[228:231], a[12:15], a[116:119]
    v_mfma_f32_16x16x32_bf16 a[4:7], a[100:103], a[12:15], a[4:7]
    s_waitcnt vmcnt(18)
    v_mfma_f32_16x16x32_bf16 a[156:159], v[140:143], a[240:243], a[156:159]
    v_mfma_f32_16x16x32_bf16 a[160:163], v[136:139], a[240:243], a[160:163]
    buffer_load_dwordx4 a[184:187], v5, s[24:27], s45 offen
    v_mfma_f32_16x16x32_bf16 a[176:179], a[144:147], a[240:243], a[176:179]
    v_mfma_f32_16x16x32_bf16 a[116:119], a[148:151], a[240:243], a[116:119]
    v_mfma_f32_16x16x32_bf16 a[4:7], a[128:131], a[240:243], a[4:7]
    s_nop 2
    v_accvgpr_read_b32 v8, a156
    v_cmp_u_f32 vcc, v8, v8
    s_cbranch_vccnz G6e1
G6e1_R:
    s_waitcnt vmcnt(13)
    v_mfma_f32_16x16x32_bf16 a[192:195], a[136:139], a[124:127], 0
    s_add_u32 s44, s42, 10747904
    s_add_u32 s44, s44, s15
    buffer_load_dwordx4 a[196:199], v4, s[24:27], s44 offen sc1
    v_mfma_f32_16x16x32_bf16 a[168:171], a[232:235], a[124:127], 0
    v_mfma_f32_16x16x32_bf16 a[172:175], a[236:239], a[124:127], 0
    v_mfma_f32_16x16x32_bf16 a[48:51], a[24:27], a[124:127], 0
    v_mfma_f32_16x16x32_bf16 a[104:107], a[28:31], a[124:127], 0
    buffer_load_dwordx4 a[8:11], v4, s[24:27], s44 offen offset:1024 sc1
    s_waitcnt vmcnt(14)
    v_mfma_f32_16x16x32_bf16 a[192:195], a[32:35], a[188:191], a[192:195]
    v_mfma_f32_16x16x32_bf16 a[168:171], a[36:39], a[188:191], a[168:171]
    v_mfma_f32_16x16x32_bf16 a[172:175], a[40:43], a[188:191], a[172:175]
    v_mfma_f32_16x16x32_bf16 a[48:51], v[204:207], a[188:191], a[48:51]
    buffer_load_dwordx4 a[12:15], v4, s[24:27], s44 offen offset:2048 sc1
    v_mfma_f32_16x16x32_bf16 a[104:107], v[168:171], a[188:191], a[104:107]
    s_waitcnt vmcnt(14)
    v_mfma_f32_16x16x32_bf16 a[192:195], v[164:167], a[92:95], a[192:195]
    v_mfma_f32_16x16x32_bf16 a[168:171], v[160:163], a[92:95], a[168:171]
    v_mfma_f32_16x16x32_bf16 a[172:175], v[156:159], a[92:95], a[172:175]
    buffer_load_dwordx4 a[240:243], v5, s[24:27], s45 offen offset:1024
    v_mfma_f32_16x16x32_bf16 a[48:51], v[152:155], a[92:95], a[48:51]
    v_mfma_f32_16x16x32_bf16 a[104:107], v[148:151], a[92:95], a[104:107]
    s_waitcnt vmcnt(14)
    v_mfma_f32_16x16x32_bf16 a[192:195], v[144:147], a[252:255], a[192:195]
    v_mfma_f32_16x16x32_bf16 a[168:171], a[200:203], a[252:255], a[168:171]
    buffer_load_dwordx4 v[252:255], v5, s[24:27], s45 offen offset:2048
    v_mfma_f32_16x16x32_bf16 a[172:175], a[204:207], a[252:255], a[172:175]
    v_mfma_f32_16x16x32_bf16 a[48:51], a[208:211], a[252:255], a[48:51]
    v_mfma_f32_16x16x32_bf16 a[104:107], a[164:167], a[252:255], a[104:107]
    s_waitcnt vmcnt(14)
    v_mfma_f32_16x16x32_bf16 a[192:195], a[0:3], a[56:59], a[192:195]
    buffer_load_dwordx4 v[248:251], v5, s[24:27], s44 offen offset:2048 sc1
    v_mfma_f32_16x16x32_bf16 a[168:171], a[220:223], a[56:59], a[168:171]
    v_mfma_f32_16x16x32_bf16 a[172:175], a[224:227], a[56:59], a[172:175]
    v_mfma_f32_16x16x32_bf16 a[48:51], a[228:231], a[56:59], a[48:51]
    v_mfma_f32_16x16x32_bf16 a[104:107], a[100:103], a[56:59], a[104:107]
    s_waitcnt vmcnt(14)
    v_mfma_f32_16x16x32_bf16 a[192:195], v[140:143], a[60:63], a[192:195]
    s_add_u32 s45, s37, 25020416
    buffer_load_dwordx4 v[244:247], v4, s[24:27], s45 offen
    v_mfma_f32_16x16x32_bf16 a[168:171], v[136:139], a[60:63], a[168:171]
    v_mfma_f32_16x16x32_bf16 a[172:175], a[144:147], a[60:63], a[172:175]
    v_mfma_f32_16x16x32_bf16 a[48:51], a[148:151], a[60:63], a[48:51]
    v_mfma_f32_16x16x32_bf16 a[104:107], a[128:131], a[60:63], a[104:107]
    buffer_load_dwordx4 v[240:243], v4, s[24:27], s45 offen offset:1024
    s_nop 0
    v_accvgpr_read_b32 v8, a192
    v_cmp_u_f32 vcc, v8, v8
    s_cbranch_vccnz G6e2
G6e2_R:
    s_waitcnt vmcnt(14) lgkmcnt(4)
    v_mfma_f32_16x16x32_bf16 v[72:75], a[136:139], a[180:183], v[84:87]
    s_waitcnt lgkmcnt(3)
    v_mfma_f32_16x16x32_bf16 v[56:59], a[232:235], a[180:183], v[104:107]
    s_waitcnt lgkmcnt(2)
    v_mfma_f32_16x16x32_bf16 v[60:63], a[236:239], a[180:183], v[80:83]
    s_waitcnt lgkmcnt(1)
    v_mfma_f32_16x16x32_bf16 v[32:35], a[24:27], a[180:183], v[132:135]
    buffer_load_dwordx4 a[124:127], v4, s[24:27], s45 offen offset:2048
    s_waitcnt lgkmcnt(0)
    v_mfma_f32_16x16x32_bf16 v[120:123], a[28:31], a[180:183], v[128:131]
    s_waitcnt vmcnt(14)
    v_mfma_f32_16x16x32_bf16 v[72:75], a[32:35], a[96:99], v[72:75]
    v_mfma_f32_16x16x32_bf16 v[56:59], a[36:39], a[96:99], v[56:59]
    v_mfma_f32_16x16x32_bf16 v[60:63], a[40:43], a[96:99], v[60:63]
    buffer_load_dwordx4 a[188:191], v4, s[24:27], s45 offen offset:3072
    v_mfma_f32_16x16x32_bf16 v[32:35], v[204:207], a[96:99], v[32:35]
    v_mfma_f32_16x16x32_bf16 v[120:123], v[168:171], a[96:99], v[120:123]
    s_waitcnt vmcnt(14)
    v_mfma_f32_16x16x32_bf16 v[72:75], v[164:167], a[44:47], v[72:75]
    v_mfma_f32_16x16x32_bf16 v[56:59], v[160:163], a[44:47], v[56:59]
    buffer_load_dwordx4 a[92:95], v5, s[24:27], s45 offen
    v_mfma_f32_16x16x32_bf16 v[60:63], v[156:159], a[44:47], v[60:63]
    v_mfma_f32_16x16x32_bf16 v[32:35], v[152:155], a[44:47], v[32:35]
    v_mfma_f32_16x16x32_bf16 v[120:123], v[148:151], a[44:47], v[120:123]
    s_waitcnt vmcnt(14)
    v_mfma_f32_16x16x32_bf16 v[72:75], v[144:147], a[140:143], v[72:75]
    buffer_load_dwordx4 a[252:255], v5, s[24:27], s44 offen offset:3072 sc1
    v_mfma_f32_16x16x32_bf16 v[56:59], a[200:203], a[140:143], v[56:59]
    v_mfma_f32_16x16x32_bf16 v[60:63], a[204:207], a[140:143], v[60:63]
    v_mfma_f32_16x16x32_bf16 v[32:35], a[208:211], a[140:143], v[32:35]
    v_mfma_f32_16x16x32_bf16 v[120:123], a[164:167], a[140:143], v[120:123]
    s_add_u32 s44, s42, 10756096
    s_add_u32 s44, s44, s15
    buffer_load_dwordx4 a[56:59], v4, s[24:27], s44 offen sc1
    s_waitcnt vmcnt(15)
    v_mfma_f32_16x16x32_bf16 v[72:75], a[0:3], a[132:135], v[72:75]
    v_mfma_f32_16x16x32_bf16 v[56:59], a[220:223], a[132:135], v[56:59]
    v_mfma_f32_16x16x32_bf16 v[60:63], a[224:227], a[132:135], v[60:63]
    v_mfma_f32_16x16x32_bf16 v[32:35], a[228:231], a[132:135], v[32:35]
    s_add_u32 s44, s48, 10747904
    s_add_u32 s44, s44, s15
    buffer_load_dwordx4 a[60:63], v4, s[24:27], s44 offen sc1
    v_mfma_f32_16x16x32_bf16 v[120:123], a[100:103], a[132:135], v[120:123]
    s_waitcnt vmcnt(15)
    v_mfma_f32_16x16x32_bf16 v[72:75], v[140:143], a[76:79], v[72:75]
    v_mfma_f32_16x16x32_bf16 v[56:59], v[136:139], a[76:79], v[56:59]
    v_mfma_f32_16x16x32_bf16 v[60:63], a[144:147], a[76:79], v[60:63]
    s_add_u32 s45, s38, 24989696
    buffer_load_dwordx4 v[236:239], v4, s[24:27], s45 offen
    v_mfma_f32_16x16x32_bf16 v[32:35], a[148:151], a[76:79], v[32:35]
    v_mfma_f32_16x16x32_bf16 v[120:123], a[128:131], a[76:79], v[120:123]
    s_nop 1
    v_cmp_u_f32 vcc, v72, v72
    s_cbranch_vccnz G6e3
G6e3_R:
    ds_read_b128 a[180:183], v20 offset:26624
    ds_read_b128 a[96:99], v20 offset:27648
    ds_read_b128 a[44:47], v20 offset:28672
    ds_read_b128 a[140:143], v20 offset:29696
    ds_read_b128 a[132:135], v20 offset:30720
    ds_read_b128 a[76:79], v20 offset:31744
    ds_read_b128 a[136:139], v20 offset:32768
    ds_read_b128 a[232:235], v20 offset:33792
    ds_read_b128 a[236:239], v20 offset:34816
    ds_read_b128 a[24:27], v20 offset:35840
    s_waitcnt vmcnt(14)
    v_mfma_f32_16x16x32_bf16 a[28:31], a[120:123], a[196:199], a[84:87]
    buffer_load_dwordx4 a[204:207], v4, s[24:27], s45 offen offset:1024
    v_mfma_f32_16x16x32_bf16 a[32:35], a[20:23], a[196:199], a[88:91]
    v_mfma_f32_16x16x32_bf16 a[36:39], a[244:247], a[196:199], a[108:111]
    v_mfma_f32_16x16x32_bf16 a[40:43], a[248:251], a[196:199], a[112:115]
    v_mfma_f32_16x16x32_bf16 a[200:203], a[80:83], a[196:199], a[212:215]
    buffer_load_dwordx4 a[208:211], v4, s[24:27], s45 offen offset:2048
    s_waitcnt vmcnt(15)
    v_mfma_f32_16x16x32_bf16 a[28:31], a[16:19], a[8:11], a[28:31]
    v_mfma_f32_16x16x32_bf16 a[32:35], a[68:71], a[8:11], a[32:35]
    v_mfma_f32_16x16x32_bf16 a[36:39], a[72:75], a[8:11], a[36:39]
    v_mfma_f32_16x16x32_bf16 a[40:43], a[152:155], a[8:11], a[40:43]
    buffer_load_dwordx4 a[164:167], v4, s[24:27], s45 offen offset:3072
    v_mfma_f32_16x16x32_bf16 a[200:203], a[216:219], a[8:11], a[200:203]
    s_waitcnt vmcnt(15)
    v_mfma_f32_16x16x32_bf16 a[28:31], a[52:55], a[12:15], a[28:31]
    v_mfma_f32_16x16x32_bf16 a[32:35], a[64:67], a[12:15], a[32:35]
    v_mfma_f32_16x16x32_bf16 a[36:39], a[184:187], a[12:15], a[36:39]
    buffer_load_dwordx4 a[0:3], v5, s[24:27], s45 offen
    s_waitcnt vmcnt(15)
    v_mfma_f32_16x16x32_bf16 a[40:43], a[240:243], a[12:15], a[40:43]
    s_waitcnt vmcnt(14)
    v_mfma_f32_16x16x32_bf16 a[200:203], v[252:255], a[12:15], a[200:203]
    s_waitcnt vmcnt(12)
    v_mfma_f32_16x16x32_bf16 a[28:31], v[244:247], v[248:251], a[28:31]
    s_waitcnt vmcnt(11)
    v_mfma_f32_16x16x32_bf16 a[32:35], v[240:243], v[248:251], a[32:35]
    s_add_u32 s44, s40, 10747904
    s_add_u32 s44, s44, s15
    buffer_load_dwordx4 a[220:223], v30, s[24:27], s44 offen sc1
    s_waitcnt vmcnt(11)
    v_mfma_f32_16x16x32_bf16 a[36:39], a[124:127], v[248:251], a[36:39]
    s_waitcnt vmcnt(10)
    v_mfma_f32_16x16x32_bf16 a[40:43], a[188:191], v[248:251], a[40:43]
    s_waitcnt vmcnt(9)
    v_mfma_f32_16x16x32_bf16 a[200:203], a[92:95], v[248:251], a[200:203]
    s_waitcnt vmcnt(8) lgkmcnt(9)
    v_mfma_f32_16x16x32_bf16 a[28:31], a[180:183], a[252:255], a[28:31]
    s_add_u32 s45, s39, 24989696
    buffer_load_dwordx4 a[224:227], v30, s[24:27], s45 offen
    s_waitcnt lgkmcnt(8)
    v_mfma_f32_16x16x32_bf16 a[32:35], a[96:99], a[252:255], a[32:35]
    s_waitcnt lgkmcnt(7)
    v_mfma_f32_16x16x32_bf16 a[36:39], a[44:47], a[252:255], a[36:39]
    s_waitcnt lgkmcnt(6)
    v_mfma_f32_16x16x32_bf16 a[40:43], a[140:143], a[252:255], a[40:43]
    s_waitcnt lgkmcnt(5)
    v_mfma_f32_16x16x32_bf16 a[200:203], a[132:135], a[252:255], a[200:203]
    buffer_load_dwordx4 a[228:231], v30, s[24:27], s45 offen offset:1024
    s_waitcnt vmcnt(9) lgkmcnt(4)
    v_mfma_f32_16x16x32_bf16 a[28:31], a[76:79], a[56:59], a[28:31]
    s_waitcnt lgkmcnt(3)
    v_mfma_f32_16x16x32_bf16 a[32:35], a[136:139], a[56:59], a[32:35]
    s_waitcnt lgkmcnt(2)
    v_mfma_f32_16x16x32_bf16 a[36:39], a[232:235], a[56:59], a[36:39]
    s_waitcnt lgkmcnt(1)
    v_mfma_f32_16x16x32_bf16 a[40:43], a[236:239], a[56:59], a[40:43]
    buffer_load_dwordx4 a[100:103], v30, s[24:27], s45 offen offset:2048
    s_waitcnt lgkmcnt(0)
    v_mfma_f32_16x16x32_bf16 a[200:203], a[24:27], a[56:59], a[200:203]
    s_waitcnt vmcnt(8)
    v_mfma_f32_16x16x32_bf16 a[28:31], v[236:239], a[60:63], a[28:31]
    buffer_load_dwordx4 a[144:147], v30, s[24:27], s45 offen offset:3072
    s_add_u32 s45, s39, 24993792
    buffer_load_dwordx4 a[148:151], v30, s[24:27], s45 offen
    s_add_u32 s44, s42, 10747904
    s_add_u32 s44, s44, s54
    buffer_load_dwordx4 a[128:131], v4, s[24:27], s44 offen sc1
    s_waitcnt vmcnt(10)
    v_mfma_f32_16x16x32_bf16 a[32:35], a[204:207], a[60:63], a[32:35]
    s_waitcnt vmcnt(9)
    v_mfma_f32_16x16x32_bf16 a[36:39], a[208:211], a[60:63], a[36:39]
    buffer_load_dwordx4 v[232:235], v4, s[24:27], s44 offen offset:1024 sc1
    s_waitcnt vmcnt(9)
    v_mfma_f32_16x16x32_bf16 a[40:43], a[164:167], a[60:63], a[40:43]
    buffer_load_dwordx4 v[228:231], v4, s[24:27], s44 offen offset:2048 sc1
    s_waitcnt vmcnt(9)
    v_mfma_f32_16x16x32_bf16 a[200:203], a[0:3], a[60:63], a[200:203]
    buffer_load_dwordx4 v[220:223], v5, s[24:27], s44 offen offset:2048 sc1
    buffer_load_dwordx4 v[216:219], v5, s[24:27], s44 offen offset:3072 sc1
    s_waitcnt vmcnt(9)
    v_mfma_f32_16x16x32_bf16 a[28:31], a[224:227], a[220:223], a[28:31]
    s_add_u32 s44, s42, 10756096
    s_add_u32 s44, s44, s54
    buffer_load_dwordx4 v[224:227], v4, s[24:27], s44 offen sc1
    s_waitcnt vmcnt(9)
    v_mfma_f32_16x16x32_bf16 a[32:35], a[228:231], a[220:223], a[32:35]
    s_add_u32 s44, s48, 10747904
    s_add_u32 s44, s44, s54
    buffer_load_dwordx4 v[200:203], v4, s[24:27], s44 offen sc1
    s_waitcnt vmcnt(9)
    v_mfma_f32_16x16x32_bf16 a[36:39], a[100:103], a[220:223], a[36:39]
    s_add_u32 s44, s40, 10747904
    s_add_u32 s44, s44, s54
    buffer_load_dwordx4 v[196:199], v30, s[24:27], s44 offen sc1
    s_waitcnt vmcnt(9)
    v_mfma_f32_16x16x32_bf16 a[40:43], a[144:147], a[220:223], a[40:43]
    s_add_u32 s44, s42, 10747904
    s_add_u32 s44, s44, s55
    buffer_load_dwordx4 v[192:195], v4, s[24:27], s44 offen sc1
    s_waitcnt vmcnt(9)
    v_mfma_f32_16x16x32_bf16 a[200:203], a[148:151], a[220:223], a[200:203]
    buffer_load_dwordx4 v[212:215], v4, s[24:27], s44 offen offset:1024 sc1
    v_accvgpr_read_b32 v8, a28
    v_cmp_u_f32 vcc, v8, v8
    s_cbranch_vccnz G6l0
G6l0_R:
    s_waitcnt vmcnt(9)
    v_mfma_f32_16x16x32_bf16 a[196:199], a[120:123], a[128:131], a[156:159]
    ds_write_b128 v20, a[28:31] offset:0
    buffer_load_dwordx4 a[60:63], v4, s[24:27], s44 offen offset:2048 sc1
    v_mfma_f32_16x16x32_bf16 a[8:11], a[20:23], a[128:131], a[160:163]
    v_mfma_f32_16x16x32_bf16 a[12:15], a[244:247], a[128:131], a[176:179]
    v_mfma_f32_16x16x32_bf16 a[252:255], a[248:251], a[128:131], a[116:119]
    ds_write_b128 v20, a[32:35] offset:1024
    v_mfma_f32_16x16x32_bf16 a[56:59], a[80:83], a[128:131], a[4:7]
    s_waitcnt vmcnt(9)
    v_mfma_f32_16x16x32_bf16 a[196:199], a[16:19], v[232:235], a[196:199]
    buffer_load_dwordx4 a[220:223], v5, s[24:27], s44 offen offset:2048 sc1
    v_mfma_f32_16x16x32_bf16 a[8:11], a[68:71], v[232:235], a[8:11]
    ds_write_b128 v20, a[36:39] offset:2048
    v_mfma_f32_16x16x32_bf16 a[12:15], a[72:75], v[232:235], a[12:15]
    v_mfma_f32_16x16x32_bf16 a[252:255], a[152:155], v[232:235], a[252:255]
    v_mfma_f32_16x16x32_bf16 a[56:59], a[216:219], v[232:235], a[56:59]
    ds_write_b128 v20, a[40:43] offset:3072
    buffer_load_dwordx4 a[84:87], v5, s[24:27], s44 offen offset:3072 sc1
    s_waitcnt vmcnt(10)
    v_mfma_f32_16x16x32_bf16 a[196:199], a[52:55], v[228:231], a[196:199]
    v_mfma_f32_16x16x32_bf16 a[8:11], a[64:67], v[228:231], a[8:11]
    v_mfma_f32_16x16x32_bf16 a[12:15], a[184:187], v[228:231], a[12:15]
    ds_write_b128 v20, a[200:203] offset:4096
    v_mfma_f32_16x16x32_bf16 a[252:255], a[240:243], v[228:231], a[252:255]
    s_add_u32 s44, s42, 10756096
    s_add_u32 s44, s44, s55
    buffer_load_dwordx4 a[88:91], v4, s[24:27], s44 offen sc1
    v_mfma_f32_16x16x32_bf16 a[56:59], v[252:255], v[228:231], a[56:59]
    s_waitcnt vmcnt(10)
    v_mfma_f32_16x16x32_bf16 a[196:199], v[244:247], v[220:223], a[196:199]
    v_mfma_f32_16x16x32_bf16 a[8:11], v[240:243], v[220:223], a[8:11]
    v_mfma_f32_16x16x32_bf16 a[12:15], a[124:127], v[220:223], a[12:15]
    s_add_u32 s44, s48, 10747904
    s_add_u32 s44, s44, s55
    buffer_load_dwordx4 a[108:111], v4, s[24:27], s44 offen sc1
    v_mfma_f32_16x16x32_bf16 a[252:255], a[188:191], v[220:223], a[252:255]
    v_mfma_f32_16x16x32_bf16 a[56:59], a[92:95], v[220:223], a[56:59]
    s_waitcnt vmcnt(10)
    v_mfma_f32_16x16x32_bf16 a[196:199], a[180:183], v[216:219], a[196:199]
    v_mfma_f32_16x16x32_bf16 a[8:11], a[96:99], v[216:219], a[8:11]
    s_add_u32 s44, s40, 10747904
    s_add_u32 s44, s44, s55
    buffer_load_dwordx4 a[112:115], v30, s[24:27], s44 offen sc1
    v_mfma_f32_16x16x32_bf16 a[12:15], a[44:47], v[216:219], a[12:15]
    v_mfma_f32_16x16x32_bf16 a[252:255], a[140:143], v[216:219], a[252:255]
    v_mfma_f32_16x16x32_bf16 a[56:59], a[132:135], v[216:219], a[56:59]
    s_waitcnt vmcnt(10)
    v_mfma_f32_16x16x32_bf16 a[196:199], a[76:79], v[224:227], a[196:199]
    s_add_u32 s44, s42, 10747904
    s_add_u32 s44, s44, s14
    buffer_load_dwordx4 a[212:215], v4, s[24:27], s44 offen sc1
    v_mfma_f32_16x16x32_bf16 a[8:11], a[136:139], v[224:227], a[8:11]
    v_mfma_f32_16x16x32_bf16 a[12:15], a[232:235], v[224:227], a[12:15]
    v_mfma_f32_16x16x32_bf16 a[252:255], a[236:239], v[224:227], a[252:255]
    v_mfma_f32_16x16x32_bf16 a[56:59], a[24:27], v[224:227], a[56:59]
    buffer_load_dwordx4 a[28:31], v4, s[24:27], s44 offen offset:1024 sc1
    s_waitcnt vmcnt(11)
    v_mfma_f32_16x16x32_bf16 a[196:199], v[236:239], v[200:203], a[196:199]
    v_mfma_f32_16x16x32_bf16 a[8:11], a[204:207], v[200:203], a[8:11]
    v_mfma_f32_16x16x32_bf16 a[12:15], a[208:211], v[200:203], a[12:15]
    v_mfma_f32_16x16x32_bf16 a[252:255], a[164:167], v[200:203], a[252:255]
    buffer_load_dwordx4 a[32:35], v4, s[24:27], s44 offen offset:2048 sc1
    v_mfma_f32_16x16x32_bf16 a[56:59], a[0:3], v[200:203], a[56:59]
    s_waitcnt vmcnt(11)
    v_mfma_f32_16x16x32_bf16 a[196:199], a[224:227], v[196:199], a[196:199]
    v_mfma_f32_16x16x32_bf16 a[8:11], a[228:231], v[196:199], a[8:11]
    v_mfma_f32_16x16x32_bf16 a[12:15], a[100:103], v[196:199], a[12:15]
    buffer_load_dwordx4 a[36:39], v5, s[24:27], s44 offen offset:2048 sc1
    v_mfma_f32_16x16x32_bf16 a[252:255], a[144:147], v[196:199], a[252:255]
    v_mfma_f32_16x16x32_bf16 a[56:59], a[148:151], v[196:199], a[56:59]
    s_nop 2
    v_accvgpr_read_b32 v8, a196
    v_cmp_u_f32 vcc, v8, v8
    s_cbranch_vccnz G6l1
G6l1_R:
    s_waitcnt vmcnt(11)
    v_mfma_f32_16x16x32_bf16 a[40:43], a[120:123], v[192:195], a[192:195]
    ds_write_b128 v20, a[196:199] offset:14336
    v_mfma_f32_16x16x32_bf16 a[200:203], a[20:23], v[192:195], a[168:171]
    buffer_load_dwordx4 a[176:179], v5, s[24:27], s44 offen offset:3072 sc1
    v_mfma_f32_16x16x32_bf16 a[128:131], a[244:247], v[192:195], a[172:175]
    v_mfma_f32_16x16x32_bf16 a[156:159], a[248:251], v[192:195], a[48:51]
    ds_write_b128 v20, a[8:11] offset:15360
    v_mfma_f32_16x16x32_bf16 a[160:163], a[80:83], v[192:195], a[104:107]
    s_waitcnt vmcnt(11)
    v_mfma_f32_16x16x32_bf16 a[40:43], a[16:19], v[212:215], a[40:43]
    s_add_u32 s44, s42, 10756096
    s_add_u32 s44, s44, s14
    buffer_load_dwordx4 a[116:119], v4, s[24:27], s44 offen sc1
    v_mfma_f32_16x16x32_bf16 a[200:203], a[68:71], v[212:215], a[200:203]
    ds_write_b128 v20, a[12:15] offset:16384
    v_mfma_f32_16x16x32_bf16 a[128:131], a[72:75], v[212:215], a[128:131]
    v_mfma_f32_16x16x32_bf16 a[156:159], a[152:155], v[212:215], a[156:159]
    v_mfma_f32_16x16x32_bf16 a[160:163], a[216:219], v[212:215], a[160:163]
    ds_write_b128 v20, a[252:255] offset:17408
    s_add_u32 s44, s48, 10747904
    s_add_u32 s44, s44, s14
    buffer_load_dwordx4 a[4:7], v4, s[24:27], s44 offen sc1
    s_waitcnt vmcnt(12)
    v_mfma_f32_16x16x32_bf16 a[40:43], a[52:55], a[60:63], a[40:43]
    v_mfma_f32_16x16x32_bf16 a[200:203], a[64:67], a[60:63], a[200:203]
    v_mfma_f32_16x16x32_bf16 a[128:131], a[184:187], a[60:63], a[128:131]
    ds_write_b128 v20, a[56:59] offset:18432
    v_mfma_f32_16x16x32_bf16 a[156:159], a[240:243], a[60:63], a[156:159]
    s_add_u32 s44, s40, 10747904
    s_add_u32 s44, s44, s14
    buffer_load_dwordx4 v[208:211], v30, s[24:27], s44 offen sc1
    v_mfma_f32_16x16x32_bf16 a[160:163], v[252:255], a[60:63], a[160:163]
    s_waitcnt vmcnt(12)
    v_mfma_f32_16x16x32_bf16 a[40:43], v[244:247], a[220:223], a[40:43]
    s_waitcnt lgkmcnt(0)
    s_barrier
    v_mfma_f32_16x16x32_bf16 a[200:203], v[240:243], a[220:223], a[200:203]
    ds_read_b128 v[116:119], v21 offset:0
    v_mfma_f32_16x16x32_bf16 a[128:131], a[124:127], a[220:223], a[128:131]
    ds_read_b128 v[36:39], v21 offset:1024
    v_mfma_f32_16x16x32_bf16 a[156:159], a[188:191], a[220:223], a[156:159]
    ds_read_b128 v[64:67], v21 offset:2048
    v_mfma_f32_16x16x32_bf16 a[160:163], a[92:95], a[220:223], a[160:163]
    ds_read_b128 v[88:91], v21 offset:3072
    s_waitcnt vmcnt(11)
    v_mfma_f32_16x16x32_bf16 a[40:43], a[180:183], a[84:87], a[40:43]
    ds_read_b128 v[92:95], v21 offset:4096
    v_mfma_f32_16x16x32_bf16 a[200:203], a[96:99], a[84:87], a[200:203]
    ds_read_b128 v[68:71], v22 offset:14336
    v_mfma_f32_16x16x32_bf16 a[128:131], a[44:47], a[84:87], a[128:131]
    ds_read_b128 v[48:51], v22 offset:15360
    v_mfma_f32_16x16x32_bf16 a[156:159], a[140:143], a[84:87], a[156:159]
    ds_read_b128 v[76:79], v22 offset:16384
    v_mfma_f32_16x16x32_bf16 a[160:163], a[132:135], a[84:87], a[160:163]
    s_waitcnt lgkmcnt(2)
    v_add_f32 v116, v116, v68
    v_add_f32 v117, v117, v69
    s_waitcnt vmcnt(10)
    v_mfma_f32_16x16x32_bf16 a[40:43], a[76:79], a[88:91], a[40:43]
    v_add_f32 v118, v118, v70
    v_add_f32 v119, v119, v71
    v_mfma_f32_16x16x32_bf16 a[200:203], a[136:139], a[88:91], a[200:203]
    ds_read_b128 v[68:71], v22 offset:17408
    s_waitcnt lgkmcnt(2)
    v_add_f32 v36, v36, v48
    v_add_f32 v37, v37, v49
    v_mfma_f32_16x16x32_bf16 a[128:131], a[232:235], a[88:91], a[128:131]
    v_add_f32 v38, v38, v50
    v_add_f32 v39, v39, v51
    v_mfma_f32_16x16x32_bf16 a[156:159], a[236:239], a[88:91], a[156:159]
    ds_read_b128 v[48:51], v22 offset:18432
    s_waitcnt lgkmcnt(2)
    v_add_f32 v64, v64, v76
    v_add_f32 v65, v65, v77
    v_mfma_f32_16x16x32_bf16 a[160:163], a[24:27], a[88:91], a[160:163]
    v_add_f32 v66, v66, v78
    v_add_f32 v67, v67, v79
    s_waitcnt vmcnt(9)
    v_mfma_f32_16x16x32_bf16 a[40:43], v[236:239], a[108:111], a[40:43]
    s_waitcnt lgkmcnt(1)
    v_add_f32 v88, v88, v68
    v_add_f32 v89, v89, v69
    v_mfma_f32_16x16x32_bf16 a[200:203], a[204:207], a[108:111], a[200:203]
    v_add_f32 v90, v90, v70
    v_add_f32 v91, v91, v71
    v_mfma_f32_16x16x32_bf16 a[128:131], a[208:211], a[108:111], a[128:131]
    s_waitcnt lgkmcnt(0)
    v_add_f32 v92, v92, v48
    v_add_f32 v93, v93, v49
    v_mfma_f32_16x16x32_bf16 a[156:159], a[164:167], a[108:111], a[156:159]
    v_add_f32 v94, v94, v50
    v_add_f32 v95, v95, v51
    v_mfma_f32_16x16x32_bf16 a[160:163], a[0:3], a[108:111], a[160:163]
    s_waitcnt vmcnt(8)
    v_mfma_f32_16x16x32_bf16 a[40:43], a[224:227], a[112:115], a[40:43]
    v_mfma_f32_16x16x32_bf16 a[200:203], a[228:231], a[112:115], a[200:203]
    v_mfma_f32_16x16x32_bf16 a[128:131], a[100:103], a[112:115], a[128:131]
    v_mfma_f32_16x16x32_bf16 a[156:159], a[144:147], a[112:115], a[156:159]
    v_mfma_f32_16x16x32_bf16 a[160:163], a[148:151], a[112:115], a[160:163]
    s_nop 3
    v_accvgpr_read_b32 v8, a40
    v_cmp_u_f32 vcc, v8, v8
    s_cbranch_vccnz G6l2
G6l2_R:
    s_waitcnt vmcnt(7)
    v_mfma_f32_16x16x32_bf16 v[108:111], a[120:123], a[212:215], v[72:75]
    ds_write_b128 v20, a[40:43] offset:7168
    v_mfma_f32_16x16x32_bf16 v[112:115], a[20:23], a[212:215], v[56:59]
    v_mfma_f32_16x16x32_bf16 v[40:43], a[244:247], a[212:215], v[60:63]
    v_mfma_f32_16x16x32_bf16 v[52:55], a[248:251], a[212:215], v[32:35]
    ds_write_b128 v20, a[200:203] offset:8192
    v_mfma_f32_16x16x32_bf16 v[124:127], a[80:83], a[212:215], v[120:123]
    s_waitcnt vmcnt(6)
    v_mfma_f32_16x16x32_bf16 v[108:111], a[16:19], a[28:31], v[108:111]
    v_mfma_f32_16x16x32_bf16 v[112:115], a[68:71], a[28:31], v[112:115]
    ds_write_b128 v20, a[128:131] offset:9216
    v_mfma_f32_16x16x32_bf16 v[40:43], a[72:75], a[28:31], v[40:43]
    v_mfma_f32_16x16x32_bf16 v[52:55], a[152:155], a[28:31], v[52:55]
    v_mfma_f32_16x16x32_bf16 v[124:127], a[216:219], a[28:31], v[124:127]
    ds_write_b128 v20, a[156:159] offset:10240
    s_waitcnt vmcnt(5)
    v_mfma_f32_16x16x32_bf16 v[108:111], a[52:55], a[32:35], v[108:111]
    v_mfma_f32_16x16x32_bf16 v[112:115], a[64:67], a[32:35], v[112:115]
    v_mfma_f32_16x16x32_bf16 v[40:43], a[184:187], a[32:35], v[40:43]
    ds_write_b128 v20, a[160:163] offset:11264
    v_mfma_f32_16x16x32_bf16 v[52:55], a[240:243], a[32:35], v[52:55]
    v_mfma_f32_16x16x32_bf16 v[124:127], v[252:255], a[32:35], v[124:127]
    s_waitcnt vmcnt(4)
    v_mfma_f32_16x16x32_bf16 v[108:111], v[244:247], a[36:39], v[108:111]
    s_waitcnt lgkmcnt(0)
    s_barrier
    v_mfma_f32_16x16x32_bf16 v[112:115], v[240:243], a[36:39], v[112:115]
    ds_read_b128 v[68:71], v23 offset:7168
    v_mfma_f32_16x16x32_bf16 v[40:43], a[124:127], a[36:39], v[40:43]
    ds_read_b128 v[48:51], v23 offset:8192
    v_mfma_f32_16x16x32_bf16 v[52:55], a[188:191], a[36:39], v[52:55]
    ds_read_b128 v[76:79], v23 offset:9216
    v_mfma_f32_16x16x32_bf16 v[124:127], a[92:95], a[36:39], v[124:127]
    s_waitcnt lgkmcnt(2)
    v_add_f32 v116, v116, v68
    v_add_f32 v117, v117, v69
    s_waitcnt vmcnt(3)
    v_mfma_f32_16x16x32_bf16 v[108:111], a[180:183], a[176:179], v[108:111]
    v_add_f32 v118, v118, v70
    v_add_f32 v119, v119, v71
    v_mfma_f32_16x16x32_bf16 v[112:115], a[96:99], a[176:179], v[112:115]
    ds_read_b128 v[68:71], v23 offset:10240
    s_waitcnt lgkmcnt(2)
    v_add_f32 v36, v36, v48
    v_add_f32 v37, v37, v49
    v_mfma_f32_16x16x32_bf16 v[40:43], a[44:47], a[176:179], v[40:43]
    v_add_f32 v38, v38, v50
    v_add_f32 v39, v39, v51
    v_mfma_f32_16x16x32_bf16 v[52:55], a[140:143], a[176:179], v[52:55]
    ds_read_b128 v[48:51], v23 offset:11264
    s_waitcnt lgkmcnt(2)
    v_add_f32 v64, v64, v76
    v_add_f32 v65, v65, v77
    v_mfma_f32_16x16x32_bf16 v[124:127], a[132:135], a[176:179], v[124:127]
    v_add_f32 v66, v66, v78
    v_add_f32 v67, v67, v79
    s_waitcnt vmcnt(2)
    v_mfma_f32_16x16x32_bf16 v[108:111], a[76:79], a[116:119], v[108:111]
    s_waitcnt lgkmcnt(1)
    v_add_f32 v88, v88, v68
    v_add_f32 v89, v89, v69
    v_mfma_f32_16x16x32_bf16 v[112:115], a[136:139], a[116:119], v[112:115]
    v_add_f32 v90, v90, v70
    v_add_f32 v91, v91, v71
    v_mfma_f32_16x16x32_bf16 v[40:43], a[232:235], a[116:119], v[40:43]
    s_waitcnt lgkmcnt(0)
    v_add_f32 v92, v92, v48
    v_add_f32 v93, v93, v49
    v_mfma_f32_16x16x32_bf16 v[52:55], a[236:239], a[116:119], v[52:55]
    v_add_f32 v94, v94, v50
    v_add_f32 v95, v95, v51
    v_mfma_f32_16x16x32_bf16 v[124:127], a[24:27], a[116:119], v[124:127]
    s_waitcnt vmcnt(1)
    v_mfma_f32_16x16x32_bf16 v[108:111], v[236:239], a[4:7], v[108:111]
    v_mfma_f32_16x16x32_bf16 v[112:115], a[204:207], a[4:7], v[112:115]
    v_mfma_f32_16x16x32_bf16 v[40:43], a[208:211], a[4:7], v[40:43]
    v_mfma_f32_16x16x32_bf16 v[52:55], a[164:167], a[4:7], v[52:55]
    v_mfma_f32_16x16x32_bf16 v[124:127], a[0:3], a[4:7], v[124:127]
    s_waitcnt vmcnt(0)
    v_mfma_f32_16x16x32_bf16 v[108:111], a[224:227], v[208:211], v[108:111]
    v_mfma_f32_16x16x32_bf16 v[112:115], a[228:231], v[208:211], v[112:115]
    v_mfma_f32_16x16x32_bf16 v[40:43], a[100:103], v[208:211], v[40:43]
    v_mfma_f32_16x16x32_bf16 v[52:55], a[144:147], v[208:211], v[52:55]
    v_mfma_f32_16x16x32_bf16 v[124:127], a[148:151], v[208:211], v[124:127]
    s_nop 3
    v_cmp_u_f32 vcc, v108, v108
    s_cbranch_vccnz G6l3
G6l3_R:
    v_pk_add_f32 v[108:109], v[108:109], v[116:117]
    v_pk_add_f32 v[110:111], v[110:111], v[118:119]
    v_pk_add_f32 v[112:113], v[112:113], v[36:37]
    v_pk_add_f32 v[114:115], v[114:115], v[38:39]
    v_pk_add_f32 v[40:41], v[40:41], v[64:65]
    v_pk_add_f32 v[42:43], v[42:43], v[66:67]
    v_pk_add_f32 v[52:53], v[52:53], v[88:89]
    v_pk_add_f32 v[54:55], v[54:55], v[90:91]
    v_pk_add_f32 v[124:125], v[124:125], v[92:93]
    v_pk_add_f32 v[126:127], v[126:127], v[94:95]
    v_cvt_pk_bf16_f32 v44, v108, v109
    v_cvt_pk_bf16_f32 v45, v110, v111
    v_cvt_pk_bf16_f32 v46, v112, v113
    v_cvt_pk_bf16_f32 v47, v114, v115
    v_cvt_pk_bf16_f32 v96, v40, v41
    v_cvt_pk_bf16_f32 v97, v42, v43
    v_cvt_pk_bf16_f32 v98, v52, v53
    v_cvt_pk_bf16_f32 v99, v54, v55
    v_cvt_pk_bf16_f32 v100, v124, v125
    v_cvt_pk_bf16_f32 v101, v126, v127
    buffer_store_dwordx4 v[44:47], v6, s[16:19], 0 offen
    buffer_store_dwordx4 v[96:99], v6, s[16:19], 0 offen offset:16
    buffer_store_dwordx2 v[100:101], v6, s[16:19], 0 offen offset:32
G_END:
    s_endpgm
G_SE:
    s_add_u32 s28, s67, 0
    buffer_store_dwordx4 a[4:7], v9, s[24:27], s28 offen sc1
    buffer_store_dwordx4 a[4:7], v9, s[24:27], s28 offen offset:1024 sc1
    s_add_u32 s28, s68, 0
    buffer_store_dwordx2 a[4:5], v9, s[24:27], s28 offen sc1
    s_add_u32 s28, s67, 2752512
    buffer_store_dwordx4 a[4:7], v9, s[24:27], s28 offen sc1
    buffer_store_dwordx4 a[4:7], v9, s[24:27], s28 offen offset:1024 sc1
    s_add_u32 s28, s68, 2752512
    buffer_store_dwordx2 a[4:5], v9, s[24:27], s28 offen sc1
    s_add_u32 s28, s73, 17825792
    buffer_store_dwordx2 a[4:5], v11, s[24:27], s28 offen sc1
    s_add_u32 s28, s69, 10747904
    s_add_u32 s28, s28, s71
    buffer_store_dwordx4 a[4:7], v9, s[24:27], s28 offen sc1
    buffer_store_dwordx4 a[4:7], v9, s[24:27], s28 offen offset:1024 sc1
    buffer_store_dwordx4 a[4:7], v9, s[24:27], s28 offen offset:2048 sc1
    s_add_u32 s28, s69, 10797056
    buffer_store_dwordx2 a[4:5], v10, s[24:27], s28 offen sc1
    s_add_u32 s28, s70, 10747904
    s_add_u32 s28, s28, s71
    buffer_store_dwordx4 a[4:7], v9, s[24:27], s28 offen sc1
    buffer_store_dwordx4 a[4:7], v9, s[24:27], s28 offen offset:1024 sc1
    buffer_store_dwordx4 a[4:7], v9, s[24:27], s28 offen offset:2048 sc1
    s_add_u32 s28, s70, 10797056
    buffer_store_dwordx2 a[4:5], v10, s[24:27], s28 offen sc1
    v_mov_b32 v9, v18
    v_mov_b32 v10, v18
    v_mov_b32 v11, v18
    s_branch G_SE_R
G_RP1_S:
    buffer_store_byte v17, v19, s[24:27], s64 offen offset:1024 sc1
    s_branch G_RP1_R
G_S31_S:
    s_add_u32 s28, s3, 0
    buffer_store_dwordx4 v[84:87], v29, s[24:27], s28 offen sc1
    s_branch G_S31_R
G_S33_S:
    s_add_u32 s28, s3, 1024
    buffer_store_dwordx4 v[84:87], v29, s[24:27], s28 offen sc1
    s_branch G_S33_R
G_S34_S:
    s_add_u32 s28, s66, 0
    buffer_store_dwordx2 v[84:85], v29, s[24:27], s28 offen sc1
    s_add_u32 s28, s65, 0
    buffer_store_dwordx2 v[86:87], v31, s[24:27], s28 offen sc1
    s_branch G_S34_R
G_RC1:
    s_cmp_eq_u32 s49, 0
    s_cbranch_scc1 G_RC1_R
    s_sub_u32 s49, s49, 1
    v_and_b32 v8, 7, v1
    v_lshlrev_b32 v8, 2, v8
    buffer_load_dword v8, v8, s[24:27], s9 offen offset:1024 sc1
    s_waitcnt vmcnt(0)
    v_and_b32 v8, s74, v8
    v_cmp_ne_u32 vcc, s74, v8
    s_cbranch_vccnz G_RC1
    s_branch G_RC1_R
G40:
    s_cmp_eq_u32 s49, 0
    s_cbranch_scc1 G40_X
    s_sub_u32 s49, s49, 1
    s_add_u32 s28, s52, s11
    buffer_load_dwordx4 a[76:79], v4, s[24:27], s28 offen sc1
    buffer_load_dwordx4 a[108:111], v4, s[24:27], s28 offen offset:1024 sc1
    buffer_load_dwordx4 a[112:115], v4, s[24:27], s28 offen offset:2048 sc1
    buffer_load_dwordx4 a[116:119], v4, s[24:27], s28 offen offset:3072 sc1
    buffer_load_dwordx4 a[120:123], v5, s[24:27], s28 offen sc1
    s_waitcnt vmcnt(0)
    v_mfma_f32_16x16x32_bf16 a[84:87], a[20:23], a[76:79], 0
    v_mfma_f32_16x16x32_bf16 a[84:87], a[40:43], a[108:111], a[84:87]
    v_mfma_f32_16x16x32_bf16 a[84:87], a[220:223], a[112:115], a[84:87]
    v_mfma_f32_16x16x32_bf16 a[84:87], a[8:11], a[116:119], a[84:87]
    v_mfma_f32_16x16x32_bf16 a[84:87], a[208:211], a[120:123], a[84:87]
    s_nop 7
    s_nop 3
    v_accvgpr_read_b32 v8, a84
    v_cmp_u_f32 vcc, v8, v8
    s_cbranch_vccnz G40
G40_X:
    s_add_u32 s28, s52, s12
    buffer_load_dwordx4 a[144:147], v4, s[24:27], s28 offen sc1
    buffer_load_dwordx4 a[148:151], v4, s[24:27], s28 offen offset:1024 sc1
    buffer_load_dwordx4 a[156:159], v4, s[24:27], s28 offen offset:2048 sc1
    buffer_load_dwordx4 a[160:163], v4, s[24:27], s28 offen offset:3072 sc1
    buffer_load_dwordx4 a[176:179], v5, s[24:27], s28 offen sc1
    s_add_u32 s28, s52, s13
    buffer_load_dwordx4 a[180:183], v4, s[24:27], s28 offen sc1
    buffer_load_dwordx4 a[184:187], v4, s[24:27], s28 offen offset:1024 sc1
    buffer_load_dwordx4 a[192:195], v4, s[24:27], s28 offen offset:2048 sc1
    buffer_load_dwordx4 a[212:215], v4, s[24:27], s28 offen offset:3072 sc1
    buffer_load_dwordx4 a[124:127], v5, s[24:27], s28 offen sc1
    s_add_u32 s28, s52, s10
    buffer_load_dwordx4 a[128:131], v4, s[24:27], s28 offen sc1
    v_mfma_f32_16x16x32_bf16 a[88:91], a[24:27], a[76:79], 0
    v_mfma_f32_16x16x32_bf16 a[96:99], a[28:31], a[76:79], 0
    v_mfma_f32_16x16x32_bf16 a[100:103], a[32:35], a[76:79], 0
    v_mfma_f32_16x16x32_bf16 a[104:107], a[36:39], a[76:79], 0
    v_mfma_f32_16x16x32_bf16 a[88:91], a[44:47], a[108:111], a[88:91]
    v_mfma_f32_16x16x32_bf16 a[96:99], a[140:143], a[108:111], a[96:99]
    v_mfma_f32_16x16x32_bf16 a[100:103], a[152:155], a[108:111], a[100:103]
    v_mfma_f32_16x16x32_bf16 a[104:107], a[216:219], a[108:111], a[104:107]
    v_mfma_f32_16x16x32_bf16 a[88:91], a[224:227], a[112:115], a[88:91]
    v_mfma_f32_16x16x32_bf16 a[96:99], a[228:231], a[112:115], a[96:99]
    v_mfma_f32_16x16x32_bf16 a[100:103], a[164:167], a[112:115], a[100:103]
    v_mfma_f32_16x16x32_bf16 a[104:107], a[0:3], a[112:115], a[104:107]
    v_mfma_f32_16x16x32_bf16 a[88:91], a[12:15], a[116:119], a[88:91]
    v_mfma_f32_16x16x32_bf16 a[96:99], a[196:199], a[116:119], a[96:99]
    v_mfma_f32_16x16x32_bf16 a[100:103], a[200:203], a[116:119], a[100:103]
    v_mfma_f32_16x16x32_bf16 a[104:107], a[204:207], a[116:119], a[104:107]
    v_mfma_f32_16x16x32_bf16 a[88:91], a[136:139], a[120:123], a[88:91]
    v_mfma_f32_16x16x32_bf16 a[96:99], a[232:235], a[120:123], a[96:99]
    v_mfma_f32_16x16x32_bf16 a[100:103], a[236:239], a[120:123], a[100:103]
    v_mfma_f32_16x16x32_bf16 a[104:107], a[240:243], a[120:123], a[104:107]
    s_waitcnt vmcnt(0)
    s_nop 7
    s_nop 3
    s_branch G40_R
G41:
    s_cmp_eq_u32 s49, 0
    s_cbranch_scc1 G41_X
    s_sub_u32 s49, s49, 1
    s_add_u32 s28, s52, s12
    buffer_load_dwordx4 a[144:147], v4, s[24:27], s28 offen sc1
    buffer_load_dwordx4 a[148:151], v4, s[24:27], s28 offen offset:1024 sc1
    buffer_load_dwordx4 a[156:159], v4, s[24:27], s28 offen offset:2048 sc1
    buffer_load_dwordx4 a[160:163], v4, s[24:27], s28 offen offset:3072 sc1
    buffer_load_dwordx4 a[176:179], v5, s[24:27], s28 offen sc1
    s_waitcnt vmcnt(0)
    v_mfma_f32_16x16x32_bf16 a[132:135], a[20:23], a[144:147], 0
    v_mfma_f32_16x16x32_bf16 a[132:135], a[40:43], a[148:151], a[132:135]
    v_mfma_f32_16x16x32_bf16 a[132:135], a[220:223], a[156:159], a[132:135]
    v_mfma_f32_16x16x32_bf16 a[132:135], a[8:11], a[160:163], a[132:135]
    v_mfma_f32_16x16x32_bf16 a[132:135], a[208:211], a[176:179], a[132:135]
    s_nop 7
    s_nop 3
    v_accvgpr_read_b32 v8, a132
    v_cmp_u_f32 vcc, v8, v8
    s_cbranch_vccnz G41
G41_X:
    s_add_u32 s28, s52, s13
    buffer_load_dwordx4 a[180:183], v4, s[24:27], s28 offen sc1
    buffer_load_dwordx4 a[184:187], v4, s[24:27], s28 offen offset:1024 sc1
    buffer_load_dwordx4 a[192:195], v4, s[24:27], s28 offen offset:2048 sc1
    buffer_load_dwordx4 a[212:215], v4, s[24:27], s28 offen offset:3072 sc1
    buffer_load_dwordx4 a[124:127], v5, s[24:27], s28 offen sc1
    s_add_u32 s28, s52, s10
    buffer_load_dwordx4 a[128:131], v4, s[24:27], s28 offen sc1
    buffer_load_dwordx4 a[120:123], v4, s[24:27], s28 offen offset:1024 sc1
    buffer_load_dwordx4 v[248:251], v4, s[24:27], s28 offen offset:2048 sc1
    buffer_load_dwordx4 v[244:247], v4, s[24:27], s28 offen offset:3072 sc1
    buffer_load_dwordx4 v[240:243], v5, s[24:27], s28 offen sc1
    v_mfma_f32_16x16x32_bf16 a[76:79], a[24:27], a[144:147], 0
    v_mfma_f32_16x16x32_bf16 a[108:111], a[28:31], a[144:147], 0
    v_mfma_f32_16x16x32_bf16 a[112:115], a[32:35], a[144:147], 0
    v_mfma_f32_16x16x32_bf16 a[116:119], a[36:39], a[144:147], 0
    v_mfma_f32_16x16x32_bf16 a[76:79], a[44:47], a[148:151], a[76:79]
    v_mfma_f32_16x16x32_bf16 a[108:111], a[140:143], a[148:151], a[108:111]
    v_mfma_f32_16x16x32_bf16 a[112:115], a[152:155], a[148:151], a[112:115]
    v_mfma_f32_16x16x32_bf16 a[116:119], a[216:219], a[148:151], a[116:119]
    v_mfma_f32_16x16x32_bf16 a[76:79], a[224:227], a[156:159], a[76:79]
    v_mfma_f32_16x16x32_bf16 a[108:111], a[228:231], a[156:159], a[108:111]
    v_mfma_f32_16x16x32_bf16 a[112:115], a[164:167], a[156:159], a[112:115]
    v_mfma_f32_16x16x32_bf16 a[116:119], a[0:3], a[156:159], a[116:119]
    v_mfma_f32_16x16x32_bf16 a[76:79], a[12:15], a[160:163], a[76:79]
    v_mfma_f32_16x16x32_bf16 a[108:111], a[196:199], a[160:163], a[108:111]
    v_mfma_f32_16x16x32_bf16 a[112:115], a[200:203], a[160:163], a[112:115]
    v_mfma_f32_16x16x32_bf16 a[116:119], a[204:207], a[160:163], a[116:119]
    v_mfma_f32_16x16x32_bf16 a[76:79], a[136:139], a[176:179], a[76:79]
    v_mfma_f32_16x16x32_bf16 a[108:111], a[232:235], a[176:179], a[108:111]
    v_mfma_f32_16x16x32_bf16 a[112:115], a[236:239], a[176:179], a[112:115]
    v_mfma_f32_16x16x32_bf16 a[116:119], a[240:243], a[176:179], a[116:119]
    s_waitcnt vmcnt(0)
    s_nop 7
    s_nop 3
    s_branch G41_R
G42:
    s_cmp_eq_u32 s49, 0
    s_cbranch_scc1 G42_X
    s_sub_u32 s49, s49, 1
    s_add_u32 s28, s52, s13
    buffer_load_dwordx4 a[180:183], v4, s[24:27], s28 offen sc1
    buffer_load_dwordx4 a[184:187], v4, s[24:27], s28 offen offset:1024 sc1
    buffer_load_dwordx4 a[192:195], v4, s[24:27], s28 offen offset:2048 sc1
    buffer_load_dwordx4 a[212:215], v4, s[24:27], s28 offen offset:3072 sc1
    buffer_load_dwordx4 a[124:127], v5, s[24:27], s28 offen sc1
    s_waitcnt vmcnt(0)
    v_mfma_f32_16x16x32_bf16 a[96:99], a[20:23], a[180:183], 0
    v_mfma_f32_16x16x32_bf16 a[96:99], a[40:43], a[184:187], a[96:99]
    v_mfma_f32_16x16x32_bf16 a[96:99], a[220:223], a[192:195], a[96:99]
    v_mfma_f32_16x16x32_bf16 a[96:99], a[8:11], a[212:215], a[96:99]
    v_mfma_f32_16x16x32_bf16 a[96:99], a[208:211], a[124:127], a[96:99]
    s_nop 7
    s_nop 3
    v_accvgpr_read_b32 v8, a96
    v_cmp_u_f32 vcc, v8, v8
    s_cbranch_vccnz G42
G42_X:
    s_add_u32 s28, s52, s10
    buffer_load_dwordx4 a[128:131], v4, s[24:27], s28 offen sc1
    buffer_load_dwordx4 a[120:123], v4, s[24:27], s28 offen offset:1024 sc1
    buffer_load_dwordx4 v[248:251], v4, s[24:27], s28 offen offset:2048 sc1
    buffer_load_dwordx4 v[244:247], v4, s[24:27], s28 offen offset:3072 sc1
    buffer_load_dwordx4 v[240:243], v5, s[24:27], s28 offen sc1
    v_mfma_f32_16x16x32_bf16 a[100:103], a[24:27], a[180:183], 0
    v_mfma_f32_16x16x32_bf16 a[104:107], a[28:31], a[180:183], 0
    v_mfma_f32_16x16x32_bf16 a[144:147], a[32:35], a[180:183], 0
    v_mfma_f32_16x16x32_bf16 a[148:151], a[36:39], a[180:183], 0
    v_mfma_f32_16x16x32_bf16 a[100:103], a[44:47], a[184:187], a[100:103]
    v_mfma_f32_16x16x32_bf16 a[104:107], a[140:143], a[184:187], a[104:107]
    v_mfma_f32_16x16x32_bf16 a[144:147], a[152:155], a[184:187], a[144:147]
    v_mfma_f32_16x16x32_bf16 a[148:151], a[216:219], a[184:187], a[148:151]
    v_mfma_f32_16x16x32_bf16 a[100:103], a[224:227], a[192:195], a[100:103]
    v_mfma_f32_16x16x32_bf16 a[104:107], a[228:231], a[192:195], a[104:107]
    v_mfma_f32_16x16x32_bf16 a[144:147], a[164:167], a[192:195], a[144:147]
    v_mfma_f32_16x16x32_bf16 a[148:151], a[0:3], a[192:195], a[148:151]
    v_mfma_f32_16x16x32_bf16 a[100:103], a[12:15], a[212:215], a[100:103]
    v_mfma_f32_16x16x32_bf16 a[104:107], a[196:199], a[212:215], a[104:107]
    v_mfma_f32_16x16x32_bf16 a[144:147], a[200:203], a[212:215], a[144:147]
    v_mfma_f32_16x16x32_bf16 a[148:151], a[204:207], a[212:215], a[148:151]
    v_mfma_f32_16x16x32_bf16 a[100:103], a[136:139], a[124:127], a[100:103]
    v_mfma_f32_16x16x32_bf16 a[104:107], a[232:235], a[124:127], a[104:107]
    v_mfma_f32_16x16x32_bf16 a[144:147], a[236:239], a[124:127], a[144:147]
    v_mfma_f32_16x16x32_bf16 a[148:151], a[240:243], a[124:127], a[148:151]
    s_waitcnt vmcnt(0)
    s_nop 7
    s_nop 3
    s_branch G42_R
G_RP2_S:
    buffer_store_byte v17, v19, s[24:27], s64 offen offset:2048 sc1
    s_branch G_RP2_R
G43:
    s_cmp_eq_u32 s49, 0
    s_cbranch_scc1 G43_X
    s_sub_u32 s49, s49, 1
    s_add_u32 s28, s52, s10
    buffer_load_dwordx4 a[128:131], v4, s[24:27], s28 offen sc1
    buffer_load_dwordx4 a[120:123], v4, s[24:27], s28 offen offset:1024 sc1
    buffer_load_dwordx4 v[248:251], v4, s[24:27], s28 offen offset:2048 sc1
    buffer_load_dwordx4 v[244:247], v4, s[24:27], s28 offen offset:3072 sc1
    buffer_load_dwordx4 v[240:243], v5, s[24:27], s28 offen sc1
    s_waitcnt vmcnt(0)
    v_mfma_f32_16x16x32_bf16 v[120:123], a[20:23], a[128:131], v[124:127]
    v_mfma_f32_16x16x32_bf16 v[120:123], a[40:43], a[120:123], v[120:123]
    v_mfma_f32_16x16x32_bf16 v[120:123], a[220:223], v[248:251], v[120:123]
    v_mfma_f32_16x16x32_bf16 v[120:123], a[8:11], v[244:247], v[120:123]
    v_mfma_f32_16x16x32_bf16 v[120:123], a[208:211], v[240:243], v[120:123]
    s_nop 7
    s_nop 3
    v_cmp_u_f32 vcc, v120, v120
    s_cbranch_vccnz G43
G43_X:
    v_mfma_f32_16x16x32_bf16 v[116:119], a[24:27], a[128:131], v[44:47]
    v_mfma_f32_16x16x32_bf16 v[236:239], a[28:31], a[128:131], v[48:51]
    v_mfma_f32_16x16x32_bf16 v[232:235], a[32:35], a[128:131], v[52:55]
    v_mfma_f32_16x16x32_bf16 v[228:231], a[36:39], a[128:131], v[56:59]
    v_mfma_f32_16x16x32_bf16 v[116:119], a[44:47], a[120:123], v[116:119]
    v_mfma_f32_16x16x32_bf16 v[236:239], a[140:143], a[120:123], v[236:239]
    v_mfma_f32_16x16x32_bf16 v[232:235], a[152:155], a[120:123], v[232:235]
    v_mfma_f32_16x16x32_bf16 v[228:231], a[216:219], a[120:123], v[228:231]
    v_mfma_f32_16x16x32_bf16 v[116:119], a[224:227], v[248:251], v[116:119]
    v_mfma_f32_16x16x32_bf16 v[236:239], a[228:231], v[248:251], v[236:239]
    v_mfma_f32_16x16x32_bf16 v[232:235], a[164:167], v[248:251], v[232:235]
    v_mfma_f32_16x16x32_bf16 v[228:231], a[0:3], v[248:251], v[228:231]
    v_mfma_f32_16x16x32_bf16 v[116:119], a[12:15], v[244:247], v[116:119]
    v_mfma_f32_16x16x32_bf16 v[236:239], a[196:199], v[244:247], v[236:239]
    v_mfma_f32_16x16x32_bf16 v[232:235], a[200:203], v[244:247], v[232:235]
    v_mfma_f32_16x16x32_bf16 v[228:231], a[204:207], v[244:247], v[228:231]
    v_mfma_f32_16x16x32_bf16 v[116:119], a[136:139], v[240:243], v[116:119]
    v_mfma_f32_16x16x32_bf16 v[236:239], a[232:235], v[240:243], v[236:239]
    v_mfma_f32_16x16x32_bf16 v[232:235], a[236:239], v[240:243], v[232:235]
    v_mfma_f32_16x16x32_bf16 v[228:231], a[240:243], v[240:243], v[228:231]
    s_waitcnt vmcnt(0)
    s_nop 7
    s_nop 3
    s_branch G43_R
G_SX_S:
    s_add_u32 s28, s67, 2752512
    buffer_store_dwordx4 v[80:83], v4, s[24:27], s28 offen sc1
    buffer_store_dwordx4 v[84:87], v4, s[24:27], s28 offen offset:1024 sc1
    s_add_u32 s28, s68, 2752512
    buffer_store_dwordx2 v[88:89], v4, s[24:27], s28 offen sc1
    s_branch G_SX_R
G_SS_S:
    s_add_u32 s28, s73, 17825792
    s_mov_b64 exec, 0xffff
    buffer_store_dwordx2 v[92:93], v4, s[24:27], s28 offen sc1
    s_mov_b64 exec, -1
    s_branch G_SS_R
G_RC2:
    s_cmp_eq_u32 s49, 0
    s_cbranch_scc1 G_RC2_R
    s_sub_u32 s49, s49, 1
    v_and_b32 v8, 7, v1
    v_lshlrev_b32 v8, 2, v8
    buffer_load_dword v8, v8, s[24:27], s9 offen offset:2048 sc1
    s_waitcnt vmcnt(0)
    v_and_b32 v8, s8, v8
    v_cmp_ne_u32 vcc, s8, v8
    s_cbranch_vccnz G_RC2
    s_branch G_RC2_R
G5a0:
    s_cmp_eq_u32 s49, 0
    s_cbranch_scc1 G5a0_X
    s_sub_u32 s49, s49, 1
    s_add_u32 s28, s52, 2752512
    s_add_u32 s28, s28, s11
    buffer_load_dwordx4 a[24:27], v4, s[24:27], s28 offen sc1
    buffer_load_dwordx4 a[28:31], v4, s[24:27], s28 offen offset:1024 sc1
    buffer_load_dwordx4 a[32:35], v4, s[24:27], s28 offen offset:2048 sc1
    buffer_load_dwordx4 a[36:39], v4, s[24:27], s28 offen offset:3072 sc1
    buffer_load_dwordx4 a[40:43], v5, s[24:27], s28 offen sc1
    s_waitcnt vmcnt(0)
    v_mfma_f32_16x16x32_bf16 a[100:103], a[244:247], a[24:27], 0
    v_mfma_f32_16x16x32_bf16 a[100:103], a[80:83], a[28:31], a[100:103]
    v_mfma_f32_16x16x32_bf16 a[100:103], a[68:71], a[32:35], a[100:103]
    v_mfma_f32_16x16x32_bf16 a[100:103], a[132:135], a[36:39], a[100:103]
    v_mfma_f32_16x16x32_bf16 a[100:103], a[184:187], a[40:43], a[100:103]
    s_nop 7
    s_nop 3
    v_accvgpr_read_b32 v8, a100
    v_cmp_u_f32 vcc, v8, v8
    s_cbranch_vccnz G5a0
G5a0_X:
    s_add_u32 s28, s52, 2752512
    s_add_u32 s28, s28, s12
    buffer_load_dwordx4 a[152:155], v4, s[24:27], s28 offen sc1
    buffer_load_dwordx4 a[216:219], v4, s[24:27], s28 offen offset:1024 sc1
    buffer_load_dwordx4 a[220:223], v4, s[24:27], s28 offen offset:2048 sc1
    buffer_load_dwordx4 a[224:227], v4, s[24:27], s28 offen offset:3072 sc1
    buffer_load_dwordx4 a[228:231], v5, s[24:27], s28 offen sc1
    s_add_u32 s28, s52, 2752512
    s_add_u32 s28, s28, s13
    buffer_load_dwordx4 a[164:167], v4, s[24:27], s28 offen sc1
    buffer_load_dwordx4 a[0:3], v4, s[24:27], s28 offen offset:1024 sc1
    buffer_load_dwordx4 a[8:11], v4, s[24:27], s28 offen offset:2048 sc1
    buffer_load_dwordx4 a[12:15], v4, s[24:27], s28 offen offset:3072 sc1
    v_mfma_f32_16x16x32_bf16 a[104:107], a[248:251], a[24:27], 0
    v_mfma_f32_16x16x32_bf16 a[144:147], a[168:171], a[24:27], 0
    v_mfma_f32_16x16x32_bf16 a[148:151], a[172:175], a[24:27], 0
    v_mfma_f32_16x16x32_bf16 a[128:131], a[188:191], a[24:27], 0
    v_mfma_f32_16x16x32_bf16 a[120:123], a[92:95], a[24:27], 0
    v_mfma_f32_16x16x32_bf16 a[20:23], a[252:255], a[24:27], 0
    v_mfma_f32_16x16x32_bf16 a[104:107], a[16:19], a[28:31], a[104:107]
    v_mfma_f32_16x16x32_bf16 a[144:147], a[48:51], a[28:31], a[144:147]
    v_mfma_f32_16x16x32_bf16 a[148:151], a[52:55], a[28:31], a[148:151]
    v_mfma_f32_16x16x32_bf16 a[128:131], a[56:59], a[28:31], a[128:131]
    v_mfma_f32_16x16x32_bf16 a[120:123], a[60:63], a[28:31], a[120:123]
    v_mfma_f32_16x16x32_bf16 a[20:23], a[64:67], a[28:31], a[20:23]
    v_mfma_f32_16x16x32_bf16 a[104:107], a[72:75], a[32:35], a[104:107]
    v_mfma_f32_16x16x32_bf16 a[144:147], a[84:87], a[32:35], a[144:147]
    v_mfma_f32_16x16x32_bf16 a[148:151], a[88:91], a[32:35], a[148:151]
    v_mfma_f32_16x16x32_bf16 a[128:131], a[156:159], a[32:35], a[128:131]
    v_mfma_f32_16x16x32_bf16 a[120:123], a[160:163], a[32:35], a[120:123]
    v_mfma_f32_16x16x32_bf16 a[20:23], a[176:179], a[32:35], a[20:23]
    v_mfma_f32_16x16x32_bf16 a[104:107], a[76:79], a[36:39], a[104:107]
    v_mfma_f32_16x16x32_bf16 a[144:147], a[108:111], a[36:39], a[144:147]
    v_mfma_f32_16x16x32_bf16 a[148:151], a[112:115], a[36:39], a[148:151]
    v_mfma_f32_16x16x32_bf16 a[128:131], a[116:119], a[36:39], a[128:131]
    v_mfma_f32_16x16x32_bf16 a[120:123], a[4:7], a[36:39], a[120:123]
    v_mfma_f32_16x16x32_bf16 a[20:23], a[180:183], a[36:39], a[20:23]
    v_mfma_f32_16x16x32_bf16 a[104:107], a[192:195], a[40:43], a[104:107]
    v_mfma_f32_16x16x32_bf16 a[144:147], a[212:215], a[40:43], a[144:147]
    v_mfma_f32_16x16x32_bf16 a[148:151], a[124:127], a[40:43], a[148:151]
    v_mfma_f32_16x16x32_bf16 a[128:131], a[96:99], a[40:43], a[128:131]
    v_mfma_f32_16x16x32_bf16 a[120:123], a[44:47], a[40:43], a[120:123]
    v_mfma_f32_16x16x32_bf16 a[20:23], a[140:143], a[40:43], a[20:23]
    s_waitcnt vmcnt(0)
    s_nop 7
    s_nop 3
    s_branch G5a0_R
G5a1:
    s_cmp_eq_u32 s49, 0
    s_cbranch_scc1 G5a1_X
    s_sub_u32 s49, s49, 1
    s_add_u32 s28, s52, 2752512
    s_add_u32 s28, s28, s12
    buffer_load_dwordx4 a[152:155], v4, s[24:27], s28 offen sc1
    buffer_load_dwordx4 a[216:219], v4, s[24:27], s28 offen offset:1024 sc1
    buffer_load_dwordx4 a[220:223], v4, s[24:27], s28 offen offset:2048 sc1
    buffer_load_dwordx4 a[224:227], v4, s[24:27], s28 offen offset:3072 sc1
    buffer_load_dwordx4 a[228:231], v5, s[24:27], s28 offen sc1
    s_waitcnt vmcnt(0)
    v_mfma_f32_16x16x32_bf16 a[196:199], a[244:247], a[152:155], 0
    v_mfma_f32_16x16x32_bf16 a[196:199], a[80:83], a[216:219], a[196:199]
    v_mfma_f32_16x16x32_bf16 a[196:199], a[68:71], a[220:223], a[196:199]
    v_mfma_f32_16x16x32_bf16 a[196:199], a[132:135], a[224:227], a[196:199]
    v_mfma_f32_16x16x32_bf16 a[196:199], a[184:187], a[228:231], a[196:199]
    s_nop 7
    s_nop 3
    v_accvgpr_read_b32 v8, a196
    v_cmp_u_f32 vcc, v8, v8
    s_cbranch_vccnz G5a1
G5a1_X:
    s_add_u32 s28, s52, 2752512
    s_add_u32 s28, s28, s13
    buffer_load_dwordx4 a[164:167], v4, s[24:27], s28 offen sc1
    buffer_load_dwordx4 a[0:3], v4, s[24:27], s28 offen offset:1024 sc1
    buffer_load_dwordx4 a[8:11], v4, s[24:27], s28 offen offset:2048 sc1
    buffer_load_dwordx4 a[12:15], v4, s[24:27], s28 offen offset:3072 sc1
    buffer_load_dwordx4 a[240:243], v5, s[24:27], s28 offen sc1
    s_add_u32 s28, s52, 2752512
    s_add_u32 s28, s28, s10
    buffer_load_dwordx4 a[24:27], v4, s[24:27], s28 offen sc1
    buffer_load_dwordx4 a[28:31], v4, s[24:27], s28 offen offset:1024 sc1
    buffer_load_dwordx4 a[32:35], v4, s[24:27], s28 offen offset:2048 sc1
    buffer_load_dwordx4 a[36:39], v4, s[24:27], s28 offen offset:3072 sc1
    buffer_load_dwordx4 a[40:43], v5, s[24:27], s28 offen sc1
    v_mfma_f32_16x16x32_bf16 a[200:203], a[248:251], a[152:155], 0
    v_mfma_f32_16x16x32_bf16 a[204:207], a[168:171], a[152:155], 0
    v_mfma_f32_16x16x32_bf16 a[208:211], a[172:175], a[152:155], 0
    v_mfma_f32_16x16x32_bf16 a[136:139], a[188:191], a[152:155], 0
    v_mfma_f32_16x16x32_bf16 a[232:235], a[92:95], a[152:155], 0
    v_mfma_f32_16x16x32_bf16 a[236:239], a[252:255], a[152:155], 0
    v_mfma_f32_16x16x32_bf16 a[200:203], a[16:19], a[216:219], a[200:203]
    v_mfma_f32_16x16x32_bf16 a[204:207], a[48:51], a[216:219], a[204:207]
    v_mfma_f32_16x16x32_bf16 a[208:211], a[52:55], a[216:219], a[208:211]
    v_mfma_f32_16x16x32_bf16 a[136:139], a[56:59], a[216:219], a[136:139]
    v_mfma_f32_16x16x32_bf16 a[232:235], a[60:63], a[216:219], a[232:235]
    v_mfma_f32_16x16x32_bf16 a[236:239], a[64:67], a[216:219], a[236:239]
    v_mfma_f32_16x16x32_bf16 a[200:203], a[72:75], a[220:223], a[200:203]
    v_mfma_f32_16x16x32_bf16 a[204:207], a[84:87], a[220:223], a[204:207]
    v_mfma_f32_16x16x32_bf16 a[208:211], a[88:91], a[220:223], a[208:211]
    v_mfma_f32_16x16x32_bf16 a[136:139], a[156:159], a[220:223], a[136:139]
    v_mfma_f32_16x16x32_bf16 a[232:235], a[160:163], a[220:223], a[232:235]
    v_mfma_f32_16x16x32_bf16 a[236:239], a[176:179], a[220:223], a[236:239]
    v_mfma_f32_16x16x32_bf16 a[200:203], a[76:79], a[224:227], a[200:203]
    v_mfma_f32_16x16x32_bf16 a[204:207], a[108:111], a[224:227], a[204:207]
    v_mfma_f32_16x16x32_bf16 a[208:211], a[112:115], a[224:227], a[208:211]
    v_mfma_f32_16x16x32_bf16 a[136:139], a[116:119], a[224:227], a[136:139]
    v_mfma_f32_16x16x32_bf16 a[232:235], a[4:7], a[224:227], a[232:235]
    v_mfma_f32_16x16x32_bf16 a[236:239], a[180:183], a[224:227], a[236:239]
    v_mfma_f32_16x16x32_bf16 a[200:203], a[192:195], a[228:231], a[200:203]
    v_mfma_f32_16x16x32_bf16 a[204:207], a[212:215], a[228:231], a[204:207]
    v_mfma_f32_16x16x32_bf16 a[208:211], a[124:127], a[228:231], a[208:211]
    v_mfma_f32_16x16x32_bf16 a[136:139], a[96:99], a[228:231], a[136:139]
    v_mfma_f32_16x16x32_bf16 a[232:235], a[44:47], a[228:231], a[232:235]
    v_mfma_f32_16x16x32_bf16 a[236:239], a[140:143], a[228:231], a[236:239]
    s_waitcnt vmcnt(0)
    s_nop 7
    s_nop 3
    s_branch G5a1_R
G5a_T:
    s_cmp_eq_u32 s49, 0
    s_cbranch_scc1 G5a_TR
    s_sub_u32 s49, s49, 1
    s_add_u32 s28, s72, 17825792
    buffer_load_dwordx4 v[112:115], v4, s[24:27], s28 offen sc1
    s_waitcnt vmcnt(0)
    v_add_f32 v125, v112, v114
    v_add_f32 v127, v113, v115
    v_add_f32 v45, v125, v127
    v_cmp_u_f32 vcc, v45, v45
    s_cbranch_vccnz G5a_T
    s_branch G5a_TR
G5a2:
    s_cmp_eq_u32 s49, 0
    s_cbranch_scc1 G5a2_X
    s_sub_u32 s49, s49, 1
    s_add_u32 s28, s52, 2752512
    s_add_u32 s28, s28, s13
    buffer_load_dwordx4 a[164:167], v4, s[24:27], s28 offen sc1
    buffer_load_dwordx4 a[0:3], v4, s[24:27], s28 offen offset:1024 sc1
    buffer_load_dwordx4 a[8:11], v4, s[24:27], s28 offen offset:2048 sc1
    buffer_load_dwordx4 a[12:15], v4, s[24:27], s28 offen offset:3072 sc1
    buffer_load_dwordx4 a[240:243], v5, s[24:27], s28 offen sc1
    s_waitcnt vmcnt(0)
    v_mfma_f32_16x16x32_bf16 a[152:155], a[244:247], a[164:167], a[100:103]
    v_mfma_f32_16x16x32_bf16 a[152:155], a[80:83], a[0:3], a[152:155]
    v_mfma_f32_16x16x32_bf16 a[152:155], a[68:71], a[8:11], a[152:155]
    v_mfma_f32_16x16x32_bf16 a[152:155], a[132:135], a[12:15], a[152:155]
    v_mfma_f32_16x16x32_bf16 a[152:155], a[184:187], a[240:243], a[152:155]
    s_nop 7
    s_nop 3
    v_accvgpr_read_b32 v8, a152
    v_cmp_u_f32 vcc, v8, v8
    s_cbranch_vccnz G5a2
G5a2_X:
    s_add_u32 s28, s52, 2752512
    s_add_u32 s28, s28, s10
    buffer_load_dwordx4 a[24:27], v4, s[24:27], s28 offen sc1
    buffer_load_dwordx4 a[28:31], v4, s[24:27], s28 offen offset:1024 sc1
    buffer_load_dwordx4 a[32:35], v4, s[24:27], s28 offen offset:2048 sc1
    buffer_load_dwordx4 a[36:39], v4, s[24:27], s28 offen offset:3072 sc1
    buffer_load_dwordx4 a[40:43], v5, s[24:27], s28 offen sc1
    s_add_u32 s28, s30, 2752512
    s_add_u32 s28, s28, s11
    buffer_load_dwordx4 a[220:223], v4, s[24:27], s28 offen sc1
    buffer_load_dwordx4 a[224:227], v4, s[24:27], s28 offen offset:1024 sc1
    buffer_load_dwordx4 a[228:231], v4, s[24:27], s28 offen offset:2048 sc1
    buffer_load_dwordx4 v[224:227], v4, s[24:27], s28 offen offset:3072 sc1
    v_mfma_f32_16x16x32_bf16 a[216:219], a[248:251], a[164:167], a[104:107]
    v_mfma_f32_16x16x32_bf16 a[216:219], a[16:19], a[0:3], a[216:219]
    v_mfma_f32_16x16x32_bf16 a[216:219], a[72:75], a[8:11], a[216:219]
    v_mfma_f32_16x16x32_bf16 a[216:219], a[76:79], a[12:15], a[216:219]
    v_mfma_f32_16x16x32_bf16 a[216:219], a[192:195], a[240:243], a[216:219]
    s_waitcnt vmcnt(0)
    s_nop 7
    s_nop 3
    s_branch G5a2_R
G5aS0_S:
    s_add_u32 s28, s69, s71
    s_add_u32 s28, s28, 10747904
    buffer_store_dwordx4 v[212:215], v4, s[24:27], s28 offen sc1
    s_branch G5aS0_R
G5aS1_S:
    s_add_u32 s28, s69, s71
    s_add_u32 s28, s28, 10748928
    buffer_store_dwordx4 v[208:211], v4, s[24:27], s28 offen sc1
    s_branch G5aS1_R
G5aS2_S:
    s_add_u32 s28, s69, s71
    s_add_u32 s28, s28, 10749952
    buffer_store_dwordx4 v[212:215], v4, s[24:27], s28 offen sc1
    s_branch G5aS2_R
G5aS3_S:
    s_add_u32 s28, s69, 10797056
    buffer_store_dwordx2 v[208:209], v15, s[24:27], s28 offen sc1
    s_branch G5aS3_R
G5a3:
    s_cmp_eq_u32 s49, 0
    s_cbranch_scc1 G5a3_X
    s_sub_u32 s49, s49, 1
    s_add_u32 s28, s52, 2752512
    s_add_u32 s28, s28, s10
    buffer_load_dwordx4 a[24:27], v4, s[24:27], s28 offen sc1
    buffer_load_dwordx4 a[28:31], v4, s[24:27], s28 offen offset:1024 sc1
    buffer_load_dwordx4 a[32:35], v4, s[24:27], s28 offen offset:2048 sc1
    buffer_load_dwordx4 a[36:39], v4, s[24:27], s28 offen offset:3072 sc1
    buffer_load_dwordx4 a[40:43], v5, s[24:27], s28 offen sc1
    s_waitcnt vmcnt(0)
    v_mfma_f32_16x16x32_bf16 v[220:223], a[244:247], a[24:27], v[120:123]
    v_mfma_f32_16x16x32_bf16 v[220:223], a[80:83], a[28:31], v[220:223]
    v_mfma_f32_16x16x32_bf16 v[220:223], a[68:71], a[32:35], v[220:223]
    v_mfma_f32_16x16x32_bf16 v[220:223], a[132:135], a[36:39], v[220:223]
    v_mfma_f32_16x16x32_bf16 v[220:223], a[184:187], a[40:43], v[220:223]
    s_nop 7
    s_nop 3
    v_cmp_u_f32 vcc, v220, v220
    s_cbranch_vccnz G5a3
G5a3_X:
    s_add_u32 s28, s30, 2752512
    s_add_u32 s28, s28, s11
    buffer_load_dwordx4 a[220:223], v4, s[24:27], s28 offen sc1
    buffer_load_dwordx4 a[224:227], v4, s[24:27], s28 offen offset:1024 sc1
    buffer_load_dwordx4 a[228:231], v4, s[24:27], s28 offen offset:2048 sc1
    buffer_load_dwordx4 v[224:227], v4, s[24:27], s28 offen offset:3072 sc1
    buffer_load_dwordx4 a[100:103], v5, s[24:27], s28 offen sc1
    s_add_u32 s28, s30, 2752512
    s_add_u32 s28, s28, s12
    buffer_load_dwordx4 a[104:107], v4, s[24:27], s28 offen sc1
    buffer_load_dwordx4 a[196:199], v4, s[24:27], s28 offen offset:1024 sc1
    buffer_load_dwordx4 a[200:203], v4, s[24:27], s28 offen offset:2048 sc1
    buffer_load_dwordx4 a[204:207], v4, s[24:27], s28 offen offset:3072 sc1
    v_mfma_f32_16x16x32_bf16 v[216:219], a[248:251], a[24:27], v[116:119]
    v_mfma_f32_16x16x32_bf16 v[216:219], a[16:19], a[28:31], v[216:219]
    v_mfma_f32_16x16x32_bf16 v[216:219], a[72:75], a[32:35], v[216:219]
    v_mfma_f32_16x16x32_bf16 v[216:219], a[76:79], a[36:39], v[216:219]
    v_mfma_f32_16x16x32_bf16 v[216:219], a[192:195], a[40:43], v[216:219]
    s_waitcnt vmcnt(0)
    s_nop 7
    s_nop 3
    s_branch G5a3_R
G5b0:
    s_cmp_eq_u32 s49, 0
    s_cbranch_scc1 G5b0_X
    s_sub_u32 s49, s49, 1
    s_add_u32 s28, s30, 2752512
    s_add_u32 s28, s28, s11
    buffer_load_dwordx4 a[220:223], v4, s[24:27], s28 offen sc1
    buffer_load_dwordx4 a[224:227], v4, s[24:27], s28 offen offset:1024 sc1
    buffer_load_dwordx4 a[228:231], v4, s[24:27], s28 offen offset:2048 sc1
    buffer_load_dwordx4 v[224:227], v4, s[24:27], s28 offen offset:3072 sc1
    buffer_load_dwordx4 a[100:103], v5, s[24:27], s28 offen sc1
    s_waitcnt vmcnt(0)
    v_mfma_f32_16x16x32_bf16 a[164:167], a[244:247], a[220:223], 0
    v_mfma_f32_16x16x32_bf16 a[164:167], a[80:83], a[224:227], a[164:167]
    v_mfma_f32_16x16x32_bf16 a[164:167], a[68:71], a[228:231], a[164:167]
    v_mfma_f32_16x16x32_bf16 a[164:167], a[132:135], v[224:227], a[164:167]
    v_mfma_f32_16x16x32_bf16 a[164:167], a[184:187], a[100:103], a[164:167]
    s_nop 7
    s_nop 3
    v_accvgpr_read_b32 v8, a164
    v_cmp_u_f32 vcc, v8, v8
    s_cbranch_vccnz G5b0
G5b0_X:
    s_add_u32 s28, s30, 2752512
    s_add_u32 s28, s28, s12
    buffer_load_dwordx4 a[104:107], v4, s[24:27], s28 offen sc1
    buffer_load_dwordx4 a[196:199], v4, s[24:27], s28 offen offset:1024 sc1
    buffer_load_dwordx4 a[200:203], v4, s[24:27], s28 offen offset:2048 sc1
    buffer_load_dwordx4 a[204:207], v4, s[24:27], s28 offen offset:3072 sc1
    buffer_load_dwordx4 a[208:211], v5, s[24:27], s28 offen sc1
    s_add_u32 s28, s30, 2752512
    s_add_u32 s28, s28, s13
    buffer_load_dwordx4 a[144:147], v4, s[24:27], s28 offen sc1
    buffer_load_dwordx4 a[148:151], v4, s[24:27], s28 offen offset:1024 sc1
    buffer_load_dwordx4 a[128:131], v4, s[24:27], s28 offen offset:2048 sc1
    buffer_load_dwordx4 a[120:123], v4, s[24:27], s28 offen offset:3072 sc1
    buffer_load_dwordx4 a[20:23], v5, s[24:27], s28 offen sc1
    v_mfma_f32_16x16x32_bf16 a[0:3], a[248:251], a[220:223], 0
    v_mfma_f32_16x16x32_bf16 a[8:11], a[168:171], a[220:223], 0
    v_mfma_f32_16x16x32_bf16 a[12:15], a[172:175], a[220:223], 0
    v_mfma_f32_16x16x32_bf16 a[240:243], a[188:191], a[220:223], 0
    v_mfma_f32_16x16x32_bf16 a[152:155], a[92:95], a[220:223], 0
    v_mfma_f32_16x16x32_bf16 a[216:219], a[252:255], a[220:223], 0
    v_mfma_f32_16x16x32_bf16 a[0:3], a[16:19], a[224:227], a[0:3]
    v_mfma_f32_16x16x32_bf16 a[8:11], a[48:51], a[224:227], a[8:11]
    v_mfma_f32_16x16x32_bf16 a[12:15], a[52:55], a[224:227], a[12:15]
    v_mfma_f32_16x16x32_bf16 a[240:243], a[56:59], a[224:227], a[240:243]
    v_mfma_f32_16x16x32_bf16 a[152:155], a[60:63], a[224:227], a[152:155]
    v_mfma_f32_16x16x32_bf16 a[216:219], a[64:67], a[224:227], a[216:219]
    v_mfma_f32_16x16x32_bf16 a[0:3], a[72:75], a[228:231], a[0:3]
    v_mfma_f32_16x16x32_bf16 a[8:11], a[84:87], a[228:231], a[8:11]
    v_mfma_f32_16x16x32_bf16 a[12:15], a[88:91], a[228:231], a[12:15]
    v_mfma_f32_16x16x32_bf16 a[240:243], a[156:159], a[228:231], a[240:243]
    v_mfma_f32_16x16x32_bf16 a[152:155], a[160:163], a[228:231], a[152:155]
    v_mfma_f32_16x16x32_bf16 a[216:219], a[176:179], a[228:231], a[216:219]
    v_mfma_f32_16x16x32_bf16 a[0:3], a[76:79], v[224:227], a[0:3]
    v_mfma_f32_16x16x32_bf16 a[8:11], a[108:111], v[224:227], a[8:11]
    v_mfma_f32_16x16x32_bf16 a[12:15], a[112:115], v[224:227], a[12:15]
    v_mfma_f32_16x16x32_bf16 a[240:243], a[116:119], v[224:227], a[240:243]
    v_mfma_f32_16x16x32_bf16 a[152:155], a[4:7], v[224:227], a[152:155]
    v_mfma_f32_16x16x32_bf16 a[216:219], a[180:183], v[224:227], a[216:219]
    v_mfma_f32_16x16x32_bf16 a[0:3], a[192:195], a[100:103], a[0:3]
    v_mfma_f32_16x16x32_bf16 a[8:11], a[212:215], a[100:103], a[8:11]
    v_mfma_f32_16x16x32_bf16 a[12:15], a[124:127], a[100:103], a[12:15]
    v_mfma_f32_16x16x32_bf16 a[240:243], a[96:99], a[100:103], a[240:243]
    v_mfma_f32_16x16x32_bf16 a[152:155], a[44:47], a[100:103], a[152:155]
    v_mfma_f32_16x16x32_bf16 a[216:219], a[140:143], a[100:103], a[216:219]
    s_waitcnt vmcnt(0)
    s_nop 7
    s_nop 3
    s_branch G5b0_R
G5b_T:
    s_cmp_eq_u32 s49, 0
    s_cbranch_scc1 G5b_TR
    s_sub_u32 s49, s49, 1
    s_add_u32 s28, s32, 17825792
    buffer_load_dwordx4 v[84:87], v4, s[24:27], s28 offen sc1
    s_waitcnt vmcnt(0)
    v_add_f32 v97, v84, v86
    v_add_f32 v99, v85, v87
    v_add_f32 v101, v97, v99
    v_cmp_u_f32 vcc, v101, v101
    s_cbranch_vccnz G5b_T
    s_branch G5b_TR
G5b1:
    s_cmp_eq_u32 s49, 0
    s_cbranch_scc1 G5b1_X
    s_sub_u32 s49, s49, 1
    s_add_u32 s28, s30, 2752512
    s_add_u32 s28, s28, s12
    buffer_load_dwordx4 a[104:107], v4, s[24:27], s28 offen sc1
    buffer_load_dwordx4 a[196:199], v4, s[24:27], s28 offen offset:1024 sc1
    buffer_load_dwordx4 a[200:203], v4, s[24:27], s28 offen offset:2048 sc1
    buffer_load_dwordx4 a[204:207], v4, s[24:27], s28 offen offset:3072 sc1
    buffer_load_dwordx4 a[208:211], v5, s[24:27], s28 offen sc1
    s_waitcnt vmcnt(0)
    v_mfma_f32_16x16x32_bf16 a[220:223], a[244:247], a[104:107], 0
    v_mfma_f32_16x16x32_bf16 a[220:223], a[80:83], a[196:199], a[220:223]
    v_mfma_f32_16x16x32_bf16 a[220:223], a[68:71], a[200:203], a[220:223]
    v_mfma_f32_16x16x32_bf16 a[220:223], a[132:135], a[204:207], a[220:223]
    v_mfma_f32_16x16x32_bf16 a[220:223], a[184:187], a[208:211], a[220:223]
    s_nop 7
    s_nop 3
    v_accvgpr_read_b32 v8, a220
    v_cmp_u_f32 vcc, v8, v8
    s_cbranch_vccnz G5b1
G5b1_X:
    s_add_u32 s28, s30, 2752512
    s_add_u32 s28, s28, s13
    buffer_load_dwordx4 a[144:147], v4, s[24:27], s28 offen sc1
    buffer_load_dwordx4 a[148:151], v4, s[24:27], s28 offen offset:1024 sc1
    buffer_load_dwordx4 a[128:131], v4, s[24:27], s28 offen offset:2048 sc1
    buffer_load_dwordx4 a[120:123], v4, s[24:27], s28 offen offset:3072 sc1
    buffer_load_dwordx4 a[20:23], v5, s[24:27], s28 offen sc1
    s_add_u32 s28, s30, 2752512
    s_add_u32 s28, s28, s10
    buffer_load_dwordx4 v[188:191], v4, s[24:27], s28 offen sc1
    buffer_load_dwordx4 v[184:187], v4, s[24:27], s28 offen offset:1024 sc1
    buffer_load_dwordx4 v[180:183], v4, s[24:27], s28 offen offset:2048 sc1
    buffer_load_dwordx4 v[176:179], v4, s[24:27], s28 offen offset:3072 sc1
    buffer_load_dwordx4 v[172:175], v5, s[24:27], s28 offen sc1
    v_mfma_f32_16x16x32_bf16 a[224:227], a[248:251], a[104:107], 0
    v_mfma_f32_16x16x32_bf16 a[228:231], a[168:171], a[104:107], 0
    v_mfma_f32_16x16x32_bf16 a[100:103], a[172:175], a[104:107], 0
    v_mfma_f32_16x16x32_bf16 v[200:203], a[188:191], a[104:107], 0
    v_mfma_f32_16x16x32_bf16 v[196:199], a[92:95], a[104:107], 0
    v_mfma_f32_16x16x32_bf16 v[192:195], a[252:255], a[104:107], 0
    v_mfma_f32_16x16x32_bf16 a[224:227], a[16:19], a[196:199], a[224:227]
    v_mfma_f32_16x16x32_bf16 a[228:231], a[48:51], a[196:199], a[228:231]
    v_mfma_f32_16x16x32_bf16 a[100:103], a[52:55], a[196:199], a[100:103]
    v_mfma_f32_16x16x32_bf16 v[200:203], a[56:59], a[196:199], v[200:203]
    v_mfma_f32_16x16x32_bf16 v[196:199], a[60:63], a[196:199], v[196:199]
    v_mfma_f32_16x16x32_bf16 v[192:195], a[64:67], a[196:199], v[192:195]
    v_mfma_f32_16x16x32_bf16 a[224:227], a[72:75], a[200:203], a[224:227]
    v_mfma_f32_16x16x32_bf16 a[228:231], a[84:87], a[200:203], a[228:231]
    v_mfma_f32_16x16x32_bf16 a[100:103], a[88:91], a[200:203], a[100:103]
    v_mfma_f32_16x16x32_bf16 v[200:203], a[156:159], a[200:203], v[200:203]
    v_mfma_f32_16x16x32_bf16 v[196:199], a[160:163], a[200:203], v[196:199]
    v_mfma_f32_16x16x32_bf16 v[192:195], a[176:179], a[200:203], v[192:195]
    v_mfma_f32_16x16x32_bf16 a[224:227], a[76:79], a[204:207], a[224:227]
    v_mfma_f32_16x16x32_bf16 a[228:231], a[108:111], a[204:207], a[228:231]
    v_mfma_f32_16x16x32_bf16 a[100:103], a[112:115], a[204:207], a[100:103]
    v_mfma_f32_16x16x32_bf16 v[200:203], a[116:119], a[204:207], v[200:203]
    v_mfma_f32_16x16x32_bf16 v[196:199], a[4:7], a[204:207], v[196:199]
    v_mfma_f32_16x16x32_bf16 v[192:195], a[180:183], a[204:207], v[192:195]
    v_mfma_f32_16x16x32_bf16 a[224:227], a[192:195], a[208:211], a[224:227]
    v_mfma_f32_16x16x32_bf16 a[228:231], a[212:215], a[208:211], a[228:231]
    v_mfma_f32_16x16x32_bf16 a[100:103], a[124:127], a[208:211], a[100:103]
    v_mfma_f32_16x16x32_bf16 v[200:203], a[96:99], a[208:211], v[200:203]
    v_mfma_f32_16x16x32_bf16 v[196:199], a[44:47], a[208:211], v[196:199]
    v_mfma_f32_16x16x32_bf16 v[192:195], a[140:143], a[208:211], v[192:195]
    s_waitcnt vmcnt(0)
    s_nop 7
    s_nop 3
    s_branch G5b1_R
G5b2:
    s_cmp_eq_u32 s49, 0
    s_cbranch_scc1 G5b2_X
    s_sub_u32 s49, s49, 1
    s_add_u32 s28, s30, 2752512
    s_add_u32 s28, s28, s13
    buffer_load_dwordx4 a[144:147], v4, s[24:27], s28 offen sc1
    buffer_load_dwordx4 a[148:151], v4, s[24:27], s28 offen offset:1024 sc1
    buffer_load_dwordx4 a[128:131], v4, s[24:27], s28 offen offset:2048 sc1
    buffer_load_dwordx4 a[120:123], v4, s[24:27], s28 offen offset:3072 sc1
    buffer_load_dwordx4 a[20:23], v5, s[24:27], s28 offen sc1
    s_waitcnt vmcnt(0)
    v_mfma_f32_16x16x32_bf16 a[104:107], a[244:247], a[144:147], a[164:167]
    v_mfma_f32_16x16x32_bf16 a[104:107], a[80:83], a[148:151], a[104:107]
    v_mfma_f32_16x16x32_bf16 a[104:107], a[68:71], a[128:131], a[104:107]
    v_mfma_f32_16x16x32_bf16 a[104:107], a[132:135], a[120:123], a[104:107]
    v_mfma_f32_16x16x32_bf16 a[104:107], a[184:187], a[20:23], a[104:107]
    s_nop 7
    s_nop 3
    v_accvgpr_read_b32 v8, a104
    v_cmp_u_f32 vcc, v8, v8
    s_cbranch_vccnz G5b2
G5b2_X:
    s_add_u32 s28, s30, 2752512
    s_add_u32 s28, s28, s10
    buffer_load_dwordx4 v[188:191], v4, s[24:27], s28 offen sc1
    buffer_load_dwordx4 v[184:187], v4, s[24:27], s28 offen offset:1024 sc1
    buffer_load_dwordx4 v[180:183], v4, s[24:27], s28 offen offset:2048 sc1
    buffer_load_dwordx4 v[176:179], v4, s[24:27], s28 offen offset:3072 sc1
    buffer_load_dwordx4 v[172:175], v5, s[24:27], s28 offen sc1
    v_mfma_f32_16x16x32_bf16 a[196:199], a[248:251], a[144:147], a[0:3]
    v_mfma_f32_16x16x32_bf16 a[196:199], a[16:19], a[148:151], a[196:199]
    v_mfma_f32_16x16x32_bf16 a[196:199], a[72:75], a[128:131], a[196:199]
    v_mfma_f32_16x16x32_bf16 a[196:199], a[76:79], a[120:123], a[196:199]
    v_mfma_f32_16x16x32_bf16 a[196:199], a[192:195], a[20:23], a[196:199]
    s_waitcnt vmcnt(0)
    s_nop 7
    s_nop 3
    s_branch G5b2_R
G5bS0_S:
    s_add_u32 s28, s70, s71
    s_add_u32 s28, s28, 10747904
    buffer_store_dwordx4 v[124:127], v4, s[24:27], s28 offen sc1
    s_branch G5bS0_R
G5bS1_S:
    s_add_u32 s28, s70, s71
    s_add_u32 s28, s28, 10748928
    buffer_store_dwordx4 v[44:47], v4, s[24:27], s28 offen sc1
    s_branch G5bS1_R
G5bS2_S:
    s_add_u32 s28, s70, s71
    s_add_u32 s28, s28, 10749952
    buffer_store_dwordx4 v[124:127], v4, s[24:27], s28 offen sc1
    s_branch G5bS2_R
G5bS3_S:
    s_add_u32 s28, s70, 10797056
    buffer_store_dwordx2 v[44:45], v15, s[24:27], s28 offen sc1
    s_branch G5bS3_R
G5b3:
    s_cmp_eq_u32 s49, 0
    s_cbranch_scc1 G5b3_X
    s_sub_u32 s49, s49, 1
    s_add_u32 s28, s30, 2752512
    s_add_u32 s28, s28, s10
    buffer_load_dwordx4 v[188:191], v4, s[24:27], s28 offen sc1
    buffer_load_dwordx4 v[184:187], v4, s[24:27], s28 offen offset:1024 sc1
    buffer_load_dwordx4 v[180:183], v4, s[24:27], s28 offen offset:2048 sc1
    buffer_load_dwordx4 v[176:179], v4, s[24:27], s28 offen offset:3072 sc1
    buffer_load_dwordx4 v[172:175], v5, s[24:27], s28 offen sc1
    s_waitcnt vmcnt(0)
    v_mfma_f32_16x16x32_bf16 v[72:75], a[244:247], v[188:191], v[104:107]
    v_mfma_f32_16x16x32_bf16 v[72:75], a[80:83], v[184:187], v[72:75]
    v_mfma_f32_16x16x32_bf16 v[72:75], a[68:71], v[180:183], v[72:75]
    v_mfma_f32_16x16x32_bf16 v[72:75], a[132:135], v[176:179], v[72:75]
    v_mfma_f32_16x16x32_bf16 v[72:75], a[184:187], v[172:175], v[72:75]
    s_nop 7
    s_nop 3
    v_cmp_u_f32 vcc, v72, v72
    s_cbranch_vccnz G5b3
G5b3_X:
    v_mfma_f32_16x16x32_bf16 v[56:59], a[248:251], v[188:191], v[80:83]
    v_mfma_f32_16x16x32_bf16 v[56:59], a[16:19], v[184:187], v[56:59]
    v_mfma_f32_16x16x32_bf16 v[56:59], a[72:75], v[180:183], v[56:59]
    v_mfma_f32_16x16x32_bf16 v[56:59], a[76:79], v[176:179], v[56:59]
    v_mfma_f32_16x16x32_bf16 v[56:59], a[192:195], v[172:175], v[56:59]
    s_waitcnt vmcnt(0)
    s_nop 7
    s_nop 3
    s_branch G5b3_R
G6e0:
    s_cmp_eq_u32 s49, 0
    s_cbranch_scc1 G6e0_X
    s_sub_u32 s49, s49, 1
    s_add_u32 s28, s41, 10747904
    s_add_u32 s28, s28, s15
    buffer_load_dwordx4 a[132:135], v4, s[24:27], s28 offen sc1
    buffer_load_dwordx4 a[76:79], v4, s[24:27], s28 offen offset:1024 sc1
    buffer_load_dwordx4 a[184:187], v4, s[24:27], s28 offen offset:2048 sc1
    buffer_load_dwordx4 a[192:195], v5, s[24:27], s28 offen offset:2048 sc1
    buffer_load_dwordx4 a[168:171], v5, s[24:27], s28 offen offset:3072 sc1
    s_add_u32 s28, s41, 10756096
    s_add_u32 s28, s28, s15
    buffer_load_dwordx4 a[172:175], v4, s[24:27], s28 offen sc1
    s_waitcnt vmcnt(0)
    v_mfma_f32_16x16x32_bf16 a[84:87], a[136:139], a[132:135], 0
    v_mfma_f32_16x16x32_bf16 a[84:87], a[32:35], a[76:79], a[84:87]
    v_mfma_f32_16x16x32_bf16 a[84:87], v[164:167], a[184:187], a[84:87]
    v_mfma_f32_16x16x32_bf16 a[84:87], v[144:147], a[192:195], a[84:87]
    v_mfma_f32_16x16x32_bf16 a[84:87], a[0:3], a[168:171], a[84:87]
    v_mfma_f32_16x16x32_bf16 a[84:87], v[140:143], a[172:175], a[84:87]
    s_nop 7
    s_nop 3
    v_accvgpr_read_b32 v8, a84
    v_cmp_u_f32 vcc, v8, v8
    s_cbranch_vccnz G6e0
G6e0_X:
    s_add_u32 s28, s41, 10747904
    s_add_u32 s28, s28, s54
    buffer_load_dwordx4 a[48:51], v4, s[24:27], s28 offen sc1
    buffer_load_dwordx4 a[104:107], v4, s[24:27], s28 offen offset:1024 sc1
    buffer_load_dwordx4 a[196:199], v4, s[24:27], s28 offen offset:2048 sc1
    buffer_load_dwordx4 a[8:11], v5, s[24:27], s28 offen offset:2048 sc1
    buffer_load_dwordx4 a[12:15], v5, s[24:27], s28 offen offset:3072 sc1
    s_add_u32 s28, s41, 10756096
    s_add_u32 s28, s28, s54
    buffer_load_dwordx4 a[240:243], v4, s[24:27], s28 offen sc1
    s_add_u32 s28, s41, 10747904
    s_add_u32 s28, s28, s55
    buffer_load_dwordx4 a[124:127], v4, s[24:27], s28 offen sc1
    buffer_load_dwordx4 a[188:191], v4, s[24:27], s28 offen offset:1024 sc1
    buffer_load_dwordx4 a[92:95], v4, s[24:27], s28 offen offset:2048 sc1
    buffer_load_dwordx4 a[252:255], v5, s[24:27], s28 offen offset:2048 sc1
    buffer_load_dwordx4 a[56:59], v5, s[24:27], s28 offen offset:3072 sc1
    s_add_u32 s28, s41, 10756096
    s_add_u32 s28, s28, s55
    buffer_load_dwordx4 a[60:63], v4, s[24:27], s28 offen sc1
    v_mfma_f32_16x16x32_bf16 a[88:91], a[232:235], a[132:135], 0
    v_mfma_f32_16x16x32_bf16 a[108:111], a[236:239], a[132:135], 0
    v_mfma_f32_16x16x32_bf16 a[112:115], a[24:27], a[132:135], 0
    v_mfma_f32_16x16x32_bf16 a[212:215], a[28:31], a[132:135], 0
    v_mfma_f32_16x16x32_bf16 a[88:91], a[36:39], a[76:79], a[88:91]
    v_mfma_f32_16x16x32_bf16 a[108:111], a[40:43], a[76:79], a[108:111]
    v_mfma_f32_16x16x32_bf16 a[112:115], v[204:207], a[76:79], a[112:115]
    v_mfma_f32_16x16x32_bf16 a[212:215], v[168:171], a[76:79], a[212:215]
    v_mfma_f32_16x16x32_bf16 a[88:91], v[160:163], a[184:187], a[88:91]
    v_mfma_f32_16x16x32_bf16 a[108:111], v[156:159], a[184:187], a[108:111]
    v_mfma_f32_16x16x32_bf16 a[112:115], v[152:155], a[184:187], a[112:115]
    v_mfma_f32_16x16x32_bf16 a[212:215], v[148:151], a[184:187], a[212:215]
    v_mfma_f32_16x16x32_bf16 a[88:91], a[200:203], a[192:195], a[88:91]
    v_mfma_f32_16x16x32_bf16 a[108:111], a[204:207], a[192:195], a[108:111]
    v_mfma_f32_16x16x32_bf16 a[112:115], a[208:211], a[192:195], a[112:115]
    v_mfma_f32_16x16x32_bf16 a[212:215], a[164:167], a[192:195], a[212:215]
    v_mfma_f32_16x16x32_bf16 a[88:91], a[220:223], a[168:171], a[88:91]
    v_mfma_f32_16x16x32_bf16 a[108:111], a[224:227], a[168:171], a[108:111]
    v_mfma_f32_16x16x32_bf16 a[112:115], a[228:231], a[168:171], a[112:115]
    v_mfma_f32_16x16x32_bf16 a[212:215], a[100:103], a[168:171], a[212:215]
    v_mfma_f32_16x16x32_bf16 a[88:91], v[136:139], a[172:175], a[88:91]
    v_mfma_f32_16x16x32_bf16 a[108:111], a[144:147], a[172:175], a[108:111]
    v_mfma_f32_16x16x32_bf16 a[112:115], a[148:151], a[172:175], a[112:115]
    v_mfma_f32_16x16x32_bf16 a[212:215], a[128:131], a[172:175], a[212:215]
    s_waitcnt vmcnt(0)
    s_nop 7
    s_nop 3
    s_branch G6e0_R
G6e1:
    s_cmp_eq_u32 s49, 0
    s_cbranch_scc1 G6e1_X
    s_sub_u32 s49, s49, 1
    s_add_u32 s28, s41, 10747904
    s_add_u32 s28, s28, s54
    buffer_load_dwordx4 a[48:51], v4, s[24:27], s28 offen sc1
    buffer_load_dwordx4 a[104:107], v4, s[24:27], s28 offen offset:1024 sc1
    buffer_load_dwordx4 a[196:199], v4, s[24:27], s28 offen offset:2048 sc1
    buffer_load_dwordx4 a[8:11], v5, s[24:27], s28 offen offset:2048 sc1
    buffer_load_dwordx4 a[12:15], v5, s[24:27], s28 offen offset:3072 sc1
    s_add_u32 s28, s41, 10756096
    s_add_u32 s28, s28, s54
    buffer_load_dwordx4 a[240:243], v4, s[24:27], s28 offen sc1
    s_waitcnt vmcnt(0)
    v_mfma_f32_16x16x32_bf16 a[156:159], a[136:139], a[48:51], 0
    v_mfma_f32_16x16x32_bf16 a[156:159], a[32:35], a[104:107], a[156:159]
    v_mfma_f32_16x16x32_bf16 a[156:159], v[164:167], a[196:199], a[156:159]
    v_mfma_f32_16x16x32_bf16 a[156:159], v[144:147], a[8:11], a[156:159]
    v_mfma_f32_16x16x32_bf16 a[156:159], a[0:3], a[12:15], a[156:159]
    v_mfma_f32_16x16x32_bf16 a[156:159], v[140:143], a[240:243], a[156:159]
    s_nop 7
    s_nop 3
    v_accvgpr_read_b32 v8, a156
    v_cmp_u_f32 vcc, v8, v8
    s_cbranch_vccnz G6e1
G6e1_X:
    s_add_u32 s28, s41, 10747904
    s_add_u32 s28, s28, s55
    buffer_load_dwordx4 a[124:127], v4, s[24:27], s28 offen sc1
    buffer_load_dwordx4 a[188:191], v4, s[24:27], s28 offen offset:1024 sc1
    buffer_load_dwordx4 a[92:95], v4, s[24:27], s28 offen offset:2048 sc1
    buffer_load_dwordx4 a[252:255], v5, s[24:27], s28 offen offset:2048 sc1
    buffer_load_dwordx4 a[56:59], v5, s[24:27], s28 offen offset:3072 sc1
    s_add_u32 s28, s41, 10756096
    s_add_u32 s28, s28, s55
    buffer_load_dwordx4 a[60:63], v4, s[24:27], s28 offen sc1
    s_add_u32 s28, s41, 10747904
    s_add_u32 s28, s28, s14
    buffer_load_dwordx4 a[180:183], v4, s[24:27], s28 offen sc1
    buffer_load_dwordx4 a[96:99], v4, s[24:27], s28 offen offset:1024 sc1
    buffer_load_dwordx4 a[44:47], v4, s[24:27], s28 offen offset:2048 sc1
    buffer_load_dwordx4 a[140:143], v5, s[24:27], s28 offen offset:2048 sc1
    buffer_load_dwordx4 a[132:135], v5, s[24:27], s28 offen offset:3072 sc1
    s_add_u32 s28, s41, 10756096
    s_add_u32 s28, s28, s14
    buffer_load_dwordx4 a[76:79], v4, s[24:27], s28 offen sc1
    v_mfma_f32_16x16x32_bf16 a[160:163], a[232:235], a[48:51], 0
    v_mfma_f32_16x16x32_bf16 a[176:179], a[236:239], a[48:51], 0
    v_mfma_f32_16x16x32_bf16 a[116:119], a[24:27], a[48:51], 0
    v_mfma_f32_16x16x32_bf16 a[4:7], a[28:31], a[48:51], 0
    v_mfma_f32_16x16x32_bf16 a[160:163], a[36:39], a[104:107], a[160:163]
    v_mfma_f32_16x16x32_bf16 a[176:179], a[40:43], a[104:107], a[176:179]
    v_mfma_f32_16x16x32_bf16 a[116:119], v[204:207], a[104:107], a[116:119]
    v_mfma_f32_16x16x32_bf16 a[4:7], v[168:171], a[104:107], a[4:7]
    v_mfma_f32_16x16x32_bf16 a[160:163], v[160:163], a[196:199], a[160:163]
    v_mfma_f32_16x16x32_bf16 a[176:179], v[156:159], a[196:199], a[176:179]
    v_mfma_f32_16x16x32_bf16 a[116:119], v[152:155], a[196:199], a[116:119]
    v_mfma_f32_16x16x32_bf16 a[4:7], v[148:151], a[196:199], a[4:7]
    v_mfma_f32_16x16x32_bf16 a[160:163], a[200:203], a[8:11], a[160:163]
    v_mfma_f32_16x16x32_bf16 a[176:179], a[204:207], a[8:11], a[176:179]
    v_mfma_f32_16x16x32_bf16 a[116:119], a[208:211], a[8:11], a[116:119]
    v_mfma_f32_16x16x32_bf16 a[4:7], a[164:167], a[8:11], a[4:7]
    v_mfma_f32_16x16x32_bf16 a[160:163], a[220:223], a[12:15], a[160:163]
    v_mfma_f32_16x16x32_bf16 a[176:179], a[224:227], a[12:15], a[176:179]
    v_mfma_f32_16x16x32_bf16 a[116:119], a[228:231], a[12:15], a[116:119]
    v_mfma_f32_16x16x32_bf16 a[4:7], a[100:103], a[12:15], a[4:7]
    v_mfma_f32_16x16x32_bf16 a[160:163], v[136:139], a[240:243], a[160:163]
    v_mfma_f32_16x16x32_bf16 a[176:179], a[144:147], a[240:243], a[176:179]
    v_mfma_f32_16x16x32_bf16 a[116:119], a[148:151], a[240:243], a[116:119]
    v_mfma_f32_16x16x32_bf16 a[4:7], a[128:131], a[240:243], a[4:7]
    s_waitcnt vmcnt(0)
    s_nop 7
    s_nop 3
    s_branch G6e1_R
G6e2:
    s_cmp_eq_u32 s49, 0
    s_cbranch_scc1 G6e2_X
    s_sub_u32 s49, s49, 1
    s_add_u32 s28, s41, 10747904
    s_add_u32 s28, s28, s55
    buffer_load_dwordx4 a[124:127], v4, s[24:27], s28 offen sc1
    buffer_load_dwordx4 a[188:191], v4, s[24:27], s28 offen offset:1024 sc1
    buffer_load_dwordx4 a[92:95], v4, s[24:27], s28 offen offset:2048 sc1
    buffer_load_dwordx4 a[252:255], v5, s[24:27], s28 offen offset:2048 sc1
    buffer_load_dwordx4 a[56:59], v5, s[24:27], s28 offen offset:3072 sc1
    s_add_u32 s28, s41, 10756096
    s_add_u32 s28, s28, s55
    buffer_load_dwordx4 a[60:63], v4, s[24:27], s28 offen sc1
    s_waitcnt vmcnt(0)
    v_mfma_f32_16x16x32_bf16 a[192:195], a[136:139], a[124:127], 0
    v_mfma_f32_16x16x32_bf16 a[192:195], a[32:35], a[188:191], a[192:195]
    v_mfma_f32_16x16x32_bf16 a[192:195], v[164:167], a[92:95], a[192:195]
    v_mfma_f32_16x16x32_bf16 a[192:195], v[144:147], a[252:255], a[192:195]
    v_mfma_f32_16x16x32_bf16 a[192:195], a[0:3], a[56:59], a[192:195]
    v_mfma_f32_16x16x32_bf16 a[192:195], v[140:143], a[60:63], a[192:195]
    s_nop 7
    s_nop 3
    v_accvgpr_read_b32 v8, a192
    v_cmp_u_f32 vcc, v8, v8
    s_cbranch_vccnz G6e2
G6e2_X:
    s_add_u32 s28, s41, 10747904
    s_add_u32 s28, s28, s14
    buffer_load_dwordx4 a[180:183], v4, s[24:27], s28 offen sc1
    buffer_load_dwordx4 a[96:99], v4, s[24:27], s28 offen offset:1024 sc1
    buffer_load_dwordx4 a[44:47], v4, s[24:27], s28 offen offset:2048 sc1
    buffer_load_dwordx4 a[140:143], v5, s[24:27], s28 offen offset:2048 sc1
    buffer_load_dwordx4 a[132:135], v5, s[24:27], s28 offen offset:3072 sc1
    s_add_u32 s28, s41, 10756096
    s_add_u32 s28, s28, s14
    buffer_load_dwordx4 a[76:79], v4, s[24:27], s28 offen sc1
    s_add_u32 s28, s42, 10747904
    s_add_u32 s28, s28, s15
    buffer_load_dwordx4 a[196:199], v4, s[24:27], s28 offen sc1
    buffer_load_dwordx4 a[8:11], v4, s[24:27], s28 offen offset:1024 sc1
    buffer_load_dwordx4 a[12:15], v4, s[24:27], s28 offen offset:2048 sc1
    buffer_load_dwordx4 v[248:251], v5, s[24:27], s28 offen offset:2048 sc1
    v_mfma_f32_16x16x32_bf16 a[168:171], a[232:235], a[124:127], 0
    v_mfma_f32_16x16x32_bf16 a[172:175], a[236:239], a[124:127], 0
    v_mfma_f32_16x16x32_bf16 a[48:51], a[24:27], a[124:127], 0
    v_mfma_f32_16x16x32_bf16 a[104:107], a[28:31], a[124:127], 0
    v_mfma_f32_16x16x32_bf16 a[168:171], a[36:39], a[188:191], a[168:171]
    v_mfma_f32_16x16x32_bf16 a[172:175], a[40:43], a[188:191], a[172:175]
    v_mfma_f32_16x16x32_bf16 a[48:51], v[204:207], a[188:191], a[48:51]
    v_mfma_f32_16x16x32_bf16 a[104:107], v[168:171], a[188:191], a[104:107]
    v_mfma_f32_16x16x32_bf16 a[168:171], v[160:163], a[92:95], a[168:171]
    v_mfma_f32_16x16x32_bf16 a[172:175], v[156:159], a[92:95], a[172:175]
    v_mfma_f32_16x16x32_bf16 a[48:51], v[152:155], a[92:95], a[48:51]
    v_mfma_f32_16x16x32_bf16 a[104:107], v[148:151], a[92:95], a[104:107]
    v_mfma_f32_16x16x32_bf16 a[168:171], a[200:203], a[252:255], a[168:171]
    v_mfma_f32_16x16x32_bf16 a[172:175], a[204:207], a[252:255], a[172:175]
    v_mfma_f32_16x16x32_bf16 a[48:51], a[208:211], a[252:255], a[48:51]
    v_mfma_f32_16x16x32_bf16 a[104:107], a[164:167], a[252:255], a[104:107]
    v_mfma_f32_16x16x32_bf16 a[168:171], a[220:223], a[56:59], a[168:171]
    v_mfma_f32_16x16x32_bf16 a[172:175], a[224:227], a[56:59], a[172:175]
    v_mfma_f32_16x16x32_bf16 a[48:51], a[228:231], a[56:59], a[48:51]
    v_mfma_f32_16x16x32_bf16 a[104:107], a[100:103], a[56:59], a[104:107]
    v_mfma_f32_16x16x32_bf16 a[168:171], v[136:139], a[60:63], a[168:171]
    v_mfma_f32_16x16x32_bf16 a[172:175], a[144:147], a[60:63], a[172:175]
    v_mfma_f32_16x16x32_bf16 a[48:51], a[148:151], a[60:63], a[48:51]
    v_mfma_f32_16x16x32_bf16 a[104:107], a[128:131], a[60:63], a[104:107]
    s_waitcnt vmcnt(0)
    s_nop 7
    s_nop 3
    s_branch G6e2_R
G6e3:
    s_cmp_eq_u32 s49, 0
    s_cbranch_scc1 G6e3_X
    s_sub_u32 s49, s49, 1
    s_add_u32 s28, s41, 10747904
    s_add_u32 s28, s28, s14
    buffer_load_dwordx4 a[180:183], v4, s[24:27], s28 offen sc1
    buffer_load_dwordx4 a[96:99], v4, s[24:27], s28 offen offset:1024 sc1
    buffer_load_dwordx4 a[44:47], v4, s[24:27], s28 offen offset:2048 sc1
    buffer_load_dwordx4 a[140:143], v5, s[24:27], s28 offen offset:2048 sc1
    buffer_load_dwordx4 a[132:135], v5, s[24:27], s28 offen offset:3072 sc1
    s_add_u32 s28, s41, 10756096
    s_add_u32 s28, s28, s14
    buffer_load_dwordx4 a[76:79], v4, s[24:27], s28 offen sc1
    s_waitcnt vmcnt(0)
    v_mfma_f32_16x16x32_bf16 v[72:75], a[136:139], a[180:183], v[84:87]
    v_mfma_f32_16x16x32_bf16 v[72:75], a[32:35], a[96:99], v[72:75]
    v_mfma_f32_16x16x32_bf16 v[72:75], v[164:167], a[44:47], v[72:75]
    v_mfma_f32_16x16x32_bf16 v[72:75], v[144:147], a[140:143], v[72:75]
    v_mfma_f32_16x16x32_bf16 v[72:75], a[0:3], a[132:135], v[72:75]
    v_mfma_f32_16x16x32_bf16 v[72:75], v[140:143], a[76:79], v[72:75]
    s_nop 7
    s_nop 3
    v_cmp_u_f32 vcc, v72, v72
    s_cbranch_vccnz G6e3
G6e3_X:
    s_add_u32 s28, s42, 10747904
    s_add_u32 s28, s28, s15
    buffer_load_dwordx4 a[196:199], v4, s[24:27], s28 offen sc1
    buffer_load_dwordx4 a[8:11], v4, s[24:27], s28 offen offset:1024 sc1
    buffer_load_dwordx4 a[12:15], v4, s[24:27], s28 offen offset:2048 sc1
    buffer_load_dwordx4 v[248:251], v5, s[24:27], s28 offen offset:2048 sc1
    buffer_load_dwordx4 a[252:255], v5, s[24:27], s28 offen offset:3072 sc1
    s_add_u32 s28, s42, 10756096
    s_add_u32 s28, s28, s15
    buffer_load_dwordx4 a[56:59], v4, s[24:27], s28 offen sc1
    s_add_u32 s28, s48, 10747904
    s_add_u32 s28, s28, s15
    buffer_load_dwordx4 a[60:63], v4, s[24:27], s28 offen sc1
    v_mfma_f32_16x16x32_bf16 v[56:59], a[232:235], a[180:183], v[104:107]
    v_mfma_f32_16x16x32_bf16 v[60:63], a[236:239], a[180:183], v[80:83]
    v_mfma_f32_16x16x32_bf16 v[32:35], a[24:27], a[180:183], v[132:135]
    v_mfma_f32_16x16x32_bf16 v[120:123], a[28:31], a[180:183], v[128:131]
    v_mfma_f32_16x16x32_bf16 v[56:59], a[36:39], a[96:99], v[56:59]
    v_mfma_f32_16x16x32_bf16 v[60:63], a[40:43], a[96:99], v[60:63]
    v_mfma_f32_16x16x32_bf16 v[32:35], v[204:207], a[96:99], v[32:35]
    v_mfma_f32_16x16x32_bf16 v[120:123], v[168:171], a[96:99], v[120:123]
    v_mfma_f32_16x16x32_bf16 v[56:59], v[160:163], a[44:47], v[56:59]
    v_mfma_f32_16x16x32_bf16 v[60:63], v[156:159], a[44:47], v[60:63]
    v_mfma_f32_16x16x32_bf16 v[32:35], v[152:155], a[44:47], v[32:35]
    v_mfma_f32_16x16x32_bf16 v[120:123], v[148:151], a[44:47], v[120:123]
    v_mfma_f32_16x16x32_bf16 v[56:59], a[200:203], a[140:143], v[56:59]
    v_mfma_f32_16x16x32_bf16 v[60:63], a[204:207], a[140:143], v[60:63]
    v_mfma_f32_16x16x32_bf16 v[32:35], a[208:211], a[140:143], v[32:35]
    v_mfma_f32_16x16x32_bf16 v[120:123], a[164:167], a[140:143], v[120:123]
    v_mfma_f32_16x16x32_bf16 v[56:59], a[220:223], a[132:135], v[56:59]
    v_mfma_f32_16x16x32_bf16 v[60:63], a[224:227], a[132:135], v[60:63]
    v_mfma_f32_16x16x32_bf16 v[32:35], a[228:231], a[132:135], v[32:35]
    v_mfma_f32_16x16x32_bf16 v[120:123], a[100:103], a[132:135], v[120:123]
    v_mfma_f32_16x16x32_bf16 v[56:59], v[136:139], a[76:79], v[56:59]
    v_mfma_f32_16x16x32_bf16 v[60:63], a[144:147], a[76:79], v[60:63]
    v_mfma_f32_16x16x32_bf16 v[32:35], a[148:151], a[76:79], v[32:35]
    v_mfma_f32_16x16x32_bf16 v[120:123], a[128:131], a[76:79], v[120:123]
    s_waitcnt vmcnt(0)
    s_nop 7
    s_nop 3
    s_branch G6e3_R
G6l0:
    s_cmp_eq_u32 s49, 0
    s_cbranch_scc1 G6l0_X
    s_sub_u32 s49, s49, 1
    s_add_u32 s28, s42, 10747904
    s_add_u32 s28, s28, s15
    buffer_load_dwordx4 a[196:199], v4, s[24:27], s28 offen sc1
    buffer_load_dwordx4 a[8:11], v4, s[24:27], s28 offen offset:1024 sc1
    buffer_load_dwordx4 a[12:15], v4, s[24:27], s28 offen offset:2048 sc1
    buffer_load_dwordx4 v[248:251], v5, s[24:27], s28 offen offset:2048 sc1
    buffer_load_dwordx4 a[252:255], v5, s[24:27], s28 offen offset:3072 sc1
    s_add_u32 s28, s42, 10756096
    s_add_u32 s28, s28, s15
    buffer_load_dwordx4 a[56:59], v4, s[24:27], s28 offen sc1
    s_add_u32 s28, s48, 10747904
    s_add_u32 s28, s28, s15
    buffer_load_dwordx4 a[60:63], v4, s[24:27], s28 offen sc1
    s_add_u32 s28, s40, 10747904
    s_add_u32 s28, s28, s15
    buffer_load_dwordx4 a[220:223], v30, s[24:27], s28 offen sc1
    s_waitcnt vmcnt(0)
    v_mfma_f32_16x16x32_bf16 a[28:31], a[120:123], a[196:199], a[84:87]
    v_mfma_f32_16x16x32_bf16 a[28:31], a[16:19], a[8:11], a[28:31]
    v_mfma_f32_16x16x32_bf16 a[28:31], a[52:55], a[12:15], a[28:31]
    v_mfma_f32_16x16x32_bf16 a[28:31], v[244:247], v[248:251], a[28:31]
    v_mfma_f32_16x16x32_bf16 a[28:31], a[180:183], a[252:255], a[28:31]
    v_mfma_f32_16x16x32_bf16 a[28:31], a[76:79], a[56:59], a[28:31]
    v_mfma_f32_16x16x32_bf16 a[28:31], v[236:239], a[60:63], a[28:31]
    v_mfma_f32_16x16x32_bf16 a[28:31], a[224:227], a[220:223], a[28:31]
    s_nop 7
    s_nop 3
    v_accvgpr_read_b32 v8, a28
    v_cmp_u_f32 vcc, v8, v8
    s_cbranch_vccnz G6l0
G6l0_X:
    s_add_u32 s28, s42, 10747904
    s_add_u32 s28, s28, s54
    buffer_load_dwordx4 a[128:131], v4, s[24:27], s28 offen sc1
    buffer_load_dwordx4 v[232:235], v4, s[24:27], s28 offen offset:1024 sc1
    buffer_load_dwordx4 v[228:231], v4, s[24:27], s28 offen offset:2048 sc1
    buffer_load_dwordx4 v[220:223], v5, s[24:27], s28 offen offset:2048 sc1
    buffer_load_dwordx4 v[216:219], v5, s[24:27], s28 offen offset:3072 sc1
    s_add_u32 s28, s42, 10756096
    s_add_u32 s28, s28, s54
    buffer_load_dwordx4 v[224:227], v4, s[24:27], s28 offen sc1
    s_add_u32 s28, s48, 10747904
    s_add_u32 s28, s28, s54
    buffer_load_dwordx4 v[200:203], v4, s[24:27], s28 offen sc1
    s_add_u32 s28, s40, 10747904
    s_add_u32 s28, s28, s54
    buffer_load_dwordx4 v[196:199], v30, s[24:27], s28 offen sc1
    s_add_u32 s28, s42, 10747904
    s_add_u32 s28, s28, s55
    buffer_load_dwordx4 v[192:195], v4, s[24:27], s28 offen sc1
    buffer_load_dwordx4 v[212:215], v4, s[24:27], s28 offen offset:1024 sc1
    v_mfma_f32_16x16x32_bf16 a[32:35], a[20:23], a[196:199], a[88:91]
    v_mfma_f32_16x16x32_bf16 a[36:39], a[244:247], a[196:199], a[108:111]
    v_mfma_f32_16x16x32_bf16 a[40:43], a[248:251], a[196:199], a[112:115]
    v_mfma_f32_16x16x32_bf16 a[200:203], a[80:83], a[196:199], a[212:215]
    v_mfma_f32_16x16x32_bf16 a[32:35], a[68:71], a[8:11], a[32:35]
    v_mfma_f32_16x16x32_bf16 a[36:39], a[72:75], a[8:11], a[36:39]
    v_mfma_f32_16x16x32_bf16 a[40:43], a[152:155], a[8:11], a[40:43]
    v_mfma_f32_16x16x32_bf16 a[200:203], a[216:219], a[8:11], a[200:203]
    v_mfma_f32_16x16x32_bf16 a[32:35], a[64:67], a[12:15], a[32:35]
    v_mfma_f32_16x16x32_bf16 a[36:39], a[184:187], a[12:15], a[36:39]
    v_mfma_f32_16x16x32_bf16 a[40:43], a[240:243], a[12:15], a[40:43]
    v_mfma_f32_16x16x32_bf16 a[200:203], v[252:255], a[12:15], a[200:203]
    v_mfma_f32_16x16x32_bf16 a[32:35], v[240:243], v[248:251], a[32:35]
    v_mfma_f32_16x16x32_bf16 a[36:39], a[124:127], v[248:251], a[36:39]
    v_mfma_f32_16x16x32_bf16 a[40:43], a[188:191], v[248:251], a[40:43]
    v_mfma_f32_16x16x32_bf16 a[200:203], a[92:95], v[248:251], a[200:203]
    v_mfma_f32_16x16x32_bf16 a[32:35], a[96:99], a[252:255], a[32:35]
    v_mfma_f32_16x16x32_bf16 a[36:39], a[44:47], a[252:255], a[36:39]
    v_mfma_f32_16x16x32_bf16 a[40:43], a[140:143], a[252:255], a[40:43]
    v_mfma_f32_16x16x32_bf16 a[200:203], a[132:135], a[252:255], a[200:203]
    v_mfma_f32_16x16x32_bf16 a[32:35], a[136:139], a[56:59], a[32:35]
    v_mfma_f32_16x16x32_bf16 a[36:39], a[232:235], a[56:59], a[36:39]
    v_mfma_f32_16x16x32_bf16 a[40:43], a[236:239], a[56:59], a[40:43]
    v_mfma_f32_16x16x32_bf16 a[200:203], a[24:27], a[56:59], a[200:203]
    v_mfma_f32_16x16x32_bf16 a[32:35], a[204:207], a[60:63], a[32:35]
    v_mfma_f32_16x16x32_bf16 a[36:39], a[208:211], a[60:63], a[36:39]
    v_mfma_f32_16x16x32_bf16 a[40:43], a[164:167], a[60:63], a[40:43]
    v_mfma_f32_16x16x32_bf16 a[200:203], a[0:3], a[60:63], a[200:203]
    v_mfma_f32_16x16x32_bf16 a[32:35], a[228:231], a[220:223], a[32:35]
    v_mfma_f32_16x16x32_bf16 a[36:39], a[100:103], a[220:223], a[36:39]
    v_mfma_f32_16x16x32_bf16 a[40:43], a[144:147], a[220:223], a[40:43]
    v_mfma_f32_16x16x32_bf16 a[200:203], a[148:151], a[220:223], a[200:203]
    s_waitcnt vmcnt(0)
    s_nop 7
    s_nop 3
    s_branch G6l0_R
G6l1:
    s_cmp_eq_u32 s49, 0
    s_cbranch_scc1 G6l1_X
    s_sub_u32 s49, s49, 1
    s_add_u32 s28, s42, 10747904
    s_add_u32 s28, s28, s54
    buffer_load_dwordx4 a[128:131], v4, s[24:27], s28 offen sc1
    buffer_load_dwordx4 v[232:235], v4, s[24:27], s28 offen offset:1024 sc1
    buffer_load_dwordx4 v[228:231], v4, s[24:27], s28 offen offset:2048 sc1
    buffer_load_dwordx4 v[220:223], v5, s[24:27], s28 offen offset:2048 sc1
    buffer_load_dwordx4 v[216:219], v5, s[24:27], s28 offen offset:3072 sc1
    s_add_u32 s28, s42, 10756096
    s_add_u32 s28, s28, s54
    buffer_load_dwordx4 v[224:227], v4, s[24:27], s28 offen sc1
    s_add_u32 s28, s48, 10747904
    s_add_u32 s28, s28, s54
    buffer_load_dwordx4 v[200:203], v4, s[24:27], s28 offen sc1
    s_add_u32 s28, s40, 10747904
    s_add_u32 s28, s28, s54
    buffer_load_dwordx4 v[196:199], v30, s[24:27], s28 offen sc1
    s_waitcnt vmcnt(0)
    v_mfma_f32_16x16x32_bf16 a[196:199], a[120:123], a[128:131], a[156:159]
    v_mfma_f32_16x16x32_bf16 a[196:199], a[16:19], v[232:235], a[196:199]
    v_mfma_f32_16x16x32_bf16 a[196:199], a[52:55], v[228:231], a[196:199]
    v_mfma_f32_16x16x32_bf16 a[196:199], v[244:247], v[220:223], a[196:199]
    v_mfma_f32_16x16x32_bf16 a[196:199], a[180:183], v[216:219], a[196:199]
    v_mfma_f32_16x16x32_bf16 a[196:199], a[76:79], v[224:227], a[196:199]
    v_mfma_f32_16x16x32_bf16 a[196:199], v[236:239], v[200:203], a[196:199]
    v_mfma_f32_16x16x32_bf16 a[196:199], a[224:227], v[196:199], a[196:199]
    s_nop 7
    s_nop 3
    v_accvgpr_read_b32 v8, a196
    v_cmp_u_f32 vcc, v8, v8
    s_cbranch_vccnz G6l1
G6l1_X:
    s_add_u32 s28, s42, 10747904
    s_add_u32 s28, s28, s55
    buffer_load_dwordx4 v[192:195], v4, s[24:27], s28 offen sc1
    buffer_load_dwordx4 v[212:215], v4, s[24:27], s28 offen offset:1024 sc1
    buffer_load_dwordx4 a[60:63], v4, s[24:27], s28 offen offset:2048 sc1
    buffer_load_dwordx4 a[220:223], v5, s[24:27], s28 offen offset:2048 sc1
    buffer_load_dwordx4 a[84:87], v5, s[24:27], s28 offen offset:3072 sc1
    s_add_u32 s28, s42, 10756096
    s_add_u32 s28, s28, s55
    buffer_load_dwordx4 a[88:91], v4, s[24:27], s28 offen sc1
    s_add_u32 s28, s48, 10747904
    s_add_u32 s28, s28, s55
    buffer_load_dwordx4 a[108:111], v4, s[24:27], s28 offen sc1
    s_add_u32 s28, s40, 10747904
    s_add_u32 s28, s28, s55
    buffer_load_dwordx4 a[112:115], v30, s[24:27], s28 offen sc1
    s_add_u32 s28, s42, 10747904
    s_add_u32 s28, s28, s14
    buffer_load_dwordx4 a[212:215], v4, s[24:27], s28 offen sc1
    buffer_load_dwordx4 a[28:31], v4, s[24:27], s28 offen offset:1024 sc1
    buffer_load_dwordx4 a[32:35], v4, s[24:27], s28 offen offset:2048 sc1
    buffer_load_dwordx4 a[36:39], v5, s[24:27], s28 offen offset:2048 sc1
    v_mfma_f32_16x16x32_bf16 a[8:11], a[20:23], a[128:131], a[160:163]
    v_mfma_f32_16x16x32_bf16 a[12:15], a[244:247], a[128:131], a[176:179]
    v_mfma_f32_16x16x32_bf16 a[252:255], a[248:251], a[128:131], a[116:119]
    v_mfma_f32_16x16x32_bf16 a[56:59], a[80:83], a[128:131], a[4:7]
    v_mfma_f32_16x16x32_bf16 a[8:11], a[68:71], v[232:235], a[8:11]
    v_mfma_f32_16x16x32_bf16 a[12:15], a[72:75], v[232:235], a[12:15]
    v_mfma_f32_16x16x32_bf16 a[252:255], a[152:155], v[232:235], a[252:255]
    v_mfma_f32_16x16x32_bf16 a[56:59], a[216:219], v[232:235], a[56:59]
    v_mfma_f32_16x16x32_bf16 a[8:11], a[64:67], v[228:231], a[8:11]
    v_mfma_f32_16x16x32_bf16 a[12:15], a[184:187], v[228:231], a[12:15]
    v_mfma_f32_16x16x32_bf16 a[252:255], a[240:243], v[228:231], a[252:255]
    v_mfma_f32_16x16x32_bf16 a[56:59], v[252:255], v[228:231], a[56:59]
    v_mfma_f32_16x16x32_bf16 a[8:11], v[240:243], v[220:223], a[8:11]
    v_mfma_f32_16x16x32_bf16 a[12:15], a[124:127], v[220:223], a[12:15]
    v_mfma_f32_16x16x32_bf16 a[252:255], a[188:191], v[220:223], a[252:255]
    v_mfma_f32_16x16x32_bf16 a[56:59], a[92:95], v[220:223], a[56:59]
    v_mfma_f32_16x16x32_bf16 a[8:11], a[96:99], v[216:219], a[8:11]
    v_mfma_f32_16x16x32_bf16 a[12:15], a[44:47], v[216:219], a[12:15]
    v_mfma_f32_16x16x32_bf16 a[252:255], a[140:143], v[216:219], a[252:255]
    v_mfma_f32_16x16x32_bf16 a[56:59], a[132:135], v[216:219], a[56:59]
    v_mfma_f32_16x16x32_bf16 a[8:11], a[136:139], v[224:227], a[8:11]
    v_mfma_f32_16x16x32_bf16 a[12:15], a[232:235], v[224:227], a[12:15]
    v_mfma_f32_16x16x32_bf16 a[252:255], a[236:239], v[224:227], a[252:255]
    v_mfma_f32_16x16x32_bf16 a[56:59], a[24:27], v[224:227], a[56:59]
    v_mfma_f32_16x16x32_bf16 a[8:11], a[204:207], v[200:203], a[8:11]
    v_mfma_f32_16x16x32_bf16 a[12:15], a[208:211], v[200:203], a[12:15]
    v_mfma_f32_16x16x32_bf16 a[252:255], a[164:167], v[200:203], a[252:255]
    v_mfma_f32_16x16x32_bf16 a[56:59], a[0:3], v[200:203], a[56:59]
    v_mfma_f32_16x16x32_bf16 a[8:11], a[228:231], v[196:199], a[8:11]
    v_mfma_f32_16x16x32_bf16 a[12:15], a[100:103], v[196:199], a[12:15]
    v_mfma_f32_16x16x32_bf16 a[252:255], a[144:147], v[196:199], a[252:255]
    v_mfma_f32_16x16x32_bf16 a[56:59], a[148:151], v[196:199], a[56:59]
    s_waitcnt vmcnt(0)
    s_nop 7
    s_nop 3
    s_branch G6l1_R
G6l2:
    s_cmp_eq_u32 s49, 0
    s_cbranch_scc1 G6l2_X
    s_sub_u32 s49, s49, 1
    s_add_u32 s28, s42, 10747904
    s_add_u32 s28, s28, s55
    buffer_load_dwordx4 v[192:195], v4, s[24:27], s28 offen sc1
    buffer_load_dwordx4 v[212:215], v4, s[24:27], s28 offen offset:1024 sc1
    buffer_load_dwordx4 a[60:63], v4, s[24:27], s28 offen offset:2048 sc1
    buffer_load_dwordx4 a[220:223], v5, s[24:27], s28 offen offset:2048 sc1
    buffer_load_dwordx4 a[84:87], v5, s[24:27], s28 offen offset:3072 sc1
    s_add_u32 s28, s42, 10756096
    s_add_u32 s28, s28, s55
    buffer_load_dwordx4 a[88:91], v4, s[24:27], s28 offen sc1
    s_add_u32 s28, s48, 10747904
    s_add_u32 s28, s28, s55
    buffer_load_dwordx4 a[108:111], v4, s[24:27], s28 offen sc1
    s_add_u32 s28, s40, 10747904
    s_add_u32 s28, s28, s55
    buffer_load_dwordx4 a[112:115], v30, s[24:27], s28 offen sc1
    s_waitcnt vmcnt(0)
    v_mfma_f32_16x16x32_bf16 a[40:43], a[120:123], v[192:195], a[192:195]
    v_mfma_f32_16x16x32_bf16 a[40:43], a[16:19], v[212:215], a[40:43]
    v_mfma_f32_16x16x32_bf16 a[40:43], a[52:55], a[60:63], a[40:43]
    v_mfma_f32_16x16x32_bf16 a[40:43], v[244:247], a[220:223], a[40:43]
    v_mfma_f32_16x16x32_bf16 a[40:43], a[180:183], a[84:87], a[40:43]
    v_mfma_f32_16x16x32_bf16 a[40:43], a[76:79], a[88:91], a[40:43]
    v_mfma_f32_16x16x32_bf16 a[40:43], v[236:239], a[108:111], a[40:43]
    v_mfma_f32_16x16x32_bf16 a[40:43], a[224:227], a[112:115], a[40:43]
    s_nop 7
    s_nop 3
    v_accvgpr_read_b32 v8, a40
    v_cmp_u_f32 vcc, v8, v8
    s_cbranch_vccnz G6l2
G6l2_X:
    s_add_u32 s28, s42, 10747904
    s_add_u32 s28, s28, s14
    buffer_load_dwordx4 a[212:215], v4, s[24:27], s28 offen sc1
    buffer_load_dwordx4 a[28:31], v4, s[24:27], s28 offen offset:1024 sc1
    buffer_load_dwordx4 a[32:35], v4, s[24:27], s28 offen offset:2048 sc1
    buffer_load_dwordx4 a[36:39], v5, s[24:27], s28 offen offset:2048 sc1
    buffer_load_dwordx4 a[176:179], v5, s[24:27], s28 offen offset:3072 sc1
    s_add_u32 s28, s42, 10756096
    s_add_u32 s28, s28, s14
    buffer_load_dwordx4 a[116:119], v4, s[24:27], s28 offen sc1
    s_add_u32 s28, s48, 10747904
    s_add_u32 s28, s28, s14
    buffer_load_dwordx4 a[4:7], v4, s[24:27], s28 offen sc1
    s_add_u32 s28, s40, 10747904
    s_add_u32 s28, s28, s14
    buffer_load_dwordx4 v[208:211], v30, s[24:27], s28 offen sc1
    v_mfma_f32_16x16x32_bf16 a[200:203], a[20:23], v[192:195], a[168:171]
    v_mfma_f32_16x16x32_bf16 a[128:131], a[244:247], v[192:195], a[172:175]
    v_mfma_f32_16x16x32_bf16 a[156:159], a[248:251], v[192:195], a[48:51]
    v_mfma_f32_16x16x32_bf16 a[160:163], a[80:83], v[192:195], a[104:107]
    v_mfma_f32_16x16x32_bf16 a[200:203], a[68:71], v[212:215], a[200:203]
    v_mfma_f32_16x16x32_bf16 a[128:131], a[72:75], v[212:215], a[128:131]
    v_mfma_f32_16x16x32_bf16 a[156:159], a[152:155], v[212:215], a[156:159]
    v_mfma_f32_16x16x32_bf16 a[160:163], a[216:219], v[212:215], a[160:163]
    v_mfma_f32_16x16x32_bf16 a[200:203], a[64:67], a[60:63], a[200:203]
    v_mfma_f32_16x16x32_bf16 a[128:131], a[184:187], a[60:63], a[128:131]
    v_mfma_f32_16x16x32_bf16 a[156:159], a[240:243], a[60:63], a[156:159]
    v_mfma_f32_16x16x32_bf16 a[160:163], v[252:255], a[60:63], a[160:163]
    v_mfma_f32_16x16x32_bf16 a[200:203], v[240:243], a[220:223], a[200:203]
    v_mfma_f32_16x16x32_bf16 a[128:131], a[124:127], a[220:223], a[128:131]
    v_mfma_f32_16x16x32_bf16 a[156:159], a[188:191], a[220:223], a[156:159]
    v_mfma_f32_16x16x32_bf16 a[160:163], a[92:95], a[220:223], a[160:163]
    v_mfma_f32_16x16x32_bf16 a[200:203], a[96:99], a[84:87], a[200:203]
    v_mfma_f32_16x16x32_bf16 a[128:131], a[44:47], a[84:87], a[128:131]
    v_mfma_f32_16x16x32_bf16 a[156:159], a[140:143], a[84:87], a[156:159]
    v_mfma_f32_16x16x32_bf16 a[160:163], a[132:135], a[84:87], a[160:163]
    v_mfma_f32_16x16x32_bf16 a[200:203], a[136:139], a[88:91], a[200:203]
    v_mfma_f32_16x16x32_bf16 a[128:131], a[232:235], a[88:91], a[128:131]
    v_mfma_f32_16x16x32_bf16 a[156:159], a[236:239], a[88:91], a[156:159]
    v_mfma_f32_16x16x32_bf16 a[160:163], a[24:27], a[88:91], a[160:163]
    v_mfma_f32_16x16x32_bf16 a[200:203], a[204:207], a[108:111], a[200:203]
    v_mfma_f32_16x16x32_bf16 a[128:131], a[208:211], a[108:111], a[128:131]
    v_mfma_f32_16x16x32_bf16 a[156:159], a[164:167], a[108:111], a[156:159]
    v_mfma_f32_16x16x32_bf16 a[160:163], a[0:3], a[108:111], a[160:163]
    v_mfma_f32_16x16x32_bf16 a[200:203], a[228:231], a[112:115], a[200:203]
    v_mfma_f32_16x16x32_bf16 a[128:131], a[100:103], a[112:115], a[128:131]
    v_mfma_f32_16x16x32_bf16 a[156:159], a[144:147], a[112:115], a[156:159]
    v_mfma_f32_16x16x32_bf16 a[160:163], a[148:151], a[112:115], a[160:163]
    s_waitcnt vmcnt(0)
    s_nop 7
    s_nop 3
    s_branch G6l2_R
G6l3:
    s_cmp_eq_u32 s49, 0
    s_cbranch_scc1 G6l3_X
    s_sub_u32 s49, s49, 1
    s_add_u32 s28, s42, 10747904
    s_add_u32 s28, s28, s14
    buffer_load_dwordx4 a[212:215], v4, s[24:27], s28 offen sc1
    buffer_load_dwordx4 a[28:31], v4, s[24:27], s28 offen offset:1024 sc1
    buffer_load_dwordx4 a[32:35], v4, s[24:27], s28 offen offset:2048 sc1
    buffer_load_dwordx4 a[36:39], v5, s[24:27], s28 offen offset:2048 sc1
    buffer_load_dwordx4 a[176:179], v5, s[24:27], s28 offen offset:3072 sc1
    s_add_u32 s28, s42, 10756096
    s_add_u32 s28, s28, s14
    buffer_load_dwordx4 a[116:119], v4, s[24:27], s28 offen sc1
    s_add_u32 s28, s48, 10747904
    s_add_u32 s28, s28, s14
    buffer_load_dwordx4 a[4:7], v4, s[24:27], s28 offen sc1
    s_add_u32 s28, s40, 10747904
    s_add_u32 s28, s28, s14
    buffer_load_dwordx4 v[208:211], v30, s[24:27], s28 offen sc1
    s_waitcnt vmcnt(0)
    v_mfma_f32_16x16x32_bf16 v[108:111], a[120:123], a[212:215], v[72:75]
    v_mfma_f32_16x16x32_bf16 v[108:111], a[16:19], a[28:31], v[108:111]
    v_mfma_f32_16x16x32_bf16 v[108:111], a[52:55], a[32:35], v[108:111]
    v_mfma_f32_16x16x32_bf16 v[108:111], v[244:247], a[36:39], v[108:111]
    v_mfma_f32_16x16x32_bf16 v[108:111], a[180:183], a[176:179], v[108:111]
    v_mfma_f32_16x16x32_bf16 v[108:111], a[76:79], a[116:119], v[108:111]
    v_mfma_f32_16x16x32_bf16 v[108:111], v[236:239], a[4:7], v[108:111]
    v_mfma_f32_16x16x32_bf16 v[108:111], a[224:227], v[208:211], v[108:111]
    s_nop 7
    s_nop 3
    v_cmp_u_f32 vcc, v108, v108
    s_cbranch_vccnz G6l3
G6l3_X:
    v_mfma_f32_16x16x32_bf16 v[112:115], a[20:23], a[212:215], v[56:59]
    v_mfma_f32_16x16x32_bf16 v[40:43], a[244:247], a[212:215], v[60:63]
    v_mfma_f32_16x16x32_bf16 v[52:55], a[248:251], a[212:215], v[32:35]
    v_mfma_f32_16x16x32_bf16 v[124:127], a[80:83], a[212:215], v[120:123]
    v_mfma_f32_16x16x32_bf16 v[112:115], a[68:71], a[28:31], v[112:115]
    v_mfma_f32_16x16x32_bf16 v[40:43], a[72:75], a[28:31], v[40:43]
    v_mfma_f32_16x16x32_bf16 v[52:55], a[152:155], a[28:31], v[52:55]
    v_mfma_f32_16x16x32_bf16 v[124:127], a[216:219], a[28:31], v[124:127]
    v_mfma_f32_16x16x32_bf16 v[112:115], a[64:67], a[32:35], v[112:115]
    v_mfma_f32_16x16x32_bf16 v[40:43], a[184:187], a[32:35], v[40:43]
    v_mfma_f32_16x16x32_bf16 v[52:55], a[240:243], a[32:35], v[52:55]
    v_mfma_f32_16x16x32_bf16 v[124:127], v[252:255], a[32:35], v[124:127]
    v_mfma_f32_16x16x32_bf16 v[112:115], v[240:243], a[36:39], v[112:115]
    v_mfma_f32_16x16x32_bf16 v[40:43], a[124:127], a[36:39], v[40:43]
    v_mfma_f32_16x16x32_bf16 v[52:55], a[188:191], a[36:39], v[52:55]
    v_mfma_f32_16x16x32_bf16 v[124:127], a[92:95], a[36:39], v[124:127]
    v_mfma_f32_16x16x32_bf16 v[112:115], a[96:99], a[176:179], v[112:115]
    v_mfma_f32_16x16x32_bf16 v[40:43], a[44:47], a[176:179], v[40:43]
    v_mfma_f32_16x16x32_bf16 v[52:55], a[140:143], a[176:179], v[52:55]
    v_mfma_f32_16x16x32_bf16 v[124:127], a[132:135], a[176:179], v[124:127]
    v_mfma_f32_16x16x32_bf16 v[112:115], a[136:139], a[116:119], v[112:115]
    v_mfma_f32_16x16x32_bf16 v[40:43], a[232:235], a[116:119], v[40:43]
    v_mfma_f32_16x16x32_bf16 v[52:55], a[236:239], a[116:119], v[52:55]
    v_mfma_f32_16x16x32_bf16 v[124:127], a[24:27], a[116:119], v[124:127]
    v_mfma_f32_16x16x32_bf16 v[112:115], a[204:207], a[4:7], v[112:115]
    v_mfma_f32_16x16x32_bf16 v[40:43], a[208:211], a[4:7], v[40:43]
    v_mfma_f32_16x16x32_bf16 v[52:55], a[164:167], a[4:7], v[52:55]
    v_mfma_f32_16x16x32_bf16 v[124:127], a[0:3], a[4:7], v[124:127]
    v_mfma_f32_16x16x32_bf16 v[112:115], a[228:231], v[208:211], v[112:115]
    v_mfma_f32_16x16x32_bf16 v[40:43], a[100:103], v[208:211], v[40:43]
    v_mfma_f32_16x16x32_bf16 v[52:55], a[144:147], v[208:211], v[52:55]
    v_mfma_f32_16x16x32_bf16 v[124:127], a[148:151], v[208:211], v[124:127]
    s_waitcnt vmcnt(0)
    s_nop 7
    s_nop 3
    s_branch G6l3_R
CODE_END:
.section .rodata,"a"
.p2align 6
.amdhsa_kernel f_kernel
  .amdhsa_next_free_vgpr 128
  .amdhsa_next_free_sgpr 66
  .amdhsa_accum_offset 128
  .amdhsa_group_segment_fixed_size 0
  .amdhsa_kernarg_size 120
  .amdhsa_user_sgpr_count 2
  .amdhsa_user_sgpr_kernarg_segment_ptr 1
  .amdhsa_system_sgpr_workgroup_id_x 1
  .amdhsa_float_denorm_mode_32 3
.end_amdhsa_kernel
.amdhsa_kernel g_kernel
  .amdhsa_next_free_vgpr 512
  .amdhsa_next_free_sgpr 75
  .amdhsa_accum_offset 256
  .amdhsa_group_segment_fixed_size 0
  .amdhsa_kernarg_size 120
  .amdhsa_user_sgpr_count 2
  .amdhsa_user_sgpr_kernarg_segment_ptr 1
  .amdhsa_system_sgpr_workgroup_id_x 1
  .amdhsa_float_denorm_mode_32 3
.end_amdhsa_kernel
```
